```python
import torch

def _softmax(x, axis=-1):
    return torch.softmax(x, dim=axis)
def _gelu(x):
    return torch.nn.functional.gelu(x, approximate="tanh")
def _silu(x):
    return torch.nn.functional.silu(x)
def _sigmoid(x):
    return torch.sigmoid(x)
def _layernorm(x, axis=-1, eps=1e-5):
    m = x.mean(dim=axis, keepdim=True)
    v = x.var(dim=axis, keepdim=True, unbiased=False)
    return (x - m) / torch.sqrt(v + eps)
def _scatter_add(tgt, idx, src, axis=0):
    return tgt.clone().index_add_(axis, idx, src)
def _segment_sum(src, seg, n):
    out = torch.zeros((n,) + src.shape[1:], dtype=src.dtype)
    return out.index_add_(0, seg, src)
def _pad(x, pw):
    flat = tuple(v for pair in reversed(pw) for v in pair)
    return torch.nn.functional.pad(x, flat)

kernel_name = 'standalone__mha_block_cached__near_ridge'

def setup_inputs():

    _w = (lambda a: (lambda t: t.to(torch.bfloat16) if t.is_floating_point() else t)(torch.as_tensor(a)))
    B, Sq, D = 8, 192, 640
    H, Sk, Dh = 32, 512, 128
    return {
        "x": _w((lambda *s: torch.randn(*s, dtype=torch.bfloat16) * 0.8)(B, Sq, D)),
        "k_cache": _w((lambda *s: torch.randn(*s, dtype=torch.bfloat16) * 0.8)(B, H, Sk, Dh)),
        "v_cache": _w((lambda *s: torch.randn(*s, dtype=torch.bfloat16) * 0.05)(B, H, Sk, Dh)),
        "wq": _w((lambda *s: torch.randn(*s, dtype=torch.bfloat16) * 0.8)(D, H * Dh) * (D ** -0.5)),
        "wo": _w((lambda *s: torch.randn(*s, dtype=torch.bfloat16) * 0.05)(H * Dh, D) * ((H * Dh) ** -0.5)),
    }

def reference(x, k_cache, v_cache, wq, wo):
    B, Sq, D = x.shape
    H, Dh = 32, 128
    q = (lambda x, *d: x.permute(*d))((x @ wq).reshape(B, Sq, H, Dh), 0, 2, 1, 3)
    scores = torch.einsum("bhqd,bhkd->bhqk", q, k_cache) * (Dh ** -0.5)
    p = _softmax(scores, axis=-1)
    o = torch.einsum("bhqk,bhkd->bhqd", p, v_cache)
    return (lambda x, *d: x.permute(*d))(o, 0, 2, 1, 3).reshape(B, Sq, H * Dh) @ wo
```

```asm
; @launch grid=(256,1,1) block=(256,1,1) lds=163840
.amdgcn_target "amdgcn-amd-amdhsa--gfx950"
.text
.globl standalone__mha_block_cached__near_ridge_kernel
.type standalone__mha_block_cached__near_ridge_kernel,@function
.p2align 8
standalone__mha_block_cached__near_ridge_kernel:
  s_cmp_ge_u32 s2, 256
  s_cbranch_scc1 L_attn_end
  s_load_dwordx4 s[4:7], s[0:1], 0
  s_load_dwordx4 s[8:11], s[0:1], 16
  s_load_dwordx2 s[12:13], s[0:1], 56
  s_load_dwordx2 s[54:55], s[0:1], 32
  s_load_dwordx4 s[88:91], s[0:1], 40
  s_memrealtime s[92:93]
  s_and_b32 s14, s2, 7
  s_lshr_b32 s15, s2, 3
  s_and_b32 s16, s14, 1
  s_lshl_b32 s16, s16, 2
  s_and_b32 s17, s15, 3
  s_add_u32 s16, s16, s17
  s_lshr_b32 s17, s14, 1
  s_lshl_b32 s17, s17, 3
  s_lshr_b32 s18, s15, 2
  s_add_u32 s17, s17, s18
  v_and_b32 v1, 63, v0
  v_lshrrev_b32 v2, 6, v0
  s_nop 0
  v_readfirstlane_b32 s19, v2
  v_and_b32 v3, 15, v1
  v_lshrrev_b32 v4, 4, v1
  v_and_b32 v9, 1, v2
  v_lshrrev_b32 v11, 3, v1
  v_lshrrev_b32 v12, 1, v11
  v_lshl_add_u32 v12, v9, 2, v12
  v_and_b32 v13, 7, v1
  v_xor_b32 v12, v12, v13
  v_lshl_add_u32 v11, v2, 3, v11
  v_mul_u32_u24 v11, 1280, v11
  v_lshl_add_u32 v112, v12, 4, v11
  v_lshlrev_b32 v11, 2, v4
  v_xor_b32 v11, v11, v3
  v_lshlrev_b32 v13, 4, v11
  v_lshl_add_u32 v12, v2, 2, v4
  v_lshl_add_u32 v113, v12, 13, v13
  v_lshl_add_u32 v252, v4, 8, v13
  v_xor_b32 v253, 16, v252
  v_xor_b32 v254, 32, v252
  v_xor_b32 v255, 48, v252
  s_lshl_b32 s48, s19, 10
  s_lshl_b32 s46, s19, 12
  s_lshr_b32 s53, s15, 2
  s_and_b32 s51, s15, 3
  s_add_u32 s53, s53, s51
  s_waitcnt lgkmcnt(0)
  s_mul_i32 s40, s16, 245760
  s_add_u32 s20, s4, s40
  s_addc_u32 s21, s5, 0
  s_mov_b32 s22, 245760
  s_mov_b32 s23, 131072
  s_lshl_b32 s40, s17, 8
  s_add_u32 s24, s10, s40
  s_addc_u32 s25, s11, 0
  s_sub_u32 s26, 5242880, s40
  s_mov_b32 s27, 131072
  s_mov_b32 s50, 0
  s_add_u32 s51, s50, 0
  s_lshl_b32 s49, s51, 19
  s_lshl_b32 s51, s51, 7
  s_add_u32 s50, s50, 1
  s_cmp_ge_u32 s50, 1
  s_cselect_b32 s50, 0, s50
  s_add_u32 m0, s48, 24576
  s_nop 0
  buffer_load_dwordx4 v113, s[24:27], s49 offen lds
  s_add_u32 m0, s48, 28672
  s_add_u32 s49, s49, 131072
  buffer_load_dwordx4 v113, s[24:27], s49 offen lds
  s_add_u32 m0, s48, 32768
  s_add_u32 s49, s49, 131072
  buffer_load_dwordx4 v113, s[24:27], s49 offen lds
  s_add_u32 m0, s48, 36864
  s_add_u32 s49, s49, 131072
  buffer_load_dwordx4 v113, s[24:27], s49 offen lds
  s_add_u32 m0, s48, 0
  s_nop 0
  buffer_load_dwordx4 v112, s[20:23], s51 offen lds
  s_add_u32 m0, s48, 4096
  s_add_u32 s51, s51, 40960
  buffer_load_dwordx4 v112, s[20:23], s51 offen lds
  s_add_u32 m0, s48, 8192
  s_add_u32 s51, s51, 40960
  buffer_load_dwordx4 v112, s[20:23], s51 offen lds
  s_add_u32 m0, s48, 12288
  s_add_u32 s51, s51, 40960
  buffer_load_dwordx4 v112, s[20:23], s51 offen lds
  s_add_u32 m0, s48, 16384
  s_add_u32 s51, s51, 40960
  buffer_load_dwordx4 v112, s[20:23], s51 offen lds
  s_add_u32 m0, s48, 20480
  s_add_u32 s51, s51, 40960
  buffer_load_dwordx4 v112, s[20:23], s51 offen lds
  s_lshl_b32 s41, s16, 5
  s_add_u32 s41, s41, s17
  s_lshl_b32 s41, s41, 17
  s_add_u32 s28, s6, s41
  s_addc_u32 s29, s7, 0
  s_mov_b32 s30, 131072
  s_mov_b32 s31, 131072
  s_add_u32 s32, s8, s41
  s_addc_u32 s33, s9, 0
  s_mov_b32 s34, 131072
  s_mov_b32 s35, 131072
  s_mul_i32 s41, s17, 1536
  s_mul_i32 s40, s16, 192
  s_add_u32 s41, s41, s40
  s_lshl_b32 s41, s41, 8
  s_add_u32 s41, s41, 0
  s_add_u32 s36, s12, s41
  s_addc_u32 s37, s13, 0
  s_mov_b32 s38, 49152
  s_mov_b32 s39, 131072
  s_mov_b32 s42, 1040356334
  v_bfe_u32 v5, v1, 2, 2
  v_and_b32 v6, 3, v1
  v_lshrrev_b32 v7, 5, v1
  v_and_b32 v8, 31, v1
  v_lshrrev_b32 v10, 1, v2
  v_mul_u32_u24 v11, 96, v10
  v_add_u32 v11, v11, v8
  v_bfe_u32 v12, v11, 1, 3
  v_xor_b32 v12, v12, v7
  v_lshlrev_b32 v12, 4, v12
  v_lshl_add_u32 v114, v11, 7, v12
  v_xor_b32 v115, 32, v114
  v_xor_b32 v116, 64, v114
  v_xor_b32 v117, 96, v114
  v_lshl_add_u32 v11, v7, 3, v5
  v_lshlrev_b32 v11, 8, v11
  v_and_b32 v12, 1, v4
  v_and_b32 v13, 1, v6
  v_lshl_add_u32 v12, v12, 1, v13
  v_lshl_add_u32 v12, v9, 3, v12
  v_lshlrev_b32 v13, 2, v5
  v_xor_b32 v12, v12, v13
  v_lshl_add_u32 v11, v12, 4, v11
  v_lshrrev_b32 v13, 1, v6
  v_lshl_add_u32 v11, v13, 3, v11
  v_add_u32 v122, 24576, v11
  v_xor_b32 v123, 64, v122
  v_add_u32 v118, 81920, v114
  v_add_u32 v119, 81920, v115
  v_add_u32 v120, 81920, v116
  v_add_u32 v121, 81920, v117
  v_add_u32 v124, 81920, v122
  v_add_u32 v125, 81920, v123
  v_lshlrev_b32 v11, 2, v6
  v_or_b32 v11, v11, v5
  v_xor_b32 v11, v11, v7
  v_lshlrev_b32 v11, 4, v11
  v_lshl_add_u32 v12, v9, 5, v8
  v_lshl_add_u32 v224, v12, 8, v11
  v_xor_b32 v225, 32, v224
  v_xor_b32 v226, 64, v224
  v_xor_b32 v227, 96, v224
  v_xor_b32 v228, 128, v224
  v_xor_b32 v229, 160, v224
  v_xor_b32 v230, 192, v224
  v_xor_b32 v231, 224, v224
  v_add_u32 v232, 131072, v224
  v_add_u32 v233, 131072, v225
  v_add_u32 v234, 131072, v226
  v_add_u32 v235, 131072, v227
  v_add_u32 v236, 131072, v228
  v_add_u32 v237, 131072, v229
  v_add_u32 v238, 131072, v230
  v_add_u32 v239, 131072, v231
  v_lshl_add_u32 v11, v7, 2, v5
  v_lshl_add_u32 v11, v9, 5, v11
  v_lshlrev_b32 v11, 8, v11
  v_and_b32 v12, 1, v4
  v_lshrrev_b32 v13, 1, v6
  v_lshl_add_u32 v12, v12, 1, v13
  v_xor_b32 v12, v12, v7
  v_lshl_add_u32 v12, v5, 2, v12
  v_lshl_add_u32 v11, v12, 4, v11
  v_and_b32 v13, 1, v6
  v_lshl_add_u32 v0, v13, 3, v11
  v_add_u32 v0, 65536, v0
  v_lshlrev_b32 v11, 7, v9
  v_xor_b32 v0, v0, v11
  s_mov_b32 s50, s53
  s_cmp_ge_u32 s50, 4
  s_cselect_b32 s51, 4, 0
  s_sub_u32 s50, s50, s51
  s_cmp_ge_u32 s50, 4
  s_cselect_b32 s51, 4, 0
  s_sub_u32 s50, s50, s51
  s_add_u32 s51, s50, 1
  s_lshl_b32 s49, s51, 19
  s_lshl_b32 s51, s51, 7
  s_add_u32 s50, s50, 1
  s_cmp_ge_u32 s50, 4
  s_cselect_b32 s50, 0, s50
  s_add_u32 m0, s48, 65536
  s_nop 0
  buffer_load_dwordx4 v113, s[24:27], s49 offen lds
  s_add_u32 m0, s48, 69632
  s_add_u32 s49, s49, 131072
  buffer_load_dwordx4 v113, s[24:27], s49 offen lds
  s_add_u32 m0, s48, 73728
  s_add_u32 s49, s49, 131072
  buffer_load_dwordx4 v113, s[24:27], s49 offen lds
  s_add_u32 m0, s48, 77824
  s_add_u32 s49, s49, 131072
  buffer_load_dwordx4 v113, s[24:27], s49 offen lds
  s_waitcnt vmcnt(4)
  s_barrier
  ds_read_b64_tr_b16 a[0:1], v122
  ds_read_b64_tr_b16 a[2:3], v122 offset:1024
  ds_read_b64_tr_b16 a[4:5], v123
  ds_read_b64_tr_b16 a[6:7], v123 offset:1024
  ds_read_b128 a[8:11], v114
  ds_read_b128 a[12:15], v114 offset:4096
  ds_read_b128 a[16:19], v114 offset:8192
  ds_read_b64_tr_b16 a[20:21], v122 offset:4096
  ds_read_b64_tr_b16 a[22:23], v122 offset:5120
  ds_read_b64_tr_b16 a[24:25], v123 offset:4096
  ds_read_b64_tr_b16 a[26:27], v123 offset:5120
  ds_read_b128 a[28:31], v115
  ds_read_b128 a[32:35], v115 offset:4096
  ds_read_b128 a[36:39], v115 offset:8192
  s_waitcnt lgkmcnt(7)
  v_mfma_f32_32x32x16_bf16 v[16:31], a[0:3], a[8:11], 0
  ds_read_b64_tr_b16 a[40:41], v122 offset:8192
  ds_read_b64_tr_b16 a[42:43], v122 offset:9216
  ds_read_b64_tr_b16 a[44:45], v123 offset:8192
  ds_read_b64_tr_b16 a[46:47], v123 offset:9216
  ds_read_b128 a[48:51], v116
  ds_read_b128 a[52:55], v116 offset:4096
  ds_read_b128 a[56:59], v116 offset:8192
  v_mfma_f32_32x32x16_bf16 v[48:63], a[0:3], a[12:15], 0
  s_add_u32 m0, s48, 40960
  s_nop 0
  buffer_load_dwordx4 v112, s[20:23], s51 offen lds
  v_mfma_f32_32x32x16_bf16 v[80:95], a[0:3], a[16:19], 0
  s_add_u32 m0, s48, 45056
  s_add_u32 s51, s51, 40960
  buffer_load_dwordx4 v112, s[20:23], s51 offen lds
  s_add_u32 m0, s48, 49152
  s_add_u32 s51, s51, 40960
  buffer_load_dwordx4 v112, s[20:23], s51 offen lds
  v_mfma_f32_32x32x16_bf16 v[32:47], a[4:7], a[8:11], 0
  s_add_u32 m0, s48, 53248
  s_add_u32 s51, s51, 40960
  buffer_load_dwordx4 v112, s[20:23], s51 offen lds
  s_add_u32 m0, s48, 57344
  s_add_u32 s51, s51, 40960
  buffer_load_dwordx4 v112, s[20:23], s51 offen lds
  v_mfma_f32_32x32x16_bf16 v[64:79], a[4:7], a[12:15], 0
  s_add_u32 m0, s48, 61440
  s_add_u32 s51, s51, 40960
  buffer_load_dwordx4 v112, s[20:23], s51 offen lds
  s_add_u32 s51, s50, 1
  s_lshl_b32 s49, s51, 19
  s_lshl_b32 s51, s51, 7
  s_add_u32 s50, s50, 1
  s_cmp_ge_u32 s50, 4
  s_cselect_b32 s50, 0, s50
  s_add_u32 m0, s48, 106496
  s_nop 0
  buffer_load_dwordx4 v113, s[24:27], s49 offen lds
  v_mfma_f32_32x32x16_bf16 v[96:111], a[4:7], a[16:19], 0
  s_add_u32 m0, s48, 110592
  s_add_u32 s49, s49, 131072
  buffer_load_dwordx4 v113, s[24:27], s49 offen lds
  s_waitcnt lgkmcnt(7)
  v_mfma_f32_32x32x16_bf16 v[16:31], a[20:23], a[28:31], v[16:31]
  ds_read_b64_tr_b16 a[60:61], v122 offset:12288
  ds_read_b64_tr_b16 a[62:63], v122 offset:13312
  ds_read_b64_tr_b16 a[64:65], v123 offset:12288
  ds_read_b64_tr_b16 a[66:67], v123 offset:13312
  ds_read_b128 a[68:71], v117
  ds_read_b128 a[72:75], v117 offset:4096
  ds_read_b128 a[76:79], v117 offset:8192
  v_mfma_f32_32x32x16_bf16 v[48:63], a[20:23], a[32:35], v[48:63]
  s_add_u32 m0, s48, 114688
  s_add_u32 s49, s49, 131072
  buffer_load_dwordx4 v113, s[24:27], s49 offen lds
  v_mfma_f32_32x32x16_bf16 v[80:95], a[20:23], a[36:39], v[80:95]
  s_add_u32 m0, s48, 118784
  s_add_u32 s49, s49, 131072
  buffer_load_dwordx4 v113, s[24:27], s49 offen lds
  s_add_u32 m0, s48, 81920
  s_nop 0
  buffer_load_dwordx4 v112, s[20:23], s51 offen lds
  v_mfma_f32_32x32x16_bf16 v[32:47], a[24:27], a[28:31], v[32:47]
  s_add_u32 m0, s48, 86016
  s_add_u32 s51, s51, 40960
  buffer_load_dwordx4 v112, s[20:23], s51 offen lds
  s_add_u32 m0, s48, 90112
  s_add_u32 s51, s51, 40960
  buffer_load_dwordx4 v112, s[20:23], s51 offen lds
  v_mfma_f32_32x32x16_bf16 v[64:79], a[24:27], a[32:35], v[64:79]
  s_add_u32 m0, s48, 94208
  s_add_u32 s51, s51, 40960
  buffer_load_dwordx4 v112, s[20:23], s51 offen lds
  v_mfma_f32_32x32x16_bf16 v[96:111], a[24:27], a[36:39], v[96:111]
  s_add_u32 m0, s48, 98304
  s_add_u32 s51, s51, 40960
  buffer_load_dwordx4 v112, s[20:23], s51 offen lds
  s_add_u32 m0, s48, 102400
  s_add_u32 s51, s51, 40960
  buffer_load_dwordx4 v112, s[20:23], s51 offen lds
  s_waitcnt vmcnt(10)
  s_waitcnt lgkmcnt(0)
  s_barrier
  v_mfma_f32_32x32x16_bf16 v[16:31], a[40:43], a[48:51], v[16:31]
  ds_read_b64_tr_b16 a[0:1], v122 offset:40960
  ds_read_b64_tr_b16 a[2:3], v122 offset:41984
  ds_read_b64_tr_b16 a[4:5], v123 offset:40960
  ds_read_b64_tr_b16 a[6:7], v123 offset:41984
  v_mfma_f32_32x32x16_bf16 v[48:63], a[40:43], a[52:55], v[48:63]
  ds_read_b128 a[8:11], v114 offset:40960
  ds_read_b128 a[12:15], v114 offset:45056
  ds_read_b128 a[16:19], v114 offset:49152
  v_mfma_f32_32x32x16_bf16 v[80:95], a[40:43], a[56:59], v[80:95]
  v_mfma_f32_32x32x16_bf16 v[32:47], a[44:47], a[48:51], v[32:47]
  s_add_u32 s51, s50, 1
  s_lshl_b32 s49, s51, 19
  s_lshl_b32 s51, s51, 7
  s_add_u32 s50, s50, 1
  s_cmp_ge_u32 s50, 4
  s_cselect_b32 s50, 0, s50
  s_add_u32 m0, s48, 24576
  s_nop 0
  buffer_load_dwordx4 v113, s[24:27], s49 offen lds
  v_mfma_f32_32x32x16_bf16 v[64:79], a[44:47], a[52:55], v[64:79]
  s_add_u32 m0, s48, 28672
  s_add_u32 s49, s49, 131072
  buffer_load_dwordx4 v113, s[24:27], s49 offen lds
  v_mfma_f32_32x32x16_bf16 v[96:111], a[44:47], a[56:59], v[96:111]
  s_add_u32 m0, s48, 32768
  s_add_u32 s49, s49, 131072
  buffer_load_dwordx4 v113, s[24:27], s49 offen lds
  s_waitcnt lgkmcnt(7)
  v_mfma_f32_32x32x16_bf16 v[16:31], a[60:63], a[68:71], v[16:31]
  ds_read_b64_tr_b16 a[20:21], v122 offset:45056
  ds_read_b64_tr_b16 a[22:23], v122 offset:46080
  ds_read_b64_tr_b16 a[24:25], v123 offset:45056
  ds_read_b64_tr_b16 a[26:27], v123 offset:46080
  v_mfma_f32_32x32x16_bf16 v[48:63], a[60:63], a[72:75], v[48:63]
  ds_read_b128 a[28:31], v115 offset:40960
  ds_read_b128 a[32:35], v115 offset:45056
  ds_read_b128 a[36:39], v115 offset:49152
  v_mfma_f32_32x32x16_bf16 v[80:95], a[60:63], a[76:79], v[80:95]
  v_mfma_f32_32x32x16_bf16 v[32:47], a[64:67], a[68:71], v[32:47]
  s_add_u32 m0, s48, 36864
  s_add_u32 s49, s49, 131072
  buffer_load_dwordx4 v113, s[24:27], s49 offen lds
  v_mfma_f32_32x32x16_bf16 v[64:79], a[64:67], a[72:75], v[64:79]
  s_add_u32 m0, s48, 0
  s_nop 0
  buffer_load_dwordx4 v112, s[20:23], s51 offen lds
  v_mfma_f32_32x32x16_bf16 v[96:111], a[64:67], a[76:79], v[96:111]
  s_add_u32 m0, s48, 4096
  s_add_u32 s51, s51, 40960
  buffer_load_dwordx4 v112, s[20:23], s51 offen lds
  s_waitcnt lgkmcnt(7)
  v_mfma_f32_32x32x16_bf16 v[16:31], a[0:3], a[8:11], v[16:31]
  ds_read_b64_tr_b16 a[40:41], v122 offset:49152
  ds_read_b64_tr_b16 a[42:43], v122 offset:50176
  ds_read_b64_tr_b16 a[44:45], v123 offset:49152
  ds_read_b64_tr_b16 a[46:47], v123 offset:50176
  v_mfma_f32_32x32x16_bf16 v[48:63], a[0:3], a[12:15], v[48:63]
  ds_read_b128 a[48:51], v116 offset:40960
  ds_read_b128 a[52:55], v116 offset:45056
  ds_read_b128 a[56:59], v116 offset:49152
  v_mfma_f32_32x32x16_bf16 v[80:95], a[0:3], a[16:19], v[80:95]
  v_mfma_f32_32x32x16_bf16 v[32:47], a[4:7], a[8:11], v[32:47]
  s_add_u32 m0, s48, 8192
  s_add_u32 s51, s51, 40960
  buffer_load_dwordx4 v112, s[20:23], s51 offen lds
  v_mfma_f32_32x32x16_bf16 v[64:79], a[4:7], a[12:15], v[64:79]
  s_add_u32 m0, s48, 12288
  s_add_u32 s51, s51, 40960
  buffer_load_dwordx4 v112, s[20:23], s51 offen lds
  v_mfma_f32_32x32x16_bf16 v[96:111], a[4:7], a[16:19], v[96:111]
  s_add_u32 m0, s48, 16384
  s_add_u32 s51, s51, 40960
  buffer_load_dwordx4 v112, s[20:23], s51 offen lds
  s_waitcnt lgkmcnt(7)
  v_mfma_f32_32x32x16_bf16 v[16:31], a[20:23], a[28:31], v[16:31]
  v_mfma_f32_32x32x16_bf16 v[48:63], a[20:23], a[32:35], v[48:63]
  ds_read_b64_tr_b16 a[60:61], v122 offset:53248
  ds_read_b64_tr_b16 a[62:63], v122 offset:54272
  ds_read_b64_tr_b16 a[64:65], v123 offset:53248
  ds_read_b64_tr_b16 a[66:67], v123 offset:54272
  v_mfma_f32_32x32x16_bf16 v[80:95], a[20:23], a[36:39], v[80:95]
  v_mfma_f32_32x32x16_bf16 v[32:47], a[24:27], a[28:31], v[32:47]
  ds_read_b128 a[68:71], v117 offset:40960
  ds_read_b128 a[72:75], v117 offset:45056
  ds_read_b128 a[76:79], v117 offset:49152
  v_mfma_f32_32x32x16_bf16 v[64:79], a[24:27], a[32:35], v[64:79]
  v_mfma_f32_32x32x16_bf16 v[96:111], a[24:27], a[36:39], v[96:111]
  s_add_u32 m0, s48, 20480
  s_add_u32 s51, s51, 40960
  buffer_load_dwordx4 v112, s[20:23], s51 offen lds
  s_waitcnt vmcnt(10)
  s_waitcnt lgkmcnt(0)
  s_barrier
  v_mfma_f32_32x32x16_bf16 v[16:31], a[40:43], a[48:51], v[16:31]
  ds_read_b64_tr_b16 a[0:1], v124
  ds_read_b64_tr_b16 a[2:3], v124 offset:1024
  ds_read_b64_tr_b16 a[4:5], v125
  ds_read_b64_tr_b16 a[6:7], v125 offset:1024
  v_mfma_f32_32x32x16_bf16 v[48:63], a[40:43], a[52:55], v[48:63]
  ds_read_b128 a[8:11], v118
  ds_read_b128 a[12:15], v118 offset:4096
  ds_read_b128 a[16:19], v118 offset:8192
  v_mfma_f32_32x32x16_bf16 v[80:95], a[40:43], a[56:59], v[80:95]
  v_mfma_f32_32x32x16_bf16 v[32:47], a[44:47], a[48:51], v[32:47]
  s_add_u32 s51, s50, 1
  s_lshl_b32 s49, s51, 19
  s_lshl_b32 s51, s51, 7
  s_add_u32 s50, s50, 1
  s_cmp_ge_u32 s50, 4
  s_cselect_b32 s50, 0, s50
  s_add_u32 m0, s48, 65536
  s_nop 0
  buffer_load_dwordx4 v113, s[24:27], s49 offen lds
  v_mfma_f32_32x32x16_bf16 v[64:79], a[44:47], a[52:55], v[64:79]
  s_add_u32 m0, s48, 69632
  s_add_u32 s49, s49, 131072
  buffer_load_dwordx4 v113, s[24:27], s49 offen lds
  v_mfma_f32_32x32x16_bf16 v[96:111], a[44:47], a[56:59], v[96:111]
  s_add_u32 m0, s48, 73728
  s_add_u32 s49, s49, 131072
  buffer_load_dwordx4 v113, s[24:27], s49 offen lds
  s_waitcnt lgkmcnt(7)
  v_mfma_f32_32x32x16_bf16 v[16:31], a[60:63], a[68:71], v[16:31]
  ds_read_b64_tr_b16 a[20:21], v124 offset:4096
  ds_read_b64_tr_b16 a[22:23], v124 offset:5120
  ds_read_b64_tr_b16 a[24:25], v125 offset:4096
  ds_read_b64_tr_b16 a[26:27], v125 offset:5120
  v_mfma_f32_32x32x16_bf16 v[48:63], a[60:63], a[72:75], v[48:63]
  ds_read_b128 a[28:31], v119
  ds_read_b128 a[32:35], v119 offset:4096
  ds_read_b128 a[36:39], v119 offset:8192
  v_mfma_f32_32x32x16_bf16 v[80:95], a[60:63], a[76:79], v[80:95]
  v_mfma_f32_32x32x16_bf16 v[32:47], a[64:67], a[68:71], v[32:47]
  s_add_u32 m0, s48, 77824
  s_add_u32 s49, s49, 131072
  buffer_load_dwordx4 v113, s[24:27], s49 offen lds
  v_mfma_f32_32x32x16_bf16 v[64:79], a[64:67], a[72:75], v[64:79]
  s_add_u32 m0, s48, 40960
  s_nop 0
  buffer_load_dwordx4 v112, s[20:23], s51 offen lds
  v_mfma_f32_32x32x16_bf16 v[96:111], a[64:67], a[76:79], v[96:111]
  s_add_u32 m0, s48, 45056
  s_add_u32 s51, s51, 40960
  buffer_load_dwordx4 v112, s[20:23], s51 offen lds
  s_waitcnt lgkmcnt(7)
  v_mfma_f32_32x32x16_bf16 v[16:31], a[0:3], a[8:11], v[16:31]
  ds_read_b64_tr_b16 a[40:41], v124 offset:8192
  ds_read_b64_tr_b16 a[42:43], v124 offset:9216
  ds_read_b64_tr_b16 a[44:45], v125 offset:8192
  ds_read_b64_tr_b16 a[46:47], v125 offset:9216
  v_mfma_f32_32x32x16_bf16 v[48:63], a[0:3], a[12:15], v[48:63]
  ds_read_b128 a[48:51], v120
  ds_read_b128 a[52:55], v120 offset:4096
  ds_read_b128 a[56:59], v120 offset:8192
  v_mfma_f32_32x32x16_bf16 v[80:95], a[0:3], a[16:19], v[80:95]
  v_mfma_f32_32x32x16_bf16 v[32:47], a[4:7], a[8:11], v[32:47]
  s_add_u32 m0, s48, 49152
  s_add_u32 s51, s51, 40960
  buffer_load_dwordx4 v112, s[20:23], s51 offen lds
  v_mfma_f32_32x32x16_bf16 v[64:79], a[4:7], a[12:15], v[64:79]
  s_add_u32 m0, s48, 53248
  s_add_u32 s51, s51, 40960
  buffer_load_dwordx4 v112, s[20:23], s51 offen lds
  v_mfma_f32_32x32x16_bf16 v[96:111], a[4:7], a[16:19], v[96:111]
  s_add_u32 m0, s48, 57344
  s_add_u32 s51, s51, 40960
  buffer_load_dwordx4 v112, s[20:23], s51 offen lds
  s_waitcnt lgkmcnt(7)
  v_mfma_f32_32x32x16_bf16 v[16:31], a[20:23], a[28:31], v[16:31]
  v_mfma_f32_32x32x16_bf16 v[48:63], a[20:23], a[32:35], v[48:63]
  ds_read_b64_tr_b16 a[60:61], v124 offset:12288
  ds_read_b64_tr_b16 a[62:63], v124 offset:13312
  ds_read_b64_tr_b16 a[64:65], v125 offset:12288
  ds_read_b64_tr_b16 a[66:67], v125 offset:13312
  v_mfma_f32_32x32x16_bf16 v[80:95], a[20:23], a[36:39], v[80:95]
  v_mfma_f32_32x32x16_bf16 v[32:47], a[24:27], a[28:31], v[32:47]
  ds_read_b128 a[68:71], v121
  ds_read_b128 a[72:75], v121 offset:4096
  ds_read_b128 a[76:79], v121 offset:8192
  v_mfma_f32_32x32x16_bf16 v[64:79], a[24:27], a[32:35], v[64:79]
  v_mfma_f32_32x32x16_bf16 v[96:111], a[24:27], a[36:39], v[96:111]
  s_add_u32 m0, s48, 61440
  s_add_u32 s51, s51, 40960
  buffer_load_dwordx4 v112, s[20:23], s51 offen lds
  s_waitcnt vmcnt(10)
  s_waitcnt lgkmcnt(0)
  s_barrier
  v_mfma_f32_32x32x16_bf16 v[16:31], a[40:43], a[48:51], v[16:31]
  ds_read_b64_tr_b16 a[0:1], v122
  ds_read_b64_tr_b16 a[2:3], v122 offset:1024
  ds_read_b64_tr_b16 a[4:5], v123
  ds_read_b64_tr_b16 a[6:7], v123 offset:1024
  v_mfma_f32_32x32x16_bf16 v[48:63], a[40:43], a[52:55], v[48:63]
  ds_read_b128 a[8:11], v114
  ds_read_b128 a[12:15], v114 offset:4096
  ds_read_b128 a[16:19], v114 offset:8192
  v_mfma_f32_32x32x16_bf16 v[80:95], a[40:43], a[56:59], v[80:95]
  v_mfma_f32_32x32x16_bf16 v[32:47], a[44:47], a[48:51], v[32:47]
  s_mov_b32 s50, s53
  s_cmp_ge_u32 s50, 5
  s_cselect_b32 s51, 5, 0
  s_sub_u32 s50, s50, s51
  s_cmp_ge_u32 s50, 5
  s_cselect_b32 s51, 5, 0
  s_sub_u32 s50, s50, s51
  s_add_u32 s51, s50, 5
  s_lshl_b32 s49, s51, 19
  s_lshl_b32 s51, s51, 7
  s_add_u32 s50, s50, 1
  s_cmp_ge_u32 s50, 5
  s_cselect_b32 s50, 0, s50
  s_add_u32 m0, s48, 106496
  s_nop 0
  buffer_load_dwordx4 v113, s[24:27], s49 offen lds
  v_mfma_f32_32x32x16_bf16 v[64:79], a[44:47], a[52:55], v[64:79]
  s_add_u32 m0, s48, 110592
  s_add_u32 s49, s49, 131072
  buffer_load_dwordx4 v113, s[24:27], s49 offen lds
  v_mfma_f32_32x32x16_bf16 v[96:111], a[44:47], a[56:59], v[96:111]
  s_add_u32 m0, s48, 114688
  s_add_u32 s49, s49, 131072
  buffer_load_dwordx4 v113, s[24:27], s49 offen lds
  s_waitcnt lgkmcnt(7)
  v_mfma_f32_32x32x16_bf16 v[16:31], a[60:63], a[68:71], v[16:31]
  ds_read_b64_tr_b16 a[20:21], v122 offset:4096
  ds_read_b64_tr_b16 a[22:23], v122 offset:5120
  ds_read_b64_tr_b16 a[24:25], v123 offset:4096
  ds_read_b64_tr_b16 a[26:27], v123 offset:5120
  v_mfma_f32_32x32x16_bf16 v[48:63], a[60:63], a[72:75], v[48:63]
  ds_read_b128 a[28:31], v115
  ds_read_b128 a[32:35], v115 offset:4096
  ds_read_b128 a[36:39], v115 offset:8192
  v_mfma_f32_32x32x16_bf16 v[80:95], a[60:63], a[76:79], v[80:95]
  v_mfma_f32_32x32x16_bf16 v[32:47], a[64:67], a[68:71], v[32:47]
  s_add_u32 m0, s48, 118784
  s_add_u32 s49, s49, 131072
  buffer_load_dwordx4 v113, s[24:27], s49 offen lds
  v_mfma_f32_32x32x16_bf16 v[64:79], a[64:67], a[72:75], v[64:79]
  s_add_u32 m0, s48, 81920
  s_nop 0
  buffer_load_dwordx4 v112, s[20:23], s51 offen lds
  v_mfma_f32_32x32x16_bf16 v[96:111], a[64:67], a[76:79], v[96:111]
  s_add_u32 m0, s48, 86016
  s_add_u32 s51, s51, 40960
  buffer_load_dwordx4 v112, s[20:23], s51 offen lds
  s_waitcnt lgkmcnt(7)
  v_mfma_f32_32x32x16_bf16 v[16:31], a[0:3], a[8:11], v[16:31]
  ds_read_b64_tr_b16 a[40:41], v122 offset:8192
  ds_read_b64_tr_b16 a[42:43], v122 offset:9216
  ds_read_b64_tr_b16 a[44:45], v123 offset:8192
  ds_read_b64_tr_b16 a[46:47], v123 offset:9216
  v_mfma_f32_32x32x16_bf16 v[48:63], a[0:3], a[12:15], v[48:63]
  ds_read_b128 a[48:51], v116
  ds_read_b128 a[52:55], v116 offset:4096
  ds_read_b128 a[56:59], v116 offset:8192
  v_mfma_f32_32x32x16_bf16 v[80:95], a[0:3], a[16:19], v[80:95]
  v_mfma_f32_32x32x16_bf16 v[32:47], a[4:7], a[8:11], v[32:47]
  s_add_u32 m0, s48, 90112
  s_add_u32 s51, s51, 40960
  buffer_load_dwordx4 v112, s[20:23], s51 offen lds
  v_mfma_f32_32x32x16_bf16 v[64:79], a[4:7], a[12:15], v[64:79]
  s_add_u32 m0, s48, 94208
  s_add_u32 s51, s51, 40960
  buffer_load_dwordx4 v112, s[20:23], s51 offen lds
  v_mfma_f32_32x32x16_bf16 v[96:111], a[4:7], a[16:19], v[96:111]
  s_add_u32 m0, s48, 98304
  s_add_u32 s51, s51, 40960
  buffer_load_dwordx4 v112, s[20:23], s51 offen lds
  s_waitcnt lgkmcnt(7)
  v_mfma_f32_32x32x16_bf16 v[16:31], a[20:23], a[28:31], v[16:31]
  v_mfma_f32_32x32x16_bf16 v[48:63], a[20:23], a[32:35], v[48:63]
  ds_read_b64_tr_b16 a[60:61], v122 offset:12288
  ds_read_b64_tr_b16 a[62:63], v122 offset:13312
  ds_read_b64_tr_b16 a[64:65], v123 offset:12288
  ds_read_b64_tr_b16 a[66:67], v123 offset:13312
  v_mfma_f32_32x32x16_bf16 v[80:95], a[20:23], a[36:39], v[80:95]
  v_mfma_f32_32x32x16_bf16 v[32:47], a[24:27], a[28:31], v[32:47]
  ds_read_b128 a[68:71], v117
  ds_read_b128 a[72:75], v117 offset:4096
  ds_read_b128 a[76:79], v117 offset:8192
  v_mfma_f32_32x32x16_bf16 v[64:79], a[24:27], a[32:35], v[64:79]
  v_mfma_f32_32x32x16_bf16 v[96:111], a[24:27], a[36:39], v[96:111]
  s_add_u32 m0, s48, 102400
  s_add_u32 s51, s51, 40960
  buffer_load_dwordx4 v112, s[20:23], s51 offen lds
  s_waitcnt vmcnt(10)
  s_waitcnt lgkmcnt(0)
  s_barrier
  v_mfma_f32_32x32x16_bf16 v[16:31], a[40:43], a[48:51], v[16:31]
  ds_read_b64_tr_b16 a[0:1], v122 offset:40960
  ds_read_b64_tr_b16 a[2:3], v122 offset:41984
  ds_read_b64_tr_b16 a[4:5], v123 offset:40960
  ds_read_b64_tr_b16 a[6:7], v123 offset:41984
  v_mfma_f32_32x32x16_bf16 v[48:63], a[40:43], a[52:55], v[48:63]
  ds_read_b128 a[8:11], v114 offset:40960
  ds_read_b128 a[12:15], v114 offset:45056
  ds_read_b128 a[16:19], v114 offset:49152
  v_mfma_f32_32x32x16_bf16 v[80:95], a[40:43], a[56:59], v[80:95]
  v_mfma_f32_32x32x16_bf16 v[32:47], a[44:47], a[48:51], v[32:47]
  s_add_u32 s51, s50, 5
  s_lshl_b32 s49, s51, 19
  s_lshl_b32 s51, s51, 7
  s_add_u32 s50, s50, 1
  s_cmp_ge_u32 s50, 5
  s_cselect_b32 s50, 0, s50
  s_add_u32 m0, s48, 24576
  s_nop 0
  buffer_load_dwordx4 v113, s[24:27], s49 offen lds
  v_mfma_f32_32x32x16_bf16 v[64:79], a[44:47], a[52:55], v[64:79]
  s_add_u32 m0, s48, 28672
  s_add_u32 s49, s49, 131072
  buffer_load_dwordx4 v113, s[24:27], s49 offen lds
  v_mfma_f32_32x32x16_bf16 v[96:111], a[44:47], a[56:59], v[96:111]
  s_add_u32 m0, s48, 32768
  s_add_u32 s49, s49, 131072
  buffer_load_dwordx4 v113, s[24:27], s49 offen lds
  s_waitcnt lgkmcnt(7)
  v_mfma_f32_32x32x16_bf16 v[16:31], a[60:63], a[68:71], v[16:31]
  ds_read_b64_tr_b16 a[20:21], v122 offset:45056
  ds_read_b64_tr_b16 a[22:23], v122 offset:46080
  ds_read_b64_tr_b16 a[24:25], v123 offset:45056
  ds_read_b64_tr_b16 a[26:27], v123 offset:46080
  v_mfma_f32_32x32x16_bf16 v[48:63], a[60:63], a[72:75], v[48:63]
  ds_read_b128 a[28:31], v115 offset:40960
  ds_read_b128 a[32:35], v115 offset:45056
  ds_read_b128 a[36:39], v115 offset:49152
  v_mfma_f32_32x32x16_bf16 v[80:95], a[60:63], a[76:79], v[80:95]
  v_mfma_f32_32x32x16_bf16 v[32:47], a[64:67], a[68:71], v[32:47]
  s_add_u32 m0, s48, 36864
  s_add_u32 s49, s49, 131072
  buffer_load_dwordx4 v113, s[24:27], s49 offen lds
  v_mfma_f32_32x32x16_bf16 v[64:79], a[64:67], a[72:75], v[64:79]
  s_add_u32 m0, s48, 0
  s_nop 0
  buffer_load_dwordx4 v112, s[20:23], s51 offen lds
  v_mfma_f32_32x32x16_bf16 v[96:111], a[64:67], a[76:79], v[96:111]
  s_add_u32 m0, s48, 4096
  s_add_u32 s51, s51, 40960
  buffer_load_dwordx4 v112, s[20:23], s51 offen lds
  s_waitcnt lgkmcnt(7)
  v_mfma_f32_32x32x16_bf16 v[16:31], a[0:3], a[8:11], v[16:31]
  ds_read_b64_tr_b16 a[40:41], v122 offset:49152
  ds_read_b64_tr_b16 a[42:43], v122 offset:50176
  ds_read_b64_tr_b16 a[44:45], v123 offset:49152
  ds_read_b64_tr_b16 a[46:47], v123 offset:50176
  v_mfma_f32_32x32x16_bf16 v[48:63], a[0:3], a[12:15], v[48:63]
  ds_read_b128 a[48:51], v116 offset:40960
  ds_read_b128 a[52:55], v116 offset:45056
  ds_read_b128 a[56:59], v116 offset:49152
  v_mfma_f32_32x32x16_bf16 v[80:95], a[0:3], a[16:19], v[80:95]
  v_mfma_f32_32x32x16_bf16 v[32:47], a[4:7], a[8:11], v[32:47]
  s_add_u32 m0, s48, 8192
  s_add_u32 s51, s51, 40960
  buffer_load_dwordx4 v112, s[20:23], s51 offen lds
  v_mfma_f32_32x32x16_bf16 v[64:79], a[4:7], a[12:15], v[64:79]
  s_add_u32 m0, s48, 12288
  s_add_u32 s51, s51, 40960
  buffer_load_dwordx4 v112, s[20:23], s51 offen lds
  v_mfma_f32_32x32x16_bf16 v[96:111], a[4:7], a[16:19], v[96:111]
  s_add_u32 m0, s48, 16384
  s_add_u32 s51, s51, 40960
  buffer_load_dwordx4 v112, s[20:23], s51 offen lds
  s_waitcnt lgkmcnt(7)
  v_mfma_f32_32x32x16_bf16 v[16:31], a[20:23], a[28:31], v[16:31]
  v_mfma_f32_32x32x16_bf16 v[48:63], a[20:23], a[32:35], v[48:63]
  ds_read_b64_tr_b16 a[60:61], v122 offset:53248
  ds_read_b64_tr_b16 a[62:63], v122 offset:54272
  ds_read_b64_tr_b16 a[64:65], v123 offset:53248
  ds_read_b64_tr_b16 a[66:67], v123 offset:54272
  v_mfma_f32_32x32x16_bf16 v[80:95], a[20:23], a[36:39], v[80:95]
  v_mfma_f32_32x32x16_bf16 v[32:47], a[24:27], a[28:31], v[32:47]
  ds_read_b128 a[68:71], v117 offset:40960
  ds_read_b128 a[72:75], v117 offset:45056
  ds_read_b128 a[76:79], v117 offset:49152
  v_mfma_f32_32x32x16_bf16 v[64:79], a[24:27], a[32:35], v[64:79]
  v_mfma_f32_32x32x16_bf16 v[96:111], a[24:27], a[36:39], v[96:111]
  s_add_u32 m0, s48, 20480
  s_add_u32 s51, s51, 40960
  buffer_load_dwordx4 v112, s[20:23], s51 offen lds
  s_waitcnt vmcnt(10)
  s_waitcnt lgkmcnt(0)
  s_barrier
  v_mfma_f32_32x32x16_bf16 v[16:31], a[40:43], a[48:51], v[16:31]
  ds_read_b64_tr_b16 a[0:1], v124
  ds_read_b64_tr_b16 a[2:3], v124 offset:1024
  ds_read_b64_tr_b16 a[4:5], v125
  ds_read_b64_tr_b16 a[6:7], v125 offset:1024
  v_mfma_f32_32x32x16_bf16 v[48:63], a[40:43], a[52:55], v[48:63]
  ds_read_b128 a[8:11], v118
  ds_read_b128 a[12:15], v118 offset:4096
  ds_read_b128 a[16:19], v118 offset:8192
  v_mfma_f32_32x32x16_bf16 v[80:95], a[40:43], a[56:59], v[80:95]
  s_add_u32 s51, s50, 5
  s_lshl_b32 s49, s51, 19
  s_lshl_b32 s51, s51, 7
  s_add_u32 s50, s50, 1
  s_cmp_ge_u32 s50, 5
  s_cselect_b32 s50, 0, s50
  s_add_u32 m0, s48, 65536
  s_nop 0
  buffer_load_dwordx4 v113, s[24:27], s49 offen lds
  v_mfma_f32_32x32x16_bf16 v[32:47], a[44:47], a[48:51], v[32:47]
  s_add_u32 m0, s48, 69632
  s_add_u32 s49, s49, 131072
  buffer_load_dwordx4 v113, s[24:27], s49 offen lds
  v_mfma_f32_32x32x16_bf16 v[64:79], a[44:47], a[52:55], v[64:79]
  s_add_u32 m0, s48, 73728
  s_add_u32 s49, s49, 131072
  buffer_load_dwordx4 v113, s[24:27], s49 offen lds
  v_mfma_f32_32x32x16_bf16 v[96:111], a[44:47], a[56:59], v[96:111]
  s_add_u32 m0, s48, 77824
  s_add_u32 s49, s49, 131072
  buffer_load_dwordx4 v113, s[24:27], s49 offen lds
  s_waitcnt lgkmcnt(7)
  v_mfma_f32_32x32x16_bf16 v[16:31], a[60:63], a[68:71], v[16:31]
  ds_read_b64_tr_b16 a[20:21], v124 offset:4096
  ds_read_b64_tr_b16 a[22:23], v124 offset:5120
  ds_read_b64_tr_b16 a[24:25], v125 offset:4096
  ds_read_b64_tr_b16 a[26:27], v125 offset:5120
  v_mfma_f32_32x32x16_bf16 v[48:63], a[60:63], a[72:75], v[48:63]
  ds_read_b128 a[28:31], v119
  ds_read_b128 a[32:35], v119 offset:4096
  ds_read_b128 a[36:39], v119 offset:8192
  v_mfma_f32_32x32x16_bf16 v[80:95], a[60:63], a[76:79], v[80:95]
  s_add_u32 m0, s48, 40960
  s_nop 0
  buffer_load_dwordx4 v112, s[20:23], s51 offen lds
  v_mfma_f32_32x32x16_bf16 v[32:47], a[64:67], a[68:71], v[32:47]
  s_add_u32 m0, s48, 45056
  s_add_u32 s51, s51, 40960
  buffer_load_dwordx4 v112, s[20:23], s51 offen lds
  v_mfma_f32_32x32x16_bf16 v[64:79], a[64:67], a[72:75], v[64:79]
  s_add_u32 m0, s48, 49152
  s_add_u32 s51, s51, 40960
  buffer_load_dwordx4 v112, s[20:23], s51 offen lds
  v_mfma_f32_32x32x16_bf16 v[96:111], a[64:67], a[76:79], v[96:111]
  s_add_u32 m0, s48, 53248
  s_add_u32 s51, s51, 40960
  buffer_load_dwordx4 v112, s[20:23], s51 offen lds
  s_waitcnt lgkmcnt(7)
  v_mfma_f32_32x32x16_bf16 v[16:31], a[0:3], a[8:11], v[16:31]
  ds_read_b64_tr_b16 a[40:41], v124 offset:8192
  ds_read_b64_tr_b16 a[42:43], v124 offset:9216
  ds_read_b64_tr_b16 a[44:45], v125 offset:8192
  ds_read_b64_tr_b16 a[46:47], v125 offset:9216
  v_mfma_f32_32x32x16_bf16 v[48:63], a[0:3], a[12:15], v[48:63]
  ds_read_b128 a[48:51], v120
  ds_read_b128 a[52:55], v120 offset:4096
  ds_read_b128 a[56:59], v120 offset:8192
  v_mfma_f32_32x32x16_bf16 v[80:95], a[0:3], a[16:19], v[80:95]
  s_add_u32 m0, s48, 57344
  s_add_u32 s51, s51, 40960
  buffer_load_dwordx4 v112, s[20:23], s51 offen lds
  v_mfma_f32_32x32x16_bf16 v[32:47], a[4:7], a[8:11], v[32:47]
  s_add_u32 m0, s48, 61440
  s_add_u32 s51, s51, 40960
  buffer_load_dwordx4 v112, s[20:23], s51 offen lds
  v_mfma_f32_32x32x16_bf16 v[64:79], a[4:7], a[12:15], v[64:79]
  s_add_u32 m0, s46, 131072
  s_add_u32 s47, s46, 0
  buffer_load_dwordx4 v252, s[28:31], s47 offen nt lds
  v_mfma_f32_32x32x16_bf16 v[96:111], a[4:7], a[16:19], v[96:111]
  s_add_u32 m0, s46, 131072
  s_add_u32 s47, s46, 0
  buffer_load_dwordx4 v253, s[28:31], s47 offen offset:1024 nt lds
  s_waitcnt lgkmcnt(7)
  v_mfma_f32_32x32x16_bf16 v[16:31], a[20:23], a[28:31], v[16:31]
  ds_read_b64_tr_b16 a[60:61], v124 offset:12288
  ds_read_b64_tr_b16 a[62:63], v124 offset:13312
  ds_read_b64_tr_b16 a[64:65], v125 offset:12288
  ds_read_b64_tr_b16 a[66:67], v125 offset:13312
  v_mfma_f32_32x32x16_bf16 v[48:63], a[20:23], a[32:35], v[48:63]
  v_mfma_f32_32x32x16_bf16 v[80:95], a[20:23], a[36:39], v[80:95]
  ds_read_b128 a[68:71], v121
  ds_read_b128 a[72:75], v121 offset:4096
  ds_read_b128 a[76:79], v121 offset:8192
  v_mfma_f32_32x32x16_bf16 v[32:47], a[24:27], a[28:31], v[32:47]
  s_add_u32 m0, s46, 131072
  s_add_u32 s47, s46, 0
  buffer_load_dwordx4 v254, s[28:31], s47 offen offset:2048 nt lds
  v_mfma_f32_32x32x16_bf16 v[64:79], a[24:27], a[32:35], v[64:79]
  v_mfma_f32_32x32x16_bf16 v[96:111], a[24:27], a[36:39], v[96:111]
  s_add_u32 m0, s46, 131072
  s_add_u32 s47, s46, 0
  buffer_load_dwordx4 v255, s[28:31], s47 offen offset:3072 nt lds
  s_waitcnt vmcnt(14)
  s_waitcnt lgkmcnt(0)
  s_barrier
  v_mfma_f32_32x32x16_bf16 v[16:31], a[40:43], a[48:51], v[16:31]
  ds_read_b64_tr_b16 a[0:1], v122
  ds_read_b64_tr_b16 a[2:3], v122 offset:1024
  ds_read_b64_tr_b16 a[4:5], v123
  ds_read_b64_tr_b16 a[6:7], v123 offset:1024
  v_mfma_f32_32x32x16_bf16 v[48:63], a[40:43], a[52:55], v[48:63]
  ds_read_b128 a[8:11], v114
  ds_read_b128 a[12:15], v114 offset:4096
  ds_read_b128 a[16:19], v114 offset:8192
  v_mfma_f32_32x32x16_bf16 v[80:95], a[40:43], a[56:59], v[80:95]
  v_mfma_f32_32x32x16_bf16 v[32:47], a[44:47], a[48:51], v[32:47]
  s_add_u32 s51, s50, 5
  s_lshl_b32 s49, s51, 19
  s_lshl_b32 s51, s51, 7
  s_add_u32 s50, s50, 1
  s_cmp_ge_u32 s50, 5
  s_cselect_b32 s50, 0, s50
  s_add_u32 m0, s48, 106496
  s_nop 0
  buffer_load_dwordx4 v113, s[24:27], s49 offen lds
  v_mfma_f32_32x32x16_bf16 v[64:79], a[44:47], a[52:55], v[64:79]
  s_add_u32 m0, s48, 110592
  s_add_u32 s49, s49, 131072
  buffer_load_dwordx4 v113, s[24:27], s49 offen lds
  v_mfma_f32_32x32x16_bf16 v[96:111], a[44:47], a[56:59], v[96:111]
  s_add_u32 m0, s48, 114688
  s_add_u32 s49, s49, 131072
  buffer_load_dwordx4 v113, s[24:27], s49 offen lds
  s_waitcnt lgkmcnt(7)
  v_mfma_f32_32x32x16_bf16 v[16:31], a[60:63], a[68:71], v[16:31]
  ds_read_b64_tr_b16 a[20:21], v122 offset:4096
  ds_read_b64_tr_b16 a[22:23], v122 offset:5120
  ds_read_b64_tr_b16 a[24:25], v123 offset:4096
  ds_read_b64_tr_b16 a[26:27], v123 offset:5120
  v_mfma_f32_32x32x16_bf16 v[48:63], a[60:63], a[72:75], v[48:63]
  ds_read_b128 a[28:31], v115
  ds_read_b128 a[32:35], v115 offset:4096
  ds_read_b128 a[36:39], v115 offset:8192
  v_mfma_f32_32x32x16_bf16 v[80:95], a[60:63], a[76:79], v[80:95]
  v_mfma_f32_32x32x16_bf16 v[32:47], a[64:67], a[68:71], v[32:47]
  s_add_u32 m0, s48, 118784
  s_add_u32 s49, s49, 131072
  buffer_load_dwordx4 v113, s[24:27], s49 offen lds
  v_mfma_f32_32x32x16_bf16 v[64:79], a[64:67], a[72:75], v[64:79]
  s_add_u32 m0, s48, 81920
  s_nop 0
  buffer_load_dwordx4 v112, s[20:23], s51 offen lds
  v_mfma_f32_32x32x16_bf16 v[96:111], a[64:67], a[76:79], v[96:111]
  s_add_u32 m0, s48, 86016
  s_add_u32 s51, s51, 40960
  buffer_load_dwordx4 v112, s[20:23], s51 offen lds
  s_waitcnt lgkmcnt(7)
  v_mfma_f32_32x32x16_bf16 v[16:31], a[0:3], a[8:11], v[16:31]
  ds_read_b64_tr_b16 a[40:41], v122 offset:8192
  ds_read_b64_tr_b16 a[42:43], v122 offset:9216
  ds_read_b64_tr_b16 a[44:45], v123 offset:8192
  ds_read_b64_tr_b16 a[46:47], v123 offset:9216
  v_mfma_f32_32x32x16_bf16 v[48:63], a[0:3], a[12:15], v[48:63]
  ds_read_b128 a[48:51], v116
  ds_read_b128 a[52:55], v116 offset:4096
  ds_read_b128 a[56:59], v116 offset:8192
  v_mfma_f32_32x32x16_bf16 v[80:95], a[0:3], a[16:19], v[80:95]
  v_mfma_f32_32x32x16_bf16 v[32:47], a[4:7], a[8:11], v[32:47]
  s_add_u32 m0, s48, 90112
  s_add_u32 s51, s51, 40960
  buffer_load_dwordx4 v112, s[20:23], s51 offen lds
  v_mfma_f32_32x32x16_bf16 v[64:79], a[4:7], a[12:15], v[64:79]
  s_add_u32 m0, s48, 94208
  s_add_u32 s51, s51, 40960
  buffer_load_dwordx4 v112, s[20:23], s51 offen lds
  v_mfma_f32_32x32x16_bf16 v[96:111], a[4:7], a[16:19], v[96:111]
  s_add_u32 m0, s48, 98304
  s_add_u32 s51, s51, 40960
  buffer_load_dwordx4 v112, s[20:23], s51 offen lds
  s_waitcnt lgkmcnt(7)
  v_mfma_f32_32x32x16_bf16 v[16:31], a[20:23], a[28:31], v[16:31]
  v_mfma_f32_32x32x16_bf16 v[48:63], a[20:23], a[32:35], v[48:63]
  ds_read_b64_tr_b16 a[60:61], v122 offset:12288
  ds_read_b64_tr_b16 a[62:63], v122 offset:13312
  ds_read_b64_tr_b16 a[64:65], v123 offset:12288
  ds_read_b64_tr_b16 a[66:67], v123 offset:13312
  v_mfma_f32_32x32x16_bf16 v[80:95], a[20:23], a[36:39], v[80:95]
  v_mfma_f32_32x32x16_bf16 v[32:47], a[24:27], a[28:31], v[32:47]
  ds_read_b128 a[68:71], v117
  ds_read_b128 a[72:75], v117 offset:4096
  ds_read_b128 a[76:79], v117 offset:8192
  v_mfma_f32_32x32x16_bf16 v[64:79], a[24:27], a[32:35], v[64:79]
  v_mfma_f32_32x32x16_bf16 v[96:111], a[24:27], a[36:39], v[96:111]
  s_add_u32 m0, s48, 102400
  s_add_u32 s51, s51, 40960
  buffer_load_dwordx4 v112, s[20:23], s51 offen lds
  s_waitcnt vmcnt(14)
  s_waitcnt lgkmcnt(0)
  s_barrier
  v_mfma_f32_32x32x16_bf16 v[16:31], a[40:43], a[48:51], v[16:31]
  ds_read_b64_tr_b16 a[0:1], v122 offset:40960
  ds_read_b64_tr_b16 a[2:3], v122 offset:41984
  ds_read_b64_tr_b16 a[4:5], v123 offset:40960
  ds_read_b64_tr_b16 a[6:7], v123 offset:41984
  v_mfma_f32_32x32x16_bf16 v[48:63], a[40:43], a[52:55], v[48:63]
  ds_read_b128 a[8:11], v114 offset:40960
  ds_read_b128 a[12:15], v114 offset:45056
  ds_read_b128 a[16:19], v114 offset:49152
  v_mfma_f32_32x32x16_bf16 v[80:95], a[40:43], a[56:59], v[80:95]
  s_add_u32 s51, s50, 5
  s_lshl_b32 s49, s51, 19
  s_lshl_b32 s51, s51, 7
  s_add_u32 s50, s50, 1
  s_cmp_ge_u32 s50, 5
  s_cselect_b32 s50, 0, s50
  s_add_u32 m0, s48, 24576
  s_nop 0
  buffer_load_dwordx4 v113, s[24:27], s49 offen lds
  v_mfma_f32_32x32x16_bf16 v[32:47], a[44:47], a[48:51], v[32:47]
  s_add_u32 m0, s48, 28672
  s_add_u32 s49, s49, 131072
  buffer_load_dwordx4 v113, s[24:27], s49 offen lds
  v_mfma_f32_32x32x16_bf16 v[64:79], a[44:47], a[52:55], v[64:79]
  s_add_u32 m0, s48, 32768
  s_add_u32 s49, s49, 131072
  buffer_load_dwordx4 v113, s[24:27], s49 offen lds
  v_mfma_f32_32x32x16_bf16 v[96:111], a[44:47], a[56:59], v[96:111]
  s_add_u32 m0, s48, 36864
  s_add_u32 s49, s49, 131072
  buffer_load_dwordx4 v113, s[24:27], s49 offen lds
  s_waitcnt lgkmcnt(7)
  v_mfma_f32_32x32x16_bf16 v[16:31], a[60:63], a[68:71], v[16:31]
  ds_read_b64_tr_b16 a[20:21], v122 offset:45056
  ds_read_b64_tr_b16 a[22:23], v122 offset:46080
  ds_read_b64_tr_b16 a[24:25], v123 offset:45056
  ds_read_b64_tr_b16 a[26:27], v123 offset:46080
  v_mfma_f32_32x32x16_bf16 v[48:63], a[60:63], a[72:75], v[48:63]
  ds_read_b128 a[28:31], v115 offset:40960
  ds_read_b128 a[32:35], v115 offset:45056
  ds_read_b128 a[36:39], v115 offset:49152
  v_mfma_f32_32x32x16_bf16 v[80:95], a[60:63], a[76:79], v[80:95]
  s_add_u32 m0, s48, 0
  s_nop 0
  buffer_load_dwordx4 v112, s[20:23], s51 offen lds
  v_mfma_f32_32x32x16_bf16 v[32:47], a[64:67], a[68:71], v[32:47]
  s_add_u32 m0, s48, 4096
  s_add_u32 s51, s51, 40960
  buffer_load_dwordx4 v112, s[20:23], s51 offen lds
  v_mfma_f32_32x32x16_bf16 v[64:79], a[64:67], a[72:75], v[64:79]
  s_add_u32 m0, s48, 8192
  s_add_u32 s51, s51, 40960
  buffer_load_dwordx4 v112, s[20:23], s51 offen lds
  v_mfma_f32_32x32x16_bf16 v[96:111], a[64:67], a[76:79], v[96:111]
  s_add_u32 m0, s48, 12288
  s_add_u32 s51, s51, 40960
  buffer_load_dwordx4 v112, s[20:23], s51 offen lds
  s_waitcnt lgkmcnt(7)
  v_mfma_f32_32x32x16_bf16 v[16:31], a[0:3], a[8:11], v[16:31]
  ds_read_b64_tr_b16 a[40:41], v122 offset:49152
  ds_read_b64_tr_b16 a[42:43], v122 offset:50176
  ds_read_b64_tr_b16 a[44:45], v123 offset:49152
  ds_read_b64_tr_b16 a[46:47], v123 offset:50176
  v_mfma_f32_32x32x16_bf16 v[48:63], a[0:3], a[12:15], v[48:63]
  ds_read_b128 a[48:51], v116 offset:40960
  ds_read_b128 a[52:55], v116 offset:45056
  ds_read_b128 a[56:59], v116 offset:49152
  v_mfma_f32_32x32x16_bf16 v[80:95], a[0:3], a[16:19], v[80:95]
  s_add_u32 m0, s48, 16384
  s_add_u32 s51, s51, 40960
  buffer_load_dwordx4 v112, s[20:23], s51 offen lds
  v_mfma_f32_32x32x16_bf16 v[32:47], a[4:7], a[8:11], v[32:47]
  s_add_u32 m0, s48, 20480
  s_add_u32 s51, s51, 40960
  buffer_load_dwordx4 v112, s[20:23], s51 offen lds
  v_mfma_f32_32x32x16_bf16 v[64:79], a[4:7], a[12:15], v[64:79]
  s_add_u32 m0, s46, 147456
  s_add_u32 s47, s46, 16384
  buffer_load_dwordx4 v252, s[28:31], s47 offen nt lds
  v_mfma_f32_32x32x16_bf16 v[96:111], a[4:7], a[16:19], v[96:111]
  s_add_u32 m0, s46, 147456
  s_add_u32 s47, s46, 16384
  buffer_load_dwordx4 v253, s[28:31], s47 offen offset:1024 nt lds
  s_waitcnt lgkmcnt(7)
  v_mfma_f32_32x32x16_bf16 v[16:31], a[20:23], a[28:31], v[16:31]
  ds_read_b64_tr_b16 a[60:61], v122 offset:53248
  ds_read_b64_tr_b16 a[62:63], v122 offset:54272
  ds_read_b64_tr_b16 a[64:65], v123 offset:53248
  ds_read_b64_tr_b16 a[66:67], v123 offset:54272
  v_mfma_f32_32x32x16_bf16 v[48:63], a[20:23], a[32:35], v[48:63]
  v_mfma_f32_32x32x16_bf16 v[80:95], a[20:23], a[36:39], v[80:95]
  ds_read_b128 a[68:71], v117 offset:40960
  ds_read_b128 a[72:75], v117 offset:45056
  ds_read_b128 a[76:79], v117 offset:49152
  v_mfma_f32_32x32x16_bf16 v[32:47], a[24:27], a[28:31], v[32:47]
  s_add_u32 m0, s46, 147456
  s_add_u32 s47, s46, 16384
  buffer_load_dwordx4 v254, s[28:31], s47 offen offset:2048 nt lds
  v_mfma_f32_32x32x16_bf16 v[64:79], a[24:27], a[32:35], v[64:79]
  v_mfma_f32_32x32x16_bf16 v[96:111], a[24:27], a[36:39], v[96:111]
  s_add_u32 m0, s46, 147456
  s_add_u32 s47, s46, 16384
  buffer_load_dwordx4 v255, s[28:31], s47 offen offset:3072 nt lds
  s_waitcnt vmcnt(14)
  s_waitcnt lgkmcnt(0)
  s_barrier
  v_mfma_f32_32x32x16_bf16 v[16:31], a[40:43], a[48:51], v[16:31]
  v_mfma_f32_32x32x16_bf16 v[48:63], a[40:43], a[52:55], v[48:63]
  ds_read_b64_tr_b16 a[0:1], v124
  ds_read_b64_tr_b16 a[2:3], v124 offset:1024
  ds_read_b64_tr_b16 a[4:5], v125
  ds_read_b64_tr_b16 a[6:7], v125 offset:1024
  v_mfma_f32_32x32x16_bf16 v[80:95], a[40:43], a[56:59], v[80:95]
  v_mfma_f32_32x32x16_bf16 v[32:47], a[44:47], a[48:51], v[32:47]
  ds_read_b128 a[8:11], v118
  ds_read_b128 a[12:15], v118 offset:4096
  ds_read_b128 a[16:19], v118 offset:8192
  v_mfma_f32_32x32x16_bf16 v[64:79], a[44:47], a[52:55], v[64:79]
  v_mfma_f32_32x32x16_bf16 v[96:111], a[44:47], a[56:59], v[96:111]
  s_add_u32 m0, s46, 65536
  s_add_u32 s47, s46, 0
  buffer_load_dwordx4 v252, s[32:35], s47 offen nt lds
  s_waitcnt lgkmcnt(7)
  v_mfma_f32_32x32x16_bf16 v[16:31], a[60:63], a[68:71], v[16:31]
  v_mfma_f32_32x32x16_bf16 v[48:63], a[60:63], a[72:75], v[48:63]
  ds_read_b64_tr_b16 a[20:21], v124 offset:4096
  ds_read_b64_tr_b16 a[22:23], v124 offset:5120
  ds_read_b64_tr_b16 a[24:25], v125 offset:4096
  ds_read_b64_tr_b16 a[26:27], v125 offset:5120
  v_mfma_f32_32x32x16_bf16 v[80:95], a[60:63], a[76:79], v[80:95]
  v_mfma_f32_32x32x16_bf16 v[32:47], a[64:67], a[68:71], v[32:47]
  ds_read_b128 a[28:31], v119
  ds_read_b128 a[32:35], v119 offset:4096
  ds_read_b128 a[36:39], v119 offset:8192
  v_mfma_f32_32x32x16_bf16 v[64:79], a[64:67], a[72:75], v[64:79]
  v_mfma_f32_32x32x16_bf16 v[96:111], a[64:67], a[76:79], v[96:111]
  s_add_u32 m0, s46, 65536
  s_add_u32 s47, s46, 0
  buffer_load_dwordx4 v253, s[32:35], s47 offen offset:1024 nt lds
  s_waitcnt lgkmcnt(7)
  v_mfma_f32_32x32x16_bf16 v[16:31], a[0:3], a[8:11], v[16:31]
  v_mfma_f32_32x32x16_bf16 v[48:63], a[0:3], a[12:15], v[48:63]
  ds_read_b64_tr_b16 a[40:41], v124 offset:8192
  ds_read_b64_tr_b16 a[42:43], v124 offset:9216
  ds_read_b64_tr_b16 a[44:45], v125 offset:8192
  ds_read_b64_tr_b16 a[46:47], v125 offset:9216
  v_mfma_f32_32x32x16_bf16 v[80:95], a[0:3], a[16:19], v[80:95]
  v_mfma_f32_32x32x16_bf16 v[32:47], a[4:7], a[8:11], v[32:47]
  ds_read_b128 a[48:51], v120
  ds_read_b128 a[52:55], v120 offset:4096
  ds_read_b128 a[56:59], v120 offset:8192
  v_mfma_f32_32x32x16_bf16 v[64:79], a[4:7], a[12:15], v[64:79]
  v_mfma_f32_32x32x16_bf16 v[96:111], a[4:7], a[16:19], v[96:111]
  s_add_u32 m0, s46, 65536
  s_add_u32 s47, s46, 0
  buffer_load_dwordx4 v254, s[32:35], s47 offen offset:2048 nt lds
  s_waitcnt lgkmcnt(7)
  v_mfma_f32_32x32x16_bf16 v[16:31], a[20:23], a[28:31], v[16:31]
  v_mfma_f32_32x32x16_bf16 v[48:63], a[20:23], a[32:35], v[48:63]
  ds_read_b64_tr_b16 a[60:61], v124 offset:12288
  ds_read_b64_tr_b16 a[62:63], v124 offset:13312
  ds_read_b64_tr_b16 a[64:65], v125 offset:12288
  ds_read_b64_tr_b16 a[66:67], v125 offset:13312
  v_mfma_f32_32x32x16_bf16 v[80:95], a[20:23], a[36:39], v[80:95]
  v_mfma_f32_32x32x16_bf16 v[32:47], a[24:27], a[28:31], v[32:47]
  ds_read_b128 a[68:71], v121
  ds_read_b128 a[72:75], v121 offset:4096
  ds_read_b128 a[76:79], v121 offset:8192
  v_mfma_f32_32x32x16_bf16 v[64:79], a[24:27], a[32:35], v[64:79]
  v_mfma_f32_32x32x16_bf16 v[96:111], a[24:27], a[36:39], v[96:111]
  s_add_u32 m0, s46, 65536
  s_add_u32 s47, s46, 0
  buffer_load_dwordx4 v255, s[32:35], s47 offen offset:3072 nt lds
  s_waitcnt vmcnt(8)
  s_waitcnt lgkmcnt(0)
  s_barrier
  v_mfma_f32_32x32x16_bf16 v[16:31], a[40:43], a[48:51], v[16:31]
  v_mfma_f32_32x32x16_bf16 v[48:63], a[40:43], a[52:55], v[48:63]
  ds_read_b64_tr_b16 a[0:1], v122
  ds_read_b64_tr_b16 a[2:3], v122 offset:1024
  ds_read_b64_tr_b16 a[4:5], v123
  ds_read_b64_tr_b16 a[6:7], v123 offset:1024
  v_mfma_f32_32x32x16_bf16 v[80:95], a[40:43], a[56:59], v[80:95]
  v_mfma_f32_32x32x16_bf16 v[32:47], a[44:47], a[48:51], v[32:47]
  ds_read_b128 a[8:11], v114
  ds_read_b128 a[12:15], v114 offset:4096
  ds_read_b128 a[16:19], v114 offset:8192
  v_mfma_f32_32x32x16_bf16 v[64:79], a[44:47], a[52:55], v[64:79]
  v_mfma_f32_32x32x16_bf16 v[96:111], a[44:47], a[56:59], v[96:111]
  s_add_u32 m0, s46, 49152
  s_add_u32 s47, s46, 32768
  buffer_load_dwordx4 v252, s[28:31], s47 offen nt lds
  s_waitcnt lgkmcnt(7)
  v_mfma_f32_32x32x16_bf16 v[16:31], a[60:63], a[68:71], v[16:31]
  v_mfma_f32_32x32x16_bf16 v[48:63], a[60:63], a[72:75], v[48:63]
  ds_read_b64_tr_b16 a[20:21], v122 offset:4096
  ds_read_b64_tr_b16 a[22:23], v122 offset:5120
  ds_read_b64_tr_b16 a[24:25], v123 offset:4096
  ds_read_b64_tr_b16 a[26:27], v123 offset:5120
  v_mfma_f32_32x32x16_bf16 v[80:95], a[60:63], a[76:79], v[80:95]
  v_mfma_f32_32x32x16_bf16 v[32:47], a[64:67], a[68:71], v[32:47]
  ds_read_b128 a[28:31], v115
  ds_read_b128 a[32:35], v115 offset:4096
  ds_read_b128 a[36:39], v115 offset:8192
  v_mfma_f32_32x32x16_bf16 v[64:79], a[64:67], a[72:75], v[64:79]
  v_mfma_f32_32x32x16_bf16 v[96:111], a[64:67], a[76:79], v[96:111]
  s_add_u32 m0, s46, 49152
  s_add_u32 s47, s46, 32768
  buffer_load_dwordx4 v253, s[28:31], s47 offen offset:1024 nt lds
  s_waitcnt lgkmcnt(7)
  v_mfma_f32_32x32x16_bf16 v[16:31], a[0:3], a[8:11], v[16:31]
  ds_read_b64_tr_b16 a[40:41], v122 offset:8192
  ds_read_b64_tr_b16 a[42:43], v122 offset:9216
  ds_read_b64_tr_b16 a[44:45], v123 offset:8192
  ds_read_b64_tr_b16 a[46:47], v123 offset:9216
  v_mfma_f32_32x32x16_bf16 v[48:63], a[0:3], a[12:15], v[48:63]
  ds_read_b128 a[48:51], v116
  ds_read_b128 a[52:55], v116 offset:4096
  ds_read_b128 a[56:59], v116 offset:8192
  v_mfma_f32_32x32x16_bf16 v[80:95], a[0:3], a[16:19], v[80:95]
  ds_read_b64_tr_b16 a[60:61], v122 offset:12288
  ds_read_b64_tr_b16 a[62:63], v122 offset:13312
  ds_read_b64_tr_b16 a[64:65], v123 offset:12288
  ds_read_b64_tr_b16 a[66:67], v123 offset:13312
  ds_read_b128 a[68:71], v117
  ds_read_b128 a[72:75], v117 offset:4096
  ds_read_b128 a[76:79], v117 offset:8192
  v_mfma_f32_32x32x16_bf16 v[32:47], a[4:7], a[8:11], v[32:47]
  s_add_u32 m0, s46, 49152
  s_add_u32 s47, s46, 32768
  buffer_load_dwordx4 v254, s[28:31], s47 offen offset:2048 nt lds
  v_mfma_f32_32x32x16_bf16 v[64:79], a[4:7], a[12:15], v[64:79]
  s_add_u32 m0, s46, 49152
  s_add_u32 s47, s46, 32768
  buffer_load_dwordx4 v255, s[28:31], s47 offen offset:3072 nt lds
  v_lshlrev_b32 v11, 4, v1
  v_mfma_f32_32x32x16_bf16 v[96:111], a[4:7], a[16:19], v[96:111]
  v_mul_u32_u24 v12, 12288, v2
  v_add_u32 v240, v11, v12
  v_add_u32 v240, 81920, v240
  v_xor_b32 v13, 1, v2
  v_mul_u32_u24 v12, 12288, v13
  v_add_u32 v241, v11, v12
  v_add_u32 v241, 81920, v241
  s_waitcnt lgkmcnt(0)
  v_mfma_f32_32x32x16_bf16 v[16:31], a[20:23], a[28:31], v[16:31]
  v_mfma_f32_32x32x16_bf16 v[16:31], a[40:43], a[48:51], v[16:31]
  v_mfma_f32_32x32x16_bf16 v[16:31], a[60:63], a[68:71], v[16:31]
  v_mfma_f32_32x32x16_bf16 v[32:47], a[24:27], a[28:31], v[32:47]
  v_mfma_f32_32x32x16_bf16 v[32:47], a[44:47], a[48:51], v[32:47]
  v_mfma_f32_32x32x16_bf16 v[32:47], a[64:67], a[68:71], v[32:47]
  s_nop 8
  v_mul_f32 v16, s42, v16
  v_mul_f32 v17, s42, v17
  v_mul_f32 v18, s42, v18
  v_mul_f32 v19, s42, v19
  v_mul_f32 v20, s42, v20
  v_mul_f32 v21, s42, v21
  v_mul_f32 v22, s42, v22
  v_mul_f32 v23, s42, v23
  v_mul_f32 v24, s42, v24
  v_mul_f32 v25, s42, v25
  v_mfma_f32_32x32x16_bf16 v[48:63], a[20:23], a[32:35], v[48:63]
  v_mul_f32 v26, s42, v26
  v_mul_f32 v27, s42, v27
  v_mul_f32 v28, s42, v28
  v_mul_f32 v29, s42, v29
  v_mul_f32 v30, s42, v30
  v_mul_f32 v31, s42, v31
  v_cvt_pk_bf16_f32 v16, v16, v17
  v_cvt_pk_bf16_f32 v17, v18, v19
  v_cvt_pk_bf16_f32 v18, v20, v21
  v_cvt_pk_bf16_f32 v19, v22, v23
  v_mfma_f32_32x32x16_bf16 v[48:63], a[40:43], a[52:55], v[48:63]
  v_cvt_pk_bf16_f32 v20, v24, v25
  v_cvt_pk_bf16_f32 v21, v26, v27
  v_cvt_pk_bf16_f32 v22, v28, v29
  v_cvt_pk_bf16_f32 v23, v30, v31
  ds_write_b128 v240, v[16:19]
  ds_write_b128 v240, v[20:23] offset:1024
  v_mfma_f32_32x32x16_bf16 v[48:63], a[60:63], a[72:75], v[48:63]
  v_mul_f32 v32, s42, v32
  v_mul_f32 v33, s42, v33
  v_mul_f32 v34, s42, v34
  v_mul_f32 v35, s42, v35
  v_mul_f32 v36, s42, v36
  v_mul_f32 v37, s42, v37
  v_mul_f32 v38, s42, v38
  v_mul_f32 v39, s42, v39
  v_mul_f32 v40, s42, v40
  v_mul_f32 v41, s42, v41
  v_mfma_f32_32x32x16_bf16 v[64:79], a[24:27], a[32:35], v[64:79]
  v_mul_f32 v42, s42, v42
  v_mul_f32 v43, s42, v43
  v_mul_f32 v44, s42, v44
  v_mul_f32 v45, s42, v45
  v_mul_f32 v46, s42, v46
  v_mul_f32 v47, s42, v47
  v_cvt_pk_bf16_f32 v32, v32, v33
  v_cvt_pk_bf16_f32 v33, v34, v35
  v_cvt_pk_bf16_f32 v34, v36, v37
  v_cvt_pk_bf16_f32 v35, v38, v39
  v_mfma_f32_32x32x16_bf16 v[64:79], a[44:47], a[52:55], v[64:79]
  v_cvt_pk_bf16_f32 v36, v40, v41
  v_cvt_pk_bf16_f32 v37, v42, v43
  v_cvt_pk_bf16_f32 v38, v44, v45
  v_cvt_pk_bf16_f32 v39, v46, v47
  ds_write_b128 v240, v[32:35] offset:2048
  ds_write_b128 v240, v[36:39] offset:3072
  v_mfma_f32_32x32x16_bf16 v[64:79], a[64:67], a[72:75], v[64:79]
  v_mul_f32 v48, s42, v48
  v_mul_f32 v49, s42, v49
  v_mul_f32 v50, s42, v50
  v_mul_f32 v51, s42, v51
  v_mul_f32 v52, s42, v52
  v_mul_f32 v53, s42, v53
  v_mul_f32 v54, s42, v54
  v_mul_f32 v55, s42, v55
  v_mul_f32 v56, s42, v56
  v_mul_f32 v57, s42, v57
  v_mfma_f32_32x32x16_bf16 v[80:95], a[20:23], a[36:39], v[80:95]
  v_mul_f32 v58, s42, v58
  v_mul_f32 v59, s42, v59
  v_mul_f32 v60, s42, v60
  v_mul_f32 v61, s42, v61
  v_mul_f32 v62, s42, v62
  v_mul_f32 v63, s42, v63
  v_cvt_pk_bf16_f32 v48, v48, v49
  v_cvt_pk_bf16_f32 v49, v50, v51
  v_cvt_pk_bf16_f32 v50, v52, v53
  v_cvt_pk_bf16_f32 v51, v54, v55
  v_mfma_f32_32x32x16_bf16 v[80:95], a[40:43], a[56:59], v[80:95]
  v_cvt_pk_bf16_f32 v52, v56, v57
  v_cvt_pk_bf16_f32 v53, v58, v59
  v_cvt_pk_bf16_f32 v54, v60, v61
  v_cvt_pk_bf16_f32 v55, v62, v63
  ds_write_b128 v240, v[48:51] offset:4096
  ds_write_b128 v240, v[52:55] offset:5120
  v_mfma_f32_32x32x16_bf16 v[80:95], a[60:63], a[76:79], v[80:95]
  v_mul_f32 v64, s42, v64
  v_mul_f32 v65, s42, v65
  v_mul_f32 v66, s42, v66
  v_mul_f32 v67, s42, v67
  v_mul_f32 v68, s42, v68
  v_mul_f32 v69, s42, v69
  v_mul_f32 v70, s42, v70
  v_mul_f32 v71, s42, v71
  v_mul_f32 v72, s42, v72
  v_mul_f32 v73, s42, v73
  v_mfma_f32_32x32x16_bf16 v[96:111], a[24:27], a[36:39], v[96:111]
  v_mul_f32 v74, s42, v74
  v_mul_f32 v75, s42, v75
  v_mul_f32 v76, s42, v76
  v_mul_f32 v77, s42, v77
  v_mul_f32 v78, s42, v78
  v_mul_f32 v79, s42, v79
  v_cvt_pk_bf16_f32 v64, v64, v65
  v_cvt_pk_bf16_f32 v65, v66, v67
  v_cvt_pk_bf16_f32 v66, v68, v69
  v_cvt_pk_bf16_f32 v67, v70, v71
  v_mfma_f32_32x32x16_bf16 v[96:111], a[44:47], a[56:59], v[96:111]
  v_cvt_pk_bf16_f32 v68, v72, v73
  v_cvt_pk_bf16_f32 v69, v74, v75
  v_cvt_pk_bf16_f32 v70, v76, v77
  v_cvt_pk_bf16_f32 v71, v78, v79
  ds_write_b128 v240, v[64:67] offset:6144
  ds_write_b128 v240, v[68:71] offset:7168
  v_mfma_f32_32x32x16_bf16 v[96:111], a[64:67], a[76:79], v[96:111]
  v_mul_f32 v80, s42, v80
  v_mul_f32 v81, s42, v81
  v_mul_f32 v82, s42, v82
  v_mul_f32 v83, s42, v83
  v_mul_f32 v84, s42, v84
  v_mul_f32 v85, s42, v85
  v_mul_f32 v86, s42, v86
  v_mul_f32 v87, s42, v87
  v_mul_f32 v88, s42, v88
  v_mul_f32 v89, s42, v89
  v_mul_f32 v90, s42, v90
  v_mul_f32 v91, s42, v91
  v_mul_f32 v92, s42, v92
  v_mul_f32 v93, s42, v93
  v_mul_f32 v94, s42, v94
  v_mul_f32 v95, s42, v95
  v_cvt_pk_bf16_f32 v80, v80, v81
  v_cvt_pk_bf16_f32 v81, v82, v83
  v_cvt_pk_bf16_f32 v82, v84, v85
  v_cvt_pk_bf16_f32 v83, v86, v87
  v_cvt_pk_bf16_f32 v84, v88, v89
  v_cvt_pk_bf16_f32 v85, v90, v91
  v_cvt_pk_bf16_f32 v86, v92, v93
  v_cvt_pk_bf16_f32 v87, v94, v95
  ds_write_b128 v240, v[80:83] offset:8192
  ds_write_b128 v240, v[84:87] offset:9216
  v_mul_f32 v96, s42, v96
  v_mul_f32 v97, s42, v97
  v_mul_f32 v98, s42, v98
  v_mul_f32 v99, s42, v99
  v_mul_f32 v100, s42, v100
  v_mul_f32 v101, s42, v101
  v_mul_f32 v102, s42, v102
  v_mul_f32 v103, s42, v103
  v_mul_f32 v104, s42, v104
  v_mul_f32 v105, s42, v105
  v_mul_f32 v106, s42, v106
  v_mul_f32 v107, s42, v107
  v_mul_f32 v108, s42, v108
  v_mul_f32 v109, s42, v109
  v_mul_f32 v110, s42, v110
  v_mul_f32 v111, s42, v111
  v_cvt_pk_bf16_f32 v96, v96, v97
  v_cvt_pk_bf16_f32 v97, v98, v99
  v_cvt_pk_bf16_f32 v98, v100, v101
  v_cvt_pk_bf16_f32 v99, v102, v103
  v_cvt_pk_bf16_f32 v100, v104, v105
  v_cvt_pk_bf16_f32 v101, v106, v107
  v_cvt_pk_bf16_f32 v102, v108, v109
  v_cvt_pk_bf16_f32 v103, v110, v111
  ds_write_b128 v240, v[96:99] offset:10240
  ds_write_b128 v240, v[100:103] offset:11264
  s_waitcnt lgkmcnt(0)
  s_barrier
  s_bitcmp1_b32 s19, 0
  s_cbranch_scc1 L_attn_ex1
  ds_read_b128 v[128:131], v241
  ds_read_b128 v[132:135], v241 offset:1024
  ds_read_b128 v[136:139], v241 offset:2048
  ds_read_b128 v[140:143], v241 offset:3072
  ds_read_b128 v[160:163], v241 offset:4096
  ds_read_b128 v[164:167], v241 offset:5120
  ds_read_b128 v[168:171], v241 offset:6144
  ds_read_b128 v[172:175], v241 offset:7168
  ds_read_b128 a[208:211], v241 offset:8192
  ds_read_b128 a[212:215], v241 offset:9216
  ds_read_b128 a[216:219], v241 offset:10240
  ds_read_b128 a[220:223], v241 offset:11264
  v_mov_b32 v112, v16
  v_mov_b32 v113, v17
  v_mov_b32 v114, v18
  v_mov_b32 v115, v19
  v_mov_b32 v116, v20
  v_mov_b32 v117, v21
  v_mov_b32 v118, v22
  v_mov_b32 v119, v23
  v_mov_b32 v120, v32
  v_mov_b32 v121, v33
  v_mov_b32 v122, v34
  v_mov_b32 v123, v35
  v_mov_b32 v124, v36
  v_mov_b32 v125, v37
  v_mov_b32 v126, v38
  v_mov_b32 v127, v39
  v_mov_b32 v144, v48
  v_mov_b32 v145, v49
  v_mov_b32 v146, v50
  v_mov_b32 v147, v51
  v_mov_b32 v148, v52
  v_mov_b32 v149, v53
  v_mov_b32 v150, v54
  v_mov_b32 v151, v55
  v_mov_b32 v152, v64
  v_mov_b32 v153, v65
  v_mov_b32 v154, v66
  v_mov_b32 v155, v67
  v_mov_b32 v156, v68
  v_mov_b32 v157, v69
  v_mov_b32 v158, v70
  v_mov_b32 v159, v71
  v_accvgpr_write_b32 a192, v80
  v_accvgpr_write_b32 a193, v81
  v_accvgpr_write_b32 a194, v82
  v_accvgpr_write_b32 a195, v83
  v_accvgpr_write_b32 a196, v84
  v_accvgpr_write_b32 a197, v85
  v_accvgpr_write_b32 a198, v86
  v_accvgpr_write_b32 a199, v87
  v_accvgpr_write_b32 a200, v96
  v_accvgpr_write_b32 a201, v97
  v_accvgpr_write_b32 a202, v98
  v_accvgpr_write_b32 a203, v99
  v_accvgpr_write_b32 a204, v100
  v_accvgpr_write_b32 a205, v101
  v_accvgpr_write_b32 a206, v102
  v_accvgpr_write_b32 a207, v103
  s_branch L_attn_exd
L_attn_ex1:
  ds_read_b128 v[112:115], v241
  ds_read_b128 v[116:119], v241 offset:1024
  ds_read_b128 v[120:123], v241 offset:2048
  ds_read_b128 v[124:127], v241 offset:3072
  ds_read_b128 v[144:147], v241 offset:4096
  ds_read_b128 v[148:151], v241 offset:5120
  ds_read_b128 v[152:155], v241 offset:6144
  ds_read_b128 v[156:159], v241 offset:7168
  ds_read_b128 a[192:195], v241 offset:8192
  ds_read_b128 a[196:199], v241 offset:9216
  ds_read_b128 a[200:203], v241 offset:10240
  ds_read_b128 a[204:207], v241 offset:11264
  v_mov_b32 v128, v16
  v_mov_b32 v129, v17
  v_mov_b32 v130, v18
  v_mov_b32 v131, v19
  v_mov_b32 v132, v20
  v_mov_b32 v133, v21
  v_mov_b32 v134, v22
  v_mov_b32 v135, v23
  v_mov_b32 v136, v32
  v_mov_b32 v137, v33
  v_mov_b32 v138, v34
  v_mov_b32 v139, v35
  v_mov_b32 v140, v36
  v_mov_b32 v141, v37
  v_mov_b32 v142, v38
  v_mov_b32 v143, v39
  v_mov_b32 v160, v48
  v_mov_b32 v161, v49
  v_mov_b32 v162, v50
  v_mov_b32 v163, v51
  v_mov_b32 v164, v52
  v_mov_b32 v165, v53
  v_mov_b32 v166, v54
  v_mov_b32 v167, v55
  v_mov_b32 v168, v64
  v_mov_b32 v169, v65
  v_mov_b32 v170, v66
  v_mov_b32 v171, v67
  v_mov_b32 v172, v68
  v_mov_b32 v173, v69
  v_mov_b32 v174, v70
  v_mov_b32 v175, v71
  v_accvgpr_write_b32 a208, v80
  v_accvgpr_write_b32 a209, v81
  v_accvgpr_write_b32 a210, v82
  v_accvgpr_write_b32 a211, v83
  v_accvgpr_write_b32 a212, v84
  v_accvgpr_write_b32 a213, v85
  v_accvgpr_write_b32 a214, v86
  v_accvgpr_write_b32 a215, v87
  v_accvgpr_write_b32 a216, v96
  v_accvgpr_write_b32 a217, v97
  v_accvgpr_write_b32 a218, v98
  v_accvgpr_write_b32 a219, v99
  v_accvgpr_write_b32 a220, v100
  v_accvgpr_write_b32 a221, v101
  v_accvgpr_write_b32 a222, v102
  v_accvgpr_write_b32 a223, v103
L_attn_exd:
  s_waitcnt lgkmcnt(0)
  s_waitcnt vmcnt(32)
  s_barrier
  ds_read_b128 a[224:227], v232
  ds_read_b128 a[228:231], v233
  ds_read_b128 a[232:235], v234
  ds_read_b128 a[236:239], v235
  v_mov_b32 v240, 0
  v_mov_b32 v243, 1.0
  v_mov_b32 v176, 0
  v_mov_b32 v177, 0
  s_waitcnt lgkmcnt(2)
  v_mfma_f32_32x32x16_bf16 v[16:31], a[224:227], v[112:115], 0
  ds_read_b128 a[240:243], v236
  ds_read_b128 a[244:247], v237
  v_mov_b32 v178, 0
  v_mfma_f32_32x32x16_bf16 v[32:47], a[224:227], v[144:147], 0
  v_mov_b32 v179, 0
  v_mov_b32 v180, 0
  v_mov_b32 v181, 0
  v_mov_b32 v182, 0
  v_mov_b32 v183, 0
  v_mfma_f32_32x32x16_bf16 v[48:63], a[224:227], a[192:195], 0
  s_add_u32 m0, s46, 81920
  s_add_u32 s47, s46, 16384
  buffer_load_dwordx4 v252, s[32:35], s47 offen nt lds
  v_mfma_f32_32x32x16_bf16 v[16:31], a[228:231], v[116:119], v[16:31]
  v_mov_b32 v184, 0
  v_mov_b32 v185, 0
  v_mov_b32 v186, 0
  v_mov_b32 v187, 0
  v_mov_b32 v188, 0
  v_mfma_f32_32x32x16_bf16 v[32:47], a[228:231], v[148:151], v[32:47]
  v_mov_b32 v189, 0
  v_mov_b32 v190, 0
  v_mov_b32 v191, 0
  v_mov_b32 v241, 0
  v_mfma_f32_32x32x16_bf16 v[48:63], a[228:231], a[196:199], v[48:63]
  v_mov_b32 v244, 1.0
  v_mov_b32 v192, 0
  v_mov_b32 v193, 0
  v_mov_b32 v194, 0
  s_waitcnt lgkmcnt(2)
  v_mfma_f32_32x32x16_bf16 v[16:31], a[232:235], v[120:123], v[16:31]
  ds_read_b128 a[248:251], v238
  ds_read_b128 a[252:255], v239
  v_mov_b32 v195, 0
  v_mfma_f32_32x32x16_bf16 v[32:47], a[232:235], v[152:155], v[32:47]
  v_mov_b32 v196, 0
  v_mov_b32 v197, 0
  v_mov_b32 v198, 0
  v_mov_b32 v199, 0
  v_mov_b32 v200, 0
  v_mfma_f32_32x32x16_bf16 v[48:63], a[232:235], a[200:203], v[48:63]
  buffer_load_dwordx4 v253, s[32:35], s47 offen offset:1024 nt lds
  v_mov_b32 v201, 0
  v_mov_b32 v202, 0
  v_mfma_f32_32x32x16_bf16 v[16:31], a[236:239], v[124:127], v[16:31]
  v_mov_b32 v203, 0
  v_mov_b32 v204, 0
  v_mov_b32 v205, 0
  v_mov_b32 v206, 0
  v_mfma_f32_32x32x16_bf16 v[32:47], a[236:239], v[156:159], v[32:47]
  v_mov_b32 v207, 0
  v_mov_b32 v242, 0
  v_mov_b32 v245, 1.0
  v_mov_b32 v208, 0
  v_mov_b32 v209, 0
  v_mfma_f32_32x32x16_bf16 v[48:63], a[236:239], a[204:207], v[48:63]
  v_mov_b32 v210, 0
  v_mov_b32 v211, 0
  v_mov_b32 v212, 0
  s_waitcnt lgkmcnt(2)
  v_mfma_f32_32x32x16_bf16 v[16:31], a[240:243], v[128:131], v[16:31]
  s_waitcnt vmcnt(10)
  s_barrier
  ds_read_b128 a[224:227], v232 offset:16384
  ds_read_b128 a[228:231], v233 offset:16384
  v_mfma_f32_32x32x16_bf16 v[32:47], a[240:243], v[160:163], v[32:47]
  v_mov_b32 v213, 0
  v_mov_b32 v214, 0
  v_mov_b32 v215, 0
  v_mov_b32 v216, 0
  v_mov_b32 v217, 0
  v_mfma_f32_32x32x16_bf16 v[48:63], a[240:243], a[208:211], v[48:63]
  buffer_load_dwordx4 v254, s[32:35], s47 offen offset:2048 nt lds
  v_mov_b32 v218, 0
  v_mov_b32 v219, 0
  v_mfma_f32_32x32x16_bf16 v[16:31], a[244:247], v[132:135], v[16:31]
  v_mov_b32 v220, 0
  v_mov_b32 v221, 0
  v_mov_b32 v222, 0
  v_mov_b32 v223, 0
  v_mfma_f32_32x32x16_bf16 v[32:47], a[244:247], v[164:167], v[32:47]
  s_mov_b32 s52, 0
  s_mov_b32 s53, 0
  v_mfma_f32_32x32x16_bf16 v[48:63], a[244:247], a[212:215], v[48:63]
  s_mov_b32 s56, s54
  s_mov_b32 s57, s55
  s_mov_b32 s58, 5242880
  s_mov_b32 s59, 131072
  s_mul_i32 s45, s2, 20480
  v_min_u32 v11, 39, v1
  v_mul_u32_u24 v12, 40, v2
  v_add_u32 v11, v11, v12
  v_lshlrev_b32 v11, 7, v11
  buffer_load_dword v13, v11, s[56:59], s45 offen
  s_waitcnt lgkmcnt(2)
  v_mfma_f32_32x32x16_bf16 v[16:31], a[248:251], v[136:139], v[16:31]
  ds_read_b128 a[232:235], v234 offset:16384
  ds_read_b128 a[236:239], v235 offset:16384
  v_mfma_f32_32x32x16_bf16 v[32:47], a[248:251], v[168:171], v[32:47]
  v_mfma_f32_32x32x16_bf16 v[48:63], a[248:251], a[216:219], v[48:63]
  buffer_load_dwordx4 v255, s[32:35], s47 offen offset:3072 nt lds
  v_lshl_add_u32 v251, v2, 6, v1
  v_mfma_f32_32x32x16_bf16 v[16:31], a[252:255], v[140:143], v[16:31]
  s_mov_b32 s56, s90
  s_mov_b32 s57, s91
  s_mov_b32 s58, 4
  s_mov_b32 s59, 131072
  s_lshl_b32 s45, s2, 2
  s_or_b32 s92, s92, 1
  v_lshlrev_b32 v11, 2, v251
  v_mov_b32 v12, s92
  buffer_store_dword v12, v11, s[56:59], s45 offen sc0 sc1
  v_mfma_f32_32x32x16_bf16 v[32:47], a[252:255], v[172:175], v[32:47]
  v_mfma_f32_32x32x16_bf16 v[48:63], a[252:255], a[220:223], v[48:63]
  s_nop 0
  v_max3_f32 v249, v16, v17, v18
  v_max3_f32 v249, v249, v19, v20
  v_max3_f32 v249, v249, v21, v22
  s_waitcnt lgkmcnt(2)
  v_mfma_f32_32x32x16_bf16 v[64:79], a[224:227], v[112:115], 0
  ds_read_b128 a[240:243], v236 offset:16384
  ds_read_b128 a[244:247], v237 offset:16384
  v_max3_f32 v249, v249, v23, v24
  v_max3_f32 v249, v249, v25, v26
  v_max3_f32 v249, v249, v27, v28
  v_max3_f32 v249, v249, v29, v30
  v_max_f32 v249, v249, v31
  v_max3_f32 v250, v32, v33, v34
  v_mfma_f32_32x32x16_bf16 v[80:95], a[224:227], v[144:147], 0
  v_max3_f32 v250, v250, v35, v36
  v_max3_f32 v250, v250, v37, v38
  v_max3_f32 v250, v250, v39, v40
  v_max3_f32 v250, v250, v41, v42
  v_max3_f32 v250, v250, v43, v44
  v_max3_f32 v250, v250, v45, v46
  v_max_f32 v250, v250, v47
  v_max3_f32 v251, v48, v49, v50
  v_max3_f32 v251, v251, v51, v52
  v_max3_f32 v251, v251, v53, v54
  v_mfma_f32_32x32x16_bf16 v[96:111], a[224:227], a[192:195], 0
  s_add_u32 m0, s46, 0
  s_add_u32 s47, s46, 49152
  buffer_load_dwordx4 v252, s[28:31], s47 offen nt lds
  v_max3_f32 v251, v251, v55, v56
  v_max3_f32 v251, v251, v57, v58
  v_max3_f32 v251, v251, v59, v60
  v_max3_f32 v251, v251, v61, v62
  v_max_f32 v251, v251, v63
  v_mfma_f32_32x32x16_bf16 v[64:79], a[228:231], v[116:119], v[64:79]
  v_max3_f32 v14, v249, v250, v251
  v_min3_f32 v15, v249, v250, v251
  v_max_f32 v14, v14, -v15
  v_cmp_nge_f32 vcc, 1090519040, v14
  s_cbranch_vccnz L_attn_rare0
L_attn_ret0:
  v_exp_f32 v16, v16
  v_exp_f32 v17, v17
  v_mfma_f32_32x32x16_bf16 v[80:95], a[228:231], v[148:151], v[80:95]
  v_mov_b32 v246, v16
  v_exp_f32 v18, v18
  v_add_f32 v246, v246, v17
  v_cvt_pk_bf16_f32 v16, v16, v17
  v_exp_f32 v19, v19
  v_add_f32 v246, v246, v18
  v_exp_f32 v20, v20
  v_mfma_f32_32x32x16_bf16 v[96:111], a[228:231], a[196:199], v[96:111]
  v_add_f32 v246, v246, v19
  v_cvt_pk_bf16_f32 v17, v18, v19
  v_exp_f32 v21, v21
  v_add_f32 v246, v246, v20
  v_exp_f32 v22, v22
  v_add_f32 v246, v246, v21
  v_cvt_pk_bf16_f32 v18, v20, v21
  s_waitcnt lgkmcnt(2)
  v_mfma_f32_32x32x16_bf16 v[64:79], a[232:235], v[120:123], v[64:79]
  ds_read_b128 a[248:251], v238 offset:16384
  ds_read_b128 a[252:255], v239 offset:16384
  v_exp_f32 v23, v23
  v_add_f32 v246, v246, v22
  v_exp_f32 v24, v24
  v_add_f32 v246, v246, v23
  v_cvt_pk_bf16_f32 v19, v22, v23
  v_mfma_f32_32x32x16_bf16 v[80:95], a[232:235], v[152:155], v[80:95]
  v_exp_f32 v25, v25
  v_add_f32 v246, v246, v24
  v_exp_f32 v26, v26
  v_add_f32 v246, v246, v25
  v_cvt_pk_bf16_f32 v20, v24, v25
  v_exp_f32 v27, v27
  v_add_f32 v246, v246, v26
  v_mfma_f32_32x32x16_bf16 v[96:111], a[232:235], a[200:203], v[96:111]
  buffer_load_dwordx4 v253, s[28:31], s47 offen offset:1024 nt lds
  v_exp_f32 v28, v28
  v_add_f32 v246, v246, v27
  v_cvt_pk_bf16_f32 v21, v26, v27
  v_exp_f32 v29, v29
  v_add_f32 v246, v246, v28
  v_mfma_f32_32x32x16_bf16 v[64:79], a[236:239], v[124:127], v[64:79]
  v_exp_f32 v30, v30
  v_add_f32 v246, v246, v29
  v_cvt_pk_bf16_f32 v22, v28, v29
  v_exp_f32 v31, v31
  v_add_f32 v246, v246, v30
  v_add_f32 v246, v246, v31
  v_cvt_pk_bf16_f32 v23, v30, v31
  v_mfma_f32_32x32x16_bf16 v[80:95], a[236:239], v[156:159], v[80:95]
  v_exp_f32 v32, v32
  v_exp_f32 v33, v33
  v_mov_b32 v247, v32
  v_exp_f32 v34, v34
  v_add_f32 v247, v247, v33
  v_cvt_pk_bf16_f32 v32, v32, v33
  v_exp_f32 v35, v35
  v_mfma_f32_32x32x16_bf16 v[96:111], a[236:239], a[204:207], v[96:111]
  v_add_f32 v247, v247, v34
  v_exp_f32 v36, v36
  v_add_f32 v247, v247, v35
  v_cvt_pk_bf16_f32 v33, v34, v35
  v_exp_f32 v37, v37
  v_add_f32 v247, v247, v36
  v_exp_f32 v38, v38
  s_waitcnt lgkmcnt(2)
  v_mfma_f32_32x32x16_bf16 v[64:79], a[240:243], v[128:131], v[64:79]
  v_mov_b32 v232, v0
  v_xor_b32 v233, 32, v0
  v_xor_b32 v234, 64, v0
  v_xor_b32 v235, 96, v0
  v_xor_b32 v236, 128, v0
  v_xor_b32 v237, 160, v0
  v_xor_b32 v238, 192, v0
  v_xor_b32 v239, 224, v0
  s_waitcnt vmcnt(12)
  s_barrier
  ds_read_b64_tr_b16 a[224:225], v232
  ds_read_b64_tr_b16 a[226:227], v233 offset:2048
  ds_read_b64_tr_b16 a[228:229], v234
  ds_read_b64_tr_b16 a[230:231], v235 offset:2048
  v_add_f32 v247, v247, v37
  v_cvt_pk_bf16_f32 v34, v36, v37
  v_exp_f32 v39, v39
  v_mfma_f32_32x32x16_bf16 v[80:95], a[240:243], v[160:163], v[80:95]
  v_add_f32 v247, v247, v38
  v_exp_f32 v40, v40
  v_add_f32 v247, v247, v39
  v_cvt_pk_bf16_f32 v35, v38, v39
  v_exp_f32 v41, v41
  v_add_f32 v247, v247, v40
  v_exp_f32 v42, v42
  v_mfma_f32_32x32x16_bf16 v[96:111], a[240:243], a[208:211], v[96:111]
  buffer_load_dwordx4 v254, s[28:31], s47 offen offset:2048 nt lds
  v_add_f32 v247, v247, v41
  v_cvt_pk_bf16_f32 v36, v40, v41
  v_exp_f32 v43, v43
  v_add_f32 v247, v247, v42
  v_exp_f32 v44, v44
  v_mfma_f32_32x32x16_bf16 v[64:79], a[244:247], v[132:135], v[64:79]
  v_add_f32 v247, v247, v43
  v_cvt_pk_bf16_f32 v37, v42, v43
  v_exp_f32 v45, v45
  v_add_f32 v247, v247, v44
  v_exp_f32 v46, v46
  v_add_f32 v247, v247, v45
  v_cvt_pk_bf16_f32 v38, v44, v45
  v_mfma_f32_32x32x16_bf16 v[80:95], a[244:247], v[164:167], v[80:95]
  v_exp_f32 v47, v47
  v_add_f32 v247, v247, v46
  v_add_f32 v247, v247, v47
  v_cvt_pk_bf16_f32 v39, v46, v47
  v_exp_f32 v48, v48
  v_exp_f32 v49, v49
  v_mov_b32 v248, v48
  v_mfma_f32_32x32x16_bf16 v[96:111], a[244:247], a[212:215], v[96:111]
  v_exp_f32 v50, v50
  v_add_f32 v248, v248, v49
  v_cvt_pk_bf16_f32 v48, v48, v49
  v_exp_f32 v51, v51
  v_add_f32 v248, v248, v50
  v_exp_f32 v52, v52
  v_add_f32 v248, v248, v51
  s_waitcnt lgkmcnt(4)
  v_mfma_f32_32x32x16_bf16 v[64:79], a[248:251], v[136:139], v[64:79]
  ds_read_b64_tr_b16 a[232:233], v236
  ds_read_b64_tr_b16 a[234:235], v237 offset:2048
  ds_read_b64_tr_b16 a[236:237], v238
  ds_read_b64_tr_b16 a[238:239], v239 offset:2048
  v_cvt_pk_bf16_f32 v49, v50, v51
  v_exp_f32 v53, v53
  v_add_f32 v248, v248, v52
  v_mfma_f32_32x32x16_bf16 v[80:95], a[248:251], v[168:171], v[80:95]
  v_exp_f32 v54, v54
  v_add_f32 v248, v248, v53
  v_cvt_pk_bf16_f32 v50, v52, v53
  v_exp_f32 v55, v55
  v_add_f32 v248, v248, v54
  v_exp_f32 v56, v56
  v_add_f32 v248, v248, v55
  v_mfma_f32_32x32x16_bf16 v[96:111], a[248:251], a[216:219], v[96:111]
  buffer_load_dwordx4 v255, s[28:31], s47 offen offset:3072 nt lds
  v_cvt_pk_bf16_f32 v51, v54, v55
  v_exp_f32 v57, v57
  v_add_f32 v248, v248, v56
  v_exp_f32 v58, v58
  v_add_f32 v248, v248, v57
  v_mfma_f32_32x32x16_bf16 v[64:79], a[252:255], v[140:143], v[64:79]
  v_cvt_pk_bf16_f32 v52, v56, v57
  v_exp_f32 v59, v59
  v_add_f32 v248, v248, v58
  v_exp_f32 v60, v60
  v_add_f32 v248, v248, v59
  v_cvt_pk_bf16_f32 v53, v58, v59
  v_exp_f32 v61, v61
  v_mfma_f32_32x32x16_bf16 v[80:95], a[252:255], v[172:175], v[80:95]
  v_add_f32 v248, v248, v60
  v_exp_f32 v62, v62
  v_add_f32 v248, v248, v61
  v_cvt_pk_bf16_f32 v54, v60, v61
  v_exp_f32 v63, v63
  v_add_f32 v248, v248, v62
  v_add_f32 v248, v248, v63
  v_cvt_pk_bf16_f32 v55, v62, v63
  v_mfma_f32_32x32x16_bf16 v[96:111], a[252:255], a[220:223], v[96:111]
  s_waitcnt lgkmcnt(4)
  v_mfma_f32_32x32x16_bf16 a[0:15], a[224:227], v[16:19], 0
  ds_read_b64_tr_b16 a[240:241], v232 offset:4096
  ds_read_b64_tr_b16 a[242:243], v233 offset:6144
  ds_read_b64_tr_b16 a[244:245], v234 offset:4096
  ds_read_b64_tr_b16 a[246:247], v235 offset:6144
  v_mfma_f32_32x32x16_bf16 a[64:79], a[224:227], v[32:35], 0
  s_cmp_lg_u32 s53, 0
  s_cbranch_scc1 L_attn_fix1
L_attn_fix1ret:
  v_max3_f32 v249, v64, v65, v66
  v_max3_f32 v250, v67, v68, v69
  v_max3_f32 v249, v249, v70, v71
  v_mfma_f32_32x32x16_bf16 a[128:143], a[224:227], v[48:51], 0
  s_add_u32 m0, s46, 98304
  s_add_u32 s47, s46, 32768
  buffer_load_dwordx4 v252, s[32:35], s47 offen nt lds
  v_max3_f32 v250, v250, v72, v73
  v_mfma_f32_32x32x16_bf16 a[16:31], a[228:231], v[16:19], 0
  v_max3_f32 v249, v249, v74, v75
  v_max3_f32 v250, v250, v76, v77
  v_max3_f32 v249, v249, v78, v79
  v_max3_f32 v250, v250, v80, v81
  v_max3_f32 v249, v249, v82, v83
  v_max3_f32 v250, v250, v84, v85
  v_mfma_f32_32x32x16_bf16 a[80:95], a[228:231], v[32:35], 0
  v_max3_f32 v249, v249, v86, v87
  v_max3_f32 v250, v250, v88, v89
  v_max3_f32 v249, v249, v90, v91
  v_max3_f32 v250, v250, v92, v93
  v_max3_f32 v249, v249, v94, v95
  v_max3_f32 v250, v250, v96, v97
  v_mfma_f32_32x32x16_bf16 a[144:159], a[228:231], v[48:51], 0
  v_max3_f32 v249, v249, v98, v99
  v_max3_f32 v250, v250, v100, v101
  v_max3_f32 v249, v249, v102, v103
  v_max3_f32 v250, v250, v104, v105
  s_waitcnt lgkmcnt(4)
  v_mfma_f32_32x32x16_bf16 a[32:47], a[232:235], v[16:19], 0
  ds_read_b64_tr_b16 a[248:249], v236 offset:4096
  ds_read_b64_tr_b16 a[250:251], v237 offset:6144
  ds_read_b64_tr_b16 a[252:253], v238 offset:4096
  ds_read_b64_tr_b16 a[254:255], v239 offset:6144
  v_mfma_f32_32x32x16_bf16 a[96:111], a[232:235], v[32:35], 0
  v_max3_f32 v249, v249, v106, v107
  v_max3_f32 v250, v250, v108, v109
  v_max3_f32 v249, v249, v110, v111
  v_max_f32 v249, v249, v250
  v_cmp_lt_f32 vcc, 1090519040, v249
  s_cbranch_vccnz L_attn_rare1
L_attn_ret1:
  v_mfma_f32_32x32x16_bf16 a[160:175], a[232:235], v[48:51], 0
  buffer_load_dwordx4 v253, s[32:35], s47 offen offset:1024 nt lds
  v_exp_f32 v64, v64
  v_mfma_f32_32x32x16_bf16 a[48:63], a[236:239], v[16:19], 0
  v_exp_f32 v65, v65
  v_add_f32 v246, v246, v64
  v_exp_f32 v66, v66
  v_add_f32 v246, v246, v65
  v_mfma_f32_32x32x16_bf16 a[112:127], a[236:239], v[32:35], 0
  v_cvt_pk_bf16_f32 v64, v64, v65
  v_exp_f32 v67, v67
  v_add_f32 v246, v246, v66
  v_exp_f32 v68, v68
  v_mfma_f32_32x32x16_bf16 a[176:191], a[236:239], v[48:51], 0
  v_add_f32 v246, v246, v67
  v_cvt_pk_bf16_f32 v65, v66, v67
  v_exp_f32 v69, v69
  v_add_f32 v246, v246, v68
  s_waitcnt lgkmcnt(4)
  v_mfma_f32_32x32x16_bf16 a[0:15], a[240:243], v[20:23], a[0:15]
  s_waitcnt vmcnt(12)
  s_barrier
  ds_read_b128 a[224:227], v224 offset:49152
  ds_read_b128 a[228:231], v225 offset:49152
  v_mfma_f32_32x32x16_bf16 a[64:79], a[240:243], v[36:39], a[64:79]
  v_exp_f32 v70, v70
  v_add_f32 v246, v246, v69
  v_cvt_pk_bf16_f32 v66, v68, v69
  v_exp_f32 v71, v71
  v_mfma_f32_32x32x16_bf16 a[128:143], a[240:243], v[52:55], a[128:143]
  buffer_load_dwordx4 v254, s[32:35], s47 offen offset:2048 nt lds
  v_add_f32 v246, v246, v70
  v_exp_f32 v72, v72
  v_mfma_f32_32x32x16_bf16 a[16:31], a[244:247], v[20:23], a[16:31]
  v_add_f32 v246, v246, v71
  v_cvt_pk_bf16_f32 v67, v70, v71
  v_exp_f32 v73, v73
  v_add_f32 v246, v246, v72
  v_mfma_f32_32x32x16_bf16 a[80:95], a[244:247], v[36:39], a[80:95]
  v_exp_f32 v74, v74
  v_add_f32 v246, v246, v73
  v_cvt_pk_bf16_f32 v68, v72, v73
  v_exp_f32 v75, v75
  v_add_f32 v246, v246, v74
  v_mfma_f32_32x32x16_bf16 a[144:159], a[244:247], v[52:55], a[144:159]
  v_exp_f32 v76, v76
  v_add_f32 v246, v246, v75
  v_cvt_pk_bf16_f32 v69, v74, v75
  s_waitcnt lgkmcnt(2)
  v_mfma_f32_32x32x16_bf16 a[32:47], a[248:251], v[20:23], a[32:47]
  ds_read_b128 a[232:235], v226 offset:49152
  ds_read_b128 a[236:239], v227 offset:49152
  v_exp_f32 v77, v77
  v_mfma_f32_32x32x16_bf16 a[96:111], a[248:251], v[36:39], a[96:111]
  v_add_f32 v246, v246, v76
  v_exp_f32 v78, v78
  v_add_f32 v246, v246, v77
  v_cvt_pk_bf16_f32 v70, v76, v77
  v_exp_f32 v79, v79
  v_mfma_f32_32x32x16_bf16 a[160:175], a[248:251], v[52:55], a[160:175]
  buffer_load_dwordx4 v255, s[32:35], s47 offen offset:3072 nt lds
  v_add_f32 v246, v246, v78
  v_add_f32 v246, v246, v79
  v_mfma_f32_32x32x16_bf16 a[48:63], a[252:255], v[20:23], a[48:63]
  v_cvt_pk_bf16_f32 v71, v78, v79
  v_exp_f32 v80, v80
  v_exp_f32 v81, v81
  v_add_f32 v247, v247, v80
  v_mfma_f32_32x32x16_bf16 a[112:127], a[252:255], v[36:39], a[112:127]
  v_exp_f32 v82, v82
  v_add_f32 v247, v247, v81
  v_cvt_pk_bf16_f32 v80, v80, v81
  v_exp_f32 v83, v83
  v_mfma_f32_32x32x16_bf16 a[176:191], a[252:255], v[52:55], a[176:191]
  v_add_f32 v247, v247, v82
  v_exp_f32 v84, v84
  v_add_f32 v247, v247, v83
  v_cvt_pk_bf16_f32 v81, v82, v83
  s_waitcnt lgkmcnt(2)
  v_mfma_f32_32x32x16_bf16 v[16:31], a[224:227], v[112:115], v[176:191]
  ds_read_b128 a[240:243], v228 offset:49152
  ds_read_b128 a[244:247], v229 offset:49152
  v_exp_f32 v85, v85
  v_mfma_f32_32x32x16_bf16 v[32:47], a[224:227], v[144:147], v[192:207]
  v_add_f32 v247, v247, v84
  v_exp_f32 v86, v86
  v_add_f32 v247, v247, v85
  v_cvt_pk_bf16_f32 v82, v84, v85
  v_mfma_f32_32x32x16_bf16 v[48:63], a[224:227], a[192:195], v[208:223]
  s_add_u32 m0, s46, 16384
  s_add_u32 s47, s46, 65536
  buffer_load_dwordx4 v252, s[28:31], s47 offen nt lds
  v_exp_f32 v87, v87
  v_mfma_f32_32x32x16_bf16 v[16:31], a[228:231], v[116:119], v[16:31]
  v_add_f32 v247, v247, v86
  v_exp_f32 v88, v88
  v_add_f32 v247, v247, v87
  v_cvt_pk_bf16_f32 v83, v86, v87
  v_mfma_f32_32x32x16_bf16 v[32:47], a[228:231], v[148:151], v[32:47]
  v_exp_f32 v89, v89
  v_add_f32 v247, v247, v88
  v_exp_f32 v90, v90
  v_add_f32 v247, v247, v89
  v_mfma_f32_32x32x16_bf16 v[48:63], a[228:231], a[196:199], v[48:63]
  v_cvt_pk_bf16_f32 v84, v88, v89
  v_exp_f32 v91, v91
  v_add_f32 v247, v247, v90
  s_waitcnt lgkmcnt(2)
  v_mfma_f32_32x32x16_bf16 v[16:31], a[232:235], v[120:123], v[16:31]
  ds_read_b128 a[248:251], v230 offset:49152
  ds_read_b128 a[252:255], v231 offset:49152
  v_exp_f32 v92, v92
  v_mfma_f32_32x32x16_bf16 v[32:47], a[232:235], v[152:155], v[32:47]
  v_add_f32 v247, v247, v91
  v_cvt_pk_bf16_f32 v85, v90, v91
  v_exp_f32 v93, v93
  v_add_f32 v247, v247, v92
  v_exp_f32 v94, v94
  v_mfma_f32_32x32x16_bf16 v[48:63], a[232:235], a[200:203], v[48:63]
  buffer_load_dwordx4 v253, s[28:31], s47 offen offset:1024 nt lds
  v_add_f32 v247, v247, v93
  v_cvt_pk_bf16_f32 v86, v92, v93
  v_mfma_f32_32x32x16_bf16 v[16:31], a[236:239], v[124:127], v[16:31]
  v_exp_f32 v95, v95
  v_add_f32 v247, v247, v94
  v_add_f32 v247, v247, v95
  v_cvt_pk_bf16_f32 v87, v94, v95
  v_mfma_f32_32x32x16_bf16 v[32:47], a[236:239], v[156:159], v[32:47]
  v_exp_f32 v96, v96
  v_exp_f32 v97, v97
  v_add_f32 v248, v248, v96
  v_exp_f32 v98, v98
  v_mfma_f32_32x32x16_bf16 v[48:63], a[236:239], a[204:207], v[48:63]
  v_add_f32 v248, v248, v97
  v_cvt_pk_bf16_f32 v96, v96, v97
  v_exp_f32 v99, v99
  s_waitcnt lgkmcnt(2)
  v_mfma_f32_32x32x16_bf16 v[16:31], a[240:243], v[128:131], v[16:31]
  s_waitcnt vmcnt(11)
  s_barrier
  ds_read_b64_tr_b16 a[224:225], v232 offset:16384
  ds_read_b64_tr_b16 a[226:227], v233 offset:18432
  ds_read_b64_tr_b16 a[228:229], v234 offset:16384
  ds_read_b64_tr_b16 a[230:231], v235 offset:18432
  v_mfma_f32_32x32x16_bf16 v[32:47], a[240:243], v[160:163], v[32:47]
  v_add_f32 v248, v248, v98
  v_exp_f32 v100, v100
  v_add_f32 v248, v248, v99
  v_cvt_pk_bf16_f32 v97, v98, v99
  v_mfma_f32_32x32x16_bf16 v[48:63], a[240:243], a[208:211], v[48:63]
  buffer_load_dwordx4 v254, s[28:31], s47 offen offset:2048 nt lds
  v_exp_f32 v101, v101
  v_add_f32 v248, v248, v100
  v_mfma_f32_32x32x16_bf16 v[16:31], a[244:247], v[132:135], v[16:31]
  v_exp_f32 v102, v102
  v_add_f32 v248, v248, v101
  v_cvt_pk_bf16_f32 v98, v100, v101
  v_exp_f32 v103, v103
  v_add_f32 v248, v248, v102
  v_mfma_f32_32x32x16_bf16 v[32:47], a[244:247], v[164:167], v[32:47]
  v_exp_f32 v104, v104
  v_add_f32 v248, v248, v103
  v_cvt_pk_bf16_f32 v99, v102, v103
  v_exp_f32 v105, v105
  v_mfma_f32_32x32x16_bf16 v[48:63], a[244:247], a[212:215], v[48:63]
  v_add_f32 v248, v248, v104
  v_exp_f32 v106, v106
  v_add_f32 v248, v248, v105
  s_waitcnt lgkmcnt(4)
  v_mfma_f32_32x32x16_bf16 v[16:31], a[248:251], v[136:139], v[16:31]
  ds_read_b64_tr_b16 a[232:233], v236 offset:16384
  ds_read_b64_tr_b16 a[234:235], v237 offset:18432
  ds_read_b64_tr_b16 a[236:237], v238 offset:16384
  ds_read_b64_tr_b16 a[238:239], v239 offset:18432
  v_mfma_f32_32x32x16_bf16 v[32:47], a[248:251], v[168:171], v[32:47]
  v_cvt_pk_bf16_f32 v100, v104, v105
  v_exp_f32 v107, v107
  v_add_f32 v248, v248, v106
  v_exp_f32 v108, v108
  v_mfma_f32_32x32x16_bf16 v[48:63], a[248:251], a[216:219], v[48:63]
  buffer_load_dwordx4 v255, s[28:31], s47 offen offset:3072 nt lds
  v_add_f32 v248, v248, v107
  v_cvt_pk_bf16_f32 v101, v106, v107
  v_mfma_f32_32x32x16_bf16 v[16:31], a[252:255], v[140:143], v[16:31]
  v_exp_f32 v109, v109
  v_add_f32 v248, v248, v108
  v_exp_f32 v110, v110
  v_add_f32 v248, v248, v109
  v_mfma_f32_32x32x16_bf16 v[32:47], a[252:255], v[172:175], v[32:47]
  v_cvt_pk_bf16_f32 v102, v108, v109
  v_exp_f32 v111, v111
  v_add_f32 v248, v248, v110
  v_add_f32 v248, v248, v111
  v_cvt_pk_bf16_f32 v103, v110, v111
  v_mfma_f32_32x32x16_bf16 v[48:63], a[252:255], a[220:223], v[48:63]
  s_cmp_eq_u32 s52, 0
  s_cbranch_scc0 L_attn_rs1
L_attn_rsret1:
  s_waitcnt lgkmcnt(4)
  v_mfma_f32_32x32x16_bf16 a[0:15], a[224:227], v[64:67], a[0:15]
  ds_read_b64_tr_b16 a[240:241], v232 offset:20480
  ds_read_b64_tr_b16 a[242:243], v233 offset:22528
  ds_read_b64_tr_b16 a[244:245], v234 offset:20480
  ds_read_b64_tr_b16 a[246:247], v235 offset:22528
  v_mfma_f32_32x32x16_bf16 a[64:79], a[224:227], v[80:83], a[64:79]
  v_max3_f32 v249, v16, v17, v18
  v_max3_f32 v250, v19, v20, v21
  v_max3_f32 v249, v249, v22, v23
  v_max3_f32 v250, v250, v24, v25
  v_max3_f32 v249, v249, v26, v27
  v_mfma_f32_32x32x16_bf16 a[128:143], a[224:227], v[96:99], a[128:143]
  s_add_u32 m0, s46, 114688
  s_add_u32 s47, s46, 49152
  buffer_load_dwordx4 v252, s[32:35], s47 offen nt lds
  v_max3_f32 v250, v250, v28, v29
  v_mfma_f32_32x32x16_bf16 a[16:31], a[228:231], v[64:67], a[16:31]
  v_max3_f32 v249, v249, v30, v31
  v_max3_f32 v250, v250, v32, v33
  v_max3_f32 v249, v249, v34, v35
  v_max3_f32 v250, v250, v36, v37
  v_max3_f32 v249, v249, v38, v39
  v_mfma_f32_32x32x16_bf16 a[80:95], a[228:231], v[80:83], a[80:95]
  v_max3_f32 v250, v250, v40, v41
  v_max3_f32 v249, v249, v42, v43
  v_max3_f32 v250, v250, v44, v45
  v_max3_f32 v249, v249, v46, v47
  v_max3_f32 v250, v250, v48, v49
  v_max3_f32 v249, v249, v50, v51
  v_mfma_f32_32x32x16_bf16 a[144:159], a[228:231], v[96:99], a[144:159]
  v_max3_f32 v250, v250, v52, v53
  v_max3_f32 v249, v249, v54, v55
  v_max3_f32 v250, v250, v56, v57
  v_max3_f32 v249, v249, v58, v59
  v_max3_f32 v250, v250, v60, v61
  s_waitcnt lgkmcnt(4)
  v_mfma_f32_32x32x16_bf16 a[32:47], a[232:235], v[64:67], a[32:47]
  ds_read_b64_tr_b16 a[248:249], v236 offset:20480
  ds_read_b64_tr_b16 a[250:251], v237 offset:22528
  ds_read_b64_tr_b16 a[252:253], v238 offset:20480
  ds_read_b64_tr_b16 a[254:255], v239 offset:22528
  v_mfma_f32_32x32x16_bf16 a[96:111], a[232:235], v[80:83], a[96:111]
  v_max3_f32 v249, v249, v62, v63
  v_max_f32 v249, v249, v250
  v_cmp_lt_f32 vcc, 1090519040, v249
  s_cbranch_vccnz L_attn_rare2
L_attn_ret2:
  v_mfma_f32_32x32x16_bf16 a[160:175], a[232:235], v[96:99], a[160:175]
  buffer_load_dwordx4 v253, s[32:35], s47 offen offset:1024 nt lds
  v_exp_f32 v16, v16
  v_exp_f32 v17, v17
  v_mfma_f32_32x32x16_bf16 a[48:63], a[236:239], v[64:67], a[48:63]
  v_add_f32 v246, v246, v16
  v_exp_f32 v18, v18
  v_add_f32 v246, v246, v17
  v_cvt_pk_bf16_f32 v16, v16, v17
  v_mfma_f32_32x32x16_bf16 a[112:127], a[236:239], v[80:83], a[112:127]
  v_exp_f32 v19, v19
  v_add_f32 v246, v246, v18
  v_exp_f32 v20, v20
  v_add_f32 v246, v246, v19
  v_mfma_f32_32x32x16_bf16 a[176:191], a[236:239], v[96:99], a[176:191]
  v_cvt_pk_bf16_f32 v17, v18, v19
  v_exp_f32 v21, v21
  v_add_f32 v246, v246, v20
  s_waitcnt lgkmcnt(4)
  v_mfma_f32_32x32x16_bf16 a[0:15], a[240:243], v[68:71], a[0:15]
  s_waitcnt vmcnt(10)
  s_barrier
  ds_read_b128 a[224:227], v224
  ds_read_b128 a[228:231], v225
  v_mfma_f32_32x32x16_bf16 a[64:79], a[240:243], v[84:87], a[64:79]
  v_exp_f32 v22, v22
  v_add_f32 v246, v246, v21
  v_cvt_pk_bf16_f32 v18, v20, v21
  v_exp_f32 v23, v23
  v_add_f32 v246, v246, v22
  v_mfma_f32_32x32x16_bf16 a[128:143], a[240:243], v[100:103], a[128:143]
  buffer_load_dwordx4 v254, s[32:35], s47 offen offset:2048 nt lds
  v_exp_f32 v24, v24
  v_add_f32 v246, v246, v23
  v_mfma_f32_32x32x16_bf16 a[16:31], a[244:247], v[68:71], a[16:31]
  v_cvt_pk_bf16_f32 v19, v22, v23
  v_exp_f32 v25, v25
  v_add_f32 v246, v246, v24
  v_exp_f32 v26, v26
  v_mfma_f32_32x32x16_bf16 a[80:95], a[244:247], v[84:87], a[80:95]
  v_add_f32 v246, v246, v25
  v_cvt_pk_bf16_f32 v20, v24, v25
  v_exp_f32 v27, v27
  v_add_f32 v246, v246, v26
  v_mfma_f32_32x32x16_bf16 a[144:159], a[244:247], v[100:103], a[144:159]
  v_exp_f32 v28, v28
  v_add_f32 v246, v246, v27
  v_cvt_pk_bf16_f32 v21, v26, v27
  s_waitcnt lgkmcnt(2)
  v_mfma_f32_32x32x16_bf16 a[32:47], a[248:251], v[68:71], a[32:47]
  ds_read_b128 a[232:235], v226
  ds_read_b128 a[236:239], v227
  v_exp_f32 v29, v29
  v_add_f32 v246, v246, v28
  v_mfma_f32_32x32x16_bf16 a[96:111], a[248:251], v[84:87], a[96:111]
  v_exp_f32 v30, v30
  v_add_f32 v246, v246, v29
  v_cvt_pk_bf16_f32 v22, v28, v29
  v_exp_f32 v31, v31
  v_mfma_f32_32x32x16_bf16 a[160:175], a[248:251], v[100:103], a[160:175]
  buffer_load_dwordx4 v255, s[32:35], s47 offen offset:3072 nt lds
  v_add_f32 v246, v246, v30
  v_add_f32 v246, v246, v31
  v_mfma_f32_32x32x16_bf16 a[48:63], a[252:255], v[68:71], a[48:63]
  v_cvt_pk_bf16_f32 v23, v30, v31
  v_exp_f32 v32, v32
  v_exp_f32 v33, v33
  v_add_f32 v247, v247, v32
  v_mfma_f32_32x32x16_bf16 a[112:127], a[252:255], v[84:87], a[112:127]
  v_exp_f32 v34, v34
  v_add_f32 v247, v247, v33
  v_cvt_pk_bf16_f32 v32, v32, v33
  v_exp_f32 v35, v35
  v_mfma_f32_32x32x16_bf16 a[176:191], a[252:255], v[100:103], a[176:191]
  v_add_f32 v247, v247, v34
  v_exp_f32 v36, v36
  v_add_f32 v247, v247, v35
  v_cvt_pk_bf16_f32 v33, v34, v35
  s_waitcnt lgkmcnt(2)
  v_mfma_f32_32x32x16_bf16 v[64:79], a[224:227], v[112:115], v[176:191]
  ds_read_b128 a[240:243], v228
  ds_read_b128 a[244:247], v229
  v_exp_f32 v37, v37
  v_mfma_f32_32x32x16_bf16 v[80:95], a[224:227], v[144:147], v[192:207]
  v_add_f32 v247, v247, v36
  v_exp_f32 v38, v38
  v_add_f32 v247, v247, v37
  v_cvt_pk_bf16_f32 v34, v36, v37
  v_mfma_f32_32x32x16_bf16 v[96:111], a[224:227], a[192:195], v[208:223]
  s_add_u32 m0, s46, 32768
  s_add_u32 s47, s46, 81920
  buffer_load_dwordx4 v252, s[28:31], s47 offen nt lds
  v_exp_f32 v39, v39
  v_mfma_f32_32x32x16_bf16 v[64:79], a[228:231], v[116:119], v[64:79]
  v_add_f32 v247, v247, v38
  v_exp_f32 v40, v40
  v_add_f32 v247, v247, v39
  v_cvt_pk_bf16_f32 v35, v38, v39
  v_mfma_f32_32x32x16_bf16 v[80:95], a[228:231], v[148:151], v[80:95]
  v_exp_f32 v41, v41
  v_add_f32 v247, v247, v40
  v_exp_f32 v42, v42
  v_add_f32 v247, v247, v41
  v_mfma_f32_32x32x16_bf16 v[96:111], a[228:231], a[196:199], v[96:111]
  v_cvt_pk_bf16_f32 v36, v40, v41
  v_exp_f32 v43, v43
  v_add_f32 v247, v247, v42
  s_waitcnt lgkmcnt(2)
  v_mfma_f32_32x32x16_bf16 v[64:79], a[232:235], v[120:123], v[64:79]
  ds_read_b128 a[248:251], v230
  ds_read_b128 a[252:255], v231
  v_exp_f32 v44, v44
  v_mfma_f32_32x32x16_bf16 v[80:95], a[232:235], v[152:155], v[80:95]
  v_add_f32 v247, v247, v43
  v_cvt_pk_bf16_f32 v37, v42, v43
  v_exp_f32 v45, v45
  v_add_f32 v247, v247, v44
  v_exp_f32 v46, v46
  v_mfma_f32_32x32x16_bf16 v[96:111], a[232:235], a[200:203], v[96:111]
  buffer_load_dwordx4 v253, s[28:31], s47 offen offset:1024 nt lds
  v_add_f32 v247, v247, v45
  v_cvt_pk_bf16_f32 v38, v44, v45
  v_mfma_f32_32x32x16_bf16 v[64:79], a[236:239], v[124:127], v[64:79]
  v_exp_f32 v47, v47
  v_add_f32 v247, v247, v46
  v_add_f32 v247, v247, v47
  v_cvt_pk_bf16_f32 v39, v46, v47
  v_mfma_f32_32x32x16_bf16 v[80:95], a[236:239], v[156:159], v[80:95]
  v_exp_f32 v48, v48
  v_exp_f32 v49, v49
  v_add_f32 v248, v248, v48
  v_exp_f32 v50, v50
  v_mfma_f32_32x32x16_bf16 v[96:111], a[236:239], a[204:207], v[96:111]
  v_add_f32 v248, v248, v49
  v_cvt_pk_bf16_f32 v48, v48, v49
  v_exp_f32 v51, v51
  s_waitcnt lgkmcnt(2)
  v_mfma_f32_32x32x16_bf16 v[64:79], a[240:243], v[128:131], v[64:79]
  s_waitcnt vmcnt(10)
  s_barrier
  ds_read_b64_tr_b16 a[224:225], v232 offset:32768
  ds_read_b64_tr_b16 a[226:227], v233 offset:34816
  ds_read_b64_tr_b16 a[228:229], v234 offset:32768
  ds_read_b64_tr_b16 a[230:231], v235 offset:34816
  v_mfma_f32_32x32x16_bf16 v[80:95], a[240:243], v[160:163], v[80:95]
  v_add_f32 v248, v248, v50
  v_exp_f32 v52, v52
  v_add_f32 v248, v248, v51
  v_cvt_pk_bf16_f32 v49, v50, v51
  v_mfma_f32_32x32x16_bf16 v[96:111], a[240:243], a[208:211], v[96:111]
  buffer_load_dwordx4 v254, s[28:31], s47 offen offset:2048 nt lds
  v_exp_f32 v53, v53
  v_add_f32 v248, v248, v52
  v_mfma_f32_32x32x16_bf16 v[64:79], a[244:247], v[132:135], v[64:79]
  v_exp_f32 v54, v54
  v_add_f32 v248, v248, v53
  v_cvt_pk_bf16_f32 v50, v52, v53
  v_exp_f32 v55, v55
  v_add_f32 v248, v248, v54
  v_mfma_f32_32x32x16_bf16 v[80:95], a[244:247], v[164:167], v[80:95]
  v_exp_f32 v56, v56
  v_add_f32 v248, v248, v55
  v_cvt_pk_bf16_f32 v51, v54, v55
  v_exp_f32 v57, v57
  v_mfma_f32_32x32x16_bf16 v[96:111], a[244:247], a[212:215], v[96:111]
  v_add_f32 v248, v248, v56
  v_exp_f32 v58, v58
  v_add_f32 v248, v248, v57
  s_waitcnt lgkmcnt(4)
  v_mfma_f32_32x32x16_bf16 v[64:79], a[248:251], v[136:139], v[64:79]
  ds_read_b64_tr_b16 a[232:233], v236 offset:32768
  ds_read_b64_tr_b16 a[234:235], v237 offset:34816
  ds_read_b64_tr_b16 a[236:237], v238 offset:32768
  ds_read_b64_tr_b16 a[238:239], v239 offset:34816
  v_mfma_f32_32x32x16_bf16 v[80:95], a[248:251], v[168:171], v[80:95]
  v_cvt_pk_bf16_f32 v52, v56, v57
  v_exp_f32 v59, v59
  v_add_f32 v248, v248, v58
  v_exp_f32 v60, v60
  v_mfma_f32_32x32x16_bf16 v[96:111], a[248:251], a[216:219], v[96:111]
  buffer_load_dwordx4 v255, s[28:31], s47 offen offset:3072 nt lds
  v_add_f32 v248, v248, v59
  v_cvt_pk_bf16_f32 v53, v58, v59
  v_mfma_f32_32x32x16_bf16 v[64:79], a[252:255], v[140:143], v[64:79]
  v_exp_f32 v61, v61
  v_add_f32 v248, v248, v60
  v_exp_f32 v62, v62
  v_add_f32 v248, v248, v61
  v_mfma_f32_32x32x16_bf16 v[80:95], a[252:255], v[172:175], v[80:95]
  v_cvt_pk_bf16_f32 v54, v60, v61
  v_exp_f32 v63, v63
  v_add_f32 v248, v248, v62
  v_add_f32 v248, v248, v63
  v_cvt_pk_bf16_f32 v55, v62, v63
  v_mfma_f32_32x32x16_bf16 v[96:111], a[252:255], a[220:223], v[96:111]
  s_cmp_eq_u32 s52, 0
  s_cbranch_scc0 L_attn_rs2
L_attn_rsret2:
  s_waitcnt lgkmcnt(4)
  v_mfma_f32_32x32x16_bf16 a[0:15], a[224:227], v[16:19], a[0:15]
  ds_read_b64_tr_b16 a[240:241], v232 offset:36864
  ds_read_b64_tr_b16 a[242:243], v233 offset:38912
  ds_read_b64_tr_b16 a[244:245], v234 offset:36864
  ds_read_b64_tr_b16 a[246:247], v235 offset:38912
  v_mfma_f32_32x32x16_bf16 a[64:79], a[224:227], v[32:35], a[64:79]
  v_max3_f32 v249, v64, v65, v66
  v_max3_f32 v250, v67, v68, v69
  v_max3_f32 v249, v249, v70, v71
  v_max3_f32 v250, v250, v72, v73
  v_max3_f32 v249, v249, v74, v75
  v_mfma_f32_32x32x16_bf16 a[128:143], a[224:227], v[48:51], a[128:143]
  s_add_u32 m0, s46, 65536
  s_add_u32 s47, s46, 65536
  buffer_load_dwordx4 v252, s[32:35], s47 offen nt lds
  v_max3_f32 v250, v250, v76, v77
  v_mfma_f32_32x32x16_bf16 a[16:31], a[228:231], v[16:19], a[16:31]
  v_max3_f32 v249, v249, v78, v79
  v_max3_f32 v250, v250, v80, v81
  v_max3_f32 v249, v249, v82, v83
  v_max3_f32 v250, v250, v84, v85
  v_max3_f32 v249, v249, v86, v87
  v_mfma_f32_32x32x16_bf16 a[80:95], a[228:231], v[32:35], a[80:95]
  v_max3_f32 v250, v250, v88, v89
  v_max3_f32 v249, v249, v90, v91
  v_max3_f32 v250, v250, v92, v93
  v_max3_f32 v249, v249, v94, v95
  v_max3_f32 v250, v250, v96, v97
  v_max3_f32 v249, v249, v98, v99
  v_mfma_f32_32x32x16_bf16 a[144:159], a[228:231], v[48:51], a[144:159]
  v_max3_f32 v250, v250, v100, v101
  v_max3_f32 v249, v249, v102, v103
  v_max3_f32 v250, v250, v104, v105
  v_max3_f32 v249, v249, v106, v107
  v_max3_f32 v250, v250, v108, v109
  s_waitcnt lgkmcnt(4)
  v_mfma_f32_32x32x16_bf16 a[32:47], a[232:235], v[16:19], a[32:47]
  ds_read_b64_tr_b16 a[248:249], v236 offset:36864
  ds_read_b64_tr_b16 a[250:251], v237 offset:38912
  ds_read_b64_tr_b16 a[252:253], v238 offset:36864
  ds_read_b64_tr_b16 a[254:255], v239 offset:38912
  v_mfma_f32_32x32x16_bf16 a[96:111], a[232:235], v[32:35], a[96:111]
  v_max3_f32 v249, v249, v110, v111
  v_max_f32 v249, v249, v250
  v_cmp_lt_f32 vcc, 1090519040, v249
  s_cbranch_vccnz L_attn_rare3
L_attn_ret3:
  v_mfma_f32_32x32x16_bf16 a[160:175], a[232:235], v[48:51], a[160:175]
  buffer_load_dwordx4 v253, s[32:35], s47 offen offset:1024 nt lds
  v_exp_f32 v64, v64
  v_exp_f32 v65, v65
  v_mfma_f32_32x32x16_bf16 a[48:63], a[236:239], v[16:19], a[48:63]
  v_add_f32 v246, v246, v64
  v_exp_f32 v66, v66
  v_add_f32 v246, v246, v65
  v_cvt_pk_bf16_f32 v64, v64, v65
  v_mfma_f32_32x32x16_bf16 a[112:127], a[236:239], v[32:35], a[112:127]
  v_exp_f32 v67, v67
  v_add_f32 v246, v246, v66
  v_exp_f32 v68, v68
  v_add_f32 v246, v246, v67
  v_mfma_f32_32x32x16_bf16 a[176:191], a[236:239], v[48:51], a[176:191]
  v_cvt_pk_bf16_f32 v65, v66, v67
  v_exp_f32 v69, v69
  v_add_f32 v246, v246, v68
  s_waitcnt lgkmcnt(4)
  v_mfma_f32_32x32x16_bf16 a[0:15], a[240:243], v[20:23], a[0:15]
  s_waitcnt vmcnt(10)
  s_barrier
  ds_read_b128 a[224:227], v224 offset:16384
  ds_read_b128 a[228:231], v225 offset:16384
  v_mfma_f32_32x32x16_bf16 a[64:79], a[240:243], v[36:39], a[64:79]
  v_exp_f32 v70, v70
  v_add_f32 v246, v246, v69
  v_cvt_pk_bf16_f32 v66, v68, v69
  v_exp_f32 v71, v71
  v_add_f32 v246, v246, v70
  v_mfma_f32_32x32x16_bf16 a[128:143], a[240:243], v[52:55], a[128:143]
  buffer_load_dwordx4 v254, s[32:35], s47 offen offset:2048 nt lds
  v_exp_f32 v72, v72
  v_add_f32 v246, v246, v71
  v_mfma_f32_32x32x16_bf16 a[16:31], a[244:247], v[20:23], a[16:31]
  v_cvt_pk_bf16_f32 v67, v70, v71
  v_exp_f32 v73, v73
  v_add_f32 v246, v246, v72
  v_exp_f32 v74, v74
  v_mfma_f32_32x32x16_bf16 a[80:95], a[244:247], v[36:39], a[80:95]
  v_add_f32 v246, v246, v73
  v_cvt_pk_bf16_f32 v68, v72, v73
  v_exp_f32 v75, v75
  v_add_f32 v246, v246, v74
  v_mfma_f32_32x32x16_bf16 a[144:159], a[244:247], v[52:55], a[144:159]
  v_exp_f32 v76, v76
  v_add_f32 v246, v246, v75
  v_cvt_pk_bf16_f32 v69, v74, v75
  s_waitcnt lgkmcnt(2)
  v_mfma_f32_32x32x16_bf16 a[32:47], a[248:251], v[20:23], a[32:47]
  ds_read_b128 a[232:235], v226 offset:16384
  ds_read_b128 a[236:239], v227 offset:16384
  v_exp_f32 v77, v77
  v_add_f32 v246, v246, v76
  v_mfma_f32_32x32x16_bf16 a[96:111], a[248:251], v[36:39], a[96:111]
  v_exp_f32 v78, v78
  v_add_f32 v246, v246, v77
  v_cvt_pk_bf16_f32 v70, v76, v77
  v_exp_f32 v79, v79
  v_mfma_f32_32x32x16_bf16 a[160:175], a[248:251], v[52:55], a[160:175]
  buffer_load_dwordx4 v255, s[32:35], s47 offen offset:3072 nt lds
  v_add_f32 v246, v246, v78
  v_add_f32 v246, v246, v79
  v_mfma_f32_32x32x16_bf16 a[48:63], a[252:255], v[20:23], a[48:63]
  v_cvt_pk_bf16_f32 v71, v78, v79
  v_exp_f32 v80, v80
  v_exp_f32 v81, v81
  v_add_f32 v247, v247, v80
  v_mfma_f32_32x32x16_bf16 a[112:127], a[252:255], v[36:39], a[112:127]
  v_exp_f32 v82, v82
  v_add_f32 v247, v247, v81
  v_cvt_pk_bf16_f32 v80, v80, v81
  v_exp_f32 v83, v83
  v_mfma_f32_32x32x16_bf16 a[176:191], a[252:255], v[52:55], a[176:191]
  v_add_f32 v247, v247, v82
  v_exp_f32 v84, v84
  v_add_f32 v247, v247, v83
  v_cvt_pk_bf16_f32 v81, v82, v83
  s_waitcnt lgkmcnt(2)
  v_mfma_f32_32x32x16_bf16 v[16:31], a[224:227], v[112:115], v[176:191]
  ds_read_b128 a[240:243], v228 offset:16384
  ds_read_b128 a[244:247], v229 offset:16384
  v_exp_f32 v85, v85
  v_mfma_f32_32x32x16_bf16 v[32:47], a[224:227], v[144:147], v[192:207]
  v_add_f32 v247, v247, v84
  v_exp_f32 v86, v86
  v_add_f32 v247, v247, v85
  v_cvt_pk_bf16_f32 v82, v84, v85
  v_mfma_f32_32x32x16_bf16 v[48:63], a[224:227], a[192:195], v[208:223]
  s_add_u32 m0, s46, 49152
  s_add_u32 s47, s46, 98304
  buffer_load_dwordx4 v252, s[28:31], s47 offen nt lds
  v_exp_f32 v87, v87
  v_mfma_f32_32x32x16_bf16 v[16:31], a[228:231], v[116:119], v[16:31]
  v_add_f32 v247, v247, v86
  v_exp_f32 v88, v88
  v_add_f32 v247, v247, v87
  v_cvt_pk_bf16_f32 v83, v86, v87
  v_mfma_f32_32x32x16_bf16 v[32:47], a[228:231], v[148:151], v[32:47]
  v_exp_f32 v89, v89
  v_add_f32 v247, v247, v88
  v_exp_f32 v90, v90
  v_add_f32 v247, v247, v89
  v_mfma_f32_32x32x16_bf16 v[48:63], a[228:231], a[196:199], v[48:63]
  v_cvt_pk_bf16_f32 v84, v88, v89
  v_exp_f32 v91, v91
  v_add_f32 v247, v247, v90
  s_waitcnt lgkmcnt(2)
  v_mfma_f32_32x32x16_bf16 v[16:31], a[232:235], v[120:123], v[16:31]
  ds_read_b128 a[248:251], v230 offset:16384
  ds_read_b128 a[252:255], v231 offset:16384
  v_exp_f32 v92, v92
  v_mfma_f32_32x32x16_bf16 v[32:47], a[232:235], v[152:155], v[32:47]
  v_add_f32 v247, v247, v91
  v_cvt_pk_bf16_f32 v85, v90, v91
  v_exp_f32 v93, v93
  v_add_f32 v247, v247, v92
  v_exp_f32 v94, v94
  v_mfma_f32_32x32x16_bf16 v[48:63], a[232:235], a[200:203], v[48:63]
  buffer_load_dwordx4 v253, s[28:31], s47 offen offset:1024 nt lds
  v_add_f32 v247, v247, v93
  v_cvt_pk_bf16_f32 v86, v92, v93
  v_mfma_f32_32x32x16_bf16 v[16:31], a[236:239], v[124:127], v[16:31]
  v_exp_f32 v95, v95
  v_add_f32 v247, v247, v94
  v_add_f32 v247, v247, v95
  v_cvt_pk_bf16_f32 v87, v94, v95
  v_mfma_f32_32x32x16_bf16 v[32:47], a[236:239], v[156:159], v[32:47]
  v_exp_f32 v96, v96
  v_exp_f32 v97, v97
  v_add_f32 v248, v248, v96
  v_exp_f32 v98, v98
  v_mfma_f32_32x32x16_bf16 v[48:63], a[236:239], a[204:207], v[48:63]
  v_add_f32 v248, v248, v97
  v_cvt_pk_bf16_f32 v96, v96, v97
  v_exp_f32 v99, v99
  s_waitcnt lgkmcnt(2)
  v_mfma_f32_32x32x16_bf16 v[16:31], a[240:243], v[128:131], v[16:31]
  s_waitcnt vmcnt(10)
  s_barrier
  ds_read_b64_tr_b16 a[224:225], v232 offset:49152
  ds_read_b64_tr_b16 a[226:227], v233 offset:51200
  ds_read_b64_tr_b16 a[228:229], v234 offset:49152
  ds_read_b64_tr_b16 a[230:231], v235 offset:51200
  v_mfma_f32_32x32x16_bf16 v[32:47], a[240:243], v[160:163], v[32:47]
  v_add_f32 v248, v248, v98
  v_exp_f32 v100, v100
  v_add_f32 v248, v248, v99
  v_cvt_pk_bf16_f32 v97, v98, v99
  v_mfma_f32_32x32x16_bf16 v[48:63], a[240:243], a[208:211], v[48:63]
  buffer_load_dwordx4 v254, s[28:31], s47 offen offset:2048 nt lds
  v_exp_f32 v101, v101
  v_add_f32 v248, v248, v100
  v_mfma_f32_32x32x16_bf16 v[16:31], a[244:247], v[132:135], v[16:31]
  v_exp_f32 v102, v102
  v_add_f32 v248, v248, v101
  v_cvt_pk_bf16_f32 v98, v100, v101
  v_exp_f32 v103, v103
  v_add_f32 v248, v248, v102
  v_mfma_f32_32x32x16_bf16 v[32:47], a[244:247], v[164:167], v[32:47]
  v_exp_f32 v104, v104
  v_add_f32 v248, v248, v103
  v_cvt_pk_bf16_f32 v99, v102, v103
  v_exp_f32 v105, v105
  v_mfma_f32_32x32x16_bf16 v[48:63], a[244:247], a[212:215], v[48:63]
  v_add_f32 v248, v248, v104
  v_exp_f32 v106, v106
  v_add_f32 v248, v248, v105
  s_waitcnt lgkmcnt(4)
  v_mfma_f32_32x32x16_bf16 v[16:31], a[248:251], v[136:139], v[16:31]
  ds_read_b64_tr_b16 a[232:233], v236 offset:49152
  ds_read_b64_tr_b16 a[234:235], v237 offset:51200
  ds_read_b64_tr_b16 a[236:237], v238 offset:49152
  ds_read_b64_tr_b16 a[238:239], v239 offset:51200
  v_mfma_f32_32x32x16_bf16 v[32:47], a[248:251], v[168:171], v[32:47]
  v_cvt_pk_bf16_f32 v100, v104, v105
  v_exp_f32 v107, v107
  v_add_f32 v248, v248, v106
  v_exp_f32 v108, v108
  v_mfma_f32_32x32x16_bf16 v[48:63], a[248:251], a[216:219], v[48:63]
  buffer_load_dwordx4 v255, s[28:31], s47 offen offset:3072 nt lds
  v_add_f32 v248, v248, v107
  v_cvt_pk_bf16_f32 v101, v106, v107
  v_mfma_f32_32x32x16_bf16 v[16:31], a[252:255], v[140:143], v[16:31]
  v_exp_f32 v109, v109
  v_add_f32 v248, v248, v108
  v_exp_f32 v110, v110
  v_add_f32 v248, v248, v109
  v_mfma_f32_32x32x16_bf16 v[32:47], a[252:255], v[172:175], v[32:47]
  v_cvt_pk_bf16_f32 v102, v108, v109
  v_exp_f32 v111, v111
  v_add_f32 v248, v248, v110
  v_add_f32 v248, v248, v111
  v_cvt_pk_bf16_f32 v103, v110, v111
  v_mfma_f32_32x32x16_bf16 v[48:63], a[252:255], a[220:223], v[48:63]
  s_cmp_eq_u32 s52, 0
  s_cbranch_scc0 L_attn_rs3
L_attn_rsret3:
  s_waitcnt lgkmcnt(4)
  v_mfma_f32_32x32x16_bf16 a[0:15], a[224:227], v[64:67], a[0:15]
  ds_read_b64_tr_b16 a[240:241], v232 offset:53248
  ds_read_b64_tr_b16 a[242:243], v233 offset:55296
  ds_read_b64_tr_b16 a[244:245], v234 offset:53248
  ds_read_b64_tr_b16 a[246:247], v235 offset:55296
  v_mfma_f32_32x32x16_bf16 a[64:79], a[224:227], v[80:83], a[64:79]
  v_max3_f32 v249, v16, v17, v18
  v_max3_f32 v250, v19, v20, v21
  v_max3_f32 v249, v249, v22, v23
  v_max3_f32 v250, v250, v24, v25
  v_max3_f32 v249, v249, v26, v27
  v_mfma_f32_32x32x16_bf16 a[128:143], a[224:227], v[96:99], a[128:143]
  s_add_u32 m0, s46, 81920
  s_add_u32 s47, s46, 81920
  buffer_load_dwordx4 v252, s[32:35], s47 offen nt lds
  v_max3_f32 v250, v250, v28, v29
  v_mfma_f32_32x32x16_bf16 a[16:31], a[228:231], v[64:67], a[16:31]
  v_max3_f32 v249, v249, v30, v31
  v_max3_f32 v250, v250, v32, v33
  v_max3_f32 v249, v249, v34, v35
  v_max3_f32 v250, v250, v36, v37
  v_max3_f32 v249, v249, v38, v39
  v_mfma_f32_32x32x16_bf16 a[80:95], a[228:231], v[80:83], a[80:95]
  v_max3_f32 v250, v250, v40, v41
  v_max3_f32 v249, v249, v42, v43
  v_max3_f32 v250, v250, v44, v45
  v_max3_f32 v249, v249, v46, v47
  v_max3_f32 v250, v250, v48, v49
  v_max3_f32 v249, v249, v50, v51
  v_mfma_f32_32x32x16_bf16 a[144:159], a[228:231], v[96:99], a[144:159]
  v_max3_f32 v250, v250, v52, v53
  v_max3_f32 v249, v249, v54, v55
  v_max3_f32 v250, v250, v56, v57
  v_max3_f32 v249, v249, v58, v59
  v_max3_f32 v250, v250, v60, v61
  s_waitcnt lgkmcnt(4)
  v_mfma_f32_32x32x16_bf16 a[32:47], a[232:235], v[64:67], a[32:47]
  ds_read_b64_tr_b16 a[248:249], v236 offset:53248
  ds_read_b64_tr_b16 a[250:251], v237 offset:55296
  ds_read_b64_tr_b16 a[252:253], v238 offset:53248
  ds_read_b64_tr_b16 a[254:255], v239 offset:55296
  v_mfma_f32_32x32x16_bf16 a[96:111], a[232:235], v[80:83], a[96:111]
  v_max3_f32 v249, v249, v62, v63
  v_max_f32 v249, v249, v250
  v_cmp_lt_f32 vcc, 1090519040, v249
  s_cbranch_vccnz L_attn_rare4
L_attn_ret4:
  v_mfma_f32_32x32x16_bf16 a[160:175], a[232:235], v[96:99], a[160:175]
  buffer_load_dwordx4 v253, s[32:35], s47 offen offset:1024 nt lds
  v_exp_f32 v16, v16
  v_exp_f32 v17, v17
  v_mfma_f32_32x32x16_bf16 a[48:63], a[236:239], v[64:67], a[48:63]
  v_add_f32 v246, v246, v16
  v_exp_f32 v18, v18
  v_add_f32 v246, v246, v17
  v_cvt_pk_bf16_f32 v16, v16, v17
  v_mfma_f32_32x32x16_bf16 a[112:127], a[236:239], v[80:83], a[112:127]
  v_exp_f32 v19, v19
  v_add_f32 v246, v246, v18
  v_exp_f32 v20, v20
  v_add_f32 v246, v246, v19
  v_mfma_f32_32x32x16_bf16 a[176:191], a[236:239], v[96:99], a[176:191]
  v_cvt_pk_bf16_f32 v17, v18, v19
  v_exp_f32 v21, v21
  v_add_f32 v246, v246, v20
  s_waitcnt lgkmcnt(4)
  v_mfma_f32_32x32x16_bf16 a[0:15], a[240:243], v[68:71], a[0:15]
  s_waitcnt vmcnt(10)
  s_barrier
  ds_read_b128 a[224:227], v224 offset:32768
  ds_read_b128 a[228:231], v225 offset:32768
  v_mfma_f32_32x32x16_bf16 a[64:79], a[240:243], v[84:87], a[64:79]
  v_exp_f32 v22, v22
  v_add_f32 v246, v246, v21
  v_cvt_pk_bf16_f32 v18, v20, v21
  v_exp_f32 v23, v23
  v_add_f32 v246, v246, v22
  v_mfma_f32_32x32x16_bf16 a[128:143], a[240:243], v[100:103], a[128:143]
  buffer_load_dwordx4 v254, s[32:35], s47 offen offset:2048 nt lds
  v_exp_f32 v24, v24
  v_add_f32 v246, v246, v23
  v_mfma_f32_32x32x16_bf16 a[16:31], a[244:247], v[68:71], a[16:31]
  v_cvt_pk_bf16_f32 v19, v22, v23
  v_exp_f32 v25, v25
  v_add_f32 v246, v246, v24
  v_exp_f32 v26, v26
  v_mfma_f32_32x32x16_bf16 a[80:95], a[244:247], v[84:87], a[80:95]
  v_add_f32 v246, v246, v25
  v_cvt_pk_bf16_f32 v20, v24, v25
  v_exp_f32 v27, v27
  v_add_f32 v246, v246, v26
  v_mfma_f32_32x32x16_bf16 a[144:159], a[244:247], v[100:103], a[144:159]
  v_exp_f32 v28, v28
  v_add_f32 v246, v246, v27
  v_cvt_pk_bf16_f32 v21, v26, v27
  s_waitcnt lgkmcnt(2)
  v_mfma_f32_32x32x16_bf16 a[32:47], a[248:251], v[68:71], a[32:47]
  ds_read_b128 a[232:235], v226 offset:32768
  ds_read_b128 a[236:239], v227 offset:32768
  v_exp_f32 v29, v29
  v_add_f32 v246, v246, v28
  v_mfma_f32_32x32x16_bf16 a[96:111], a[248:251], v[84:87], a[96:111]
  v_exp_f32 v30, v30
  v_add_f32 v246, v246, v29
  v_cvt_pk_bf16_f32 v22, v28, v29
  v_exp_f32 v31, v31
  v_mfma_f32_32x32x16_bf16 a[160:175], a[248:251], v[100:103], a[160:175]
  buffer_load_dwordx4 v255, s[32:35], s47 offen offset:3072 nt lds
  v_add_f32 v246, v246, v30
  v_add_f32 v246, v246, v31
  v_mfma_f32_32x32x16_bf16 a[48:63], a[252:255], v[68:71], a[48:63]
  v_cvt_pk_bf16_f32 v23, v30, v31
  v_exp_f32 v32, v32
  v_exp_f32 v33, v33
  v_add_f32 v247, v247, v32
  v_mfma_f32_32x32x16_bf16 a[112:127], a[252:255], v[84:87], a[112:127]
  v_exp_f32 v34, v34
  v_add_f32 v247, v247, v33
  v_cvt_pk_bf16_f32 v32, v32, v33
  v_exp_f32 v35, v35
  v_mfma_f32_32x32x16_bf16 a[176:191], a[252:255], v[100:103], a[176:191]
  v_add_f32 v247, v247, v34
  v_exp_f32 v36, v36
  v_add_f32 v247, v247, v35
  v_cvt_pk_bf16_f32 v33, v34, v35
  s_waitcnt lgkmcnt(2)
  v_mfma_f32_32x32x16_bf16 v[64:79], a[224:227], v[112:115], v[176:191]
  ds_read_b128 a[240:243], v228 offset:32768
  ds_read_b128 a[244:247], v229 offset:32768
  v_exp_f32 v37, v37
  v_mfma_f32_32x32x16_bf16 v[80:95], a[224:227], v[144:147], v[192:207]
  v_add_f32 v247, v247, v36
  v_exp_f32 v38, v38
  v_add_f32 v247, v247, v37
  v_cvt_pk_bf16_f32 v34, v36, v37
  v_mfma_f32_32x32x16_bf16 v[96:111], a[224:227], a[192:195], v[208:223]
  s_add_u32 m0, s46, 0
  s_add_u32 s47, s46, 114688
  buffer_load_dwordx4 v252, s[28:31], s47 offen nt lds
  v_exp_f32 v39, v39
  v_mfma_f32_32x32x16_bf16 v[64:79], a[228:231], v[116:119], v[64:79]
  v_add_f32 v247, v247, v38
  v_exp_f32 v40, v40
  v_add_f32 v247, v247, v39
  v_cvt_pk_bf16_f32 v35, v38, v39
  v_mfma_f32_32x32x16_bf16 v[80:95], a[228:231], v[148:151], v[80:95]
  v_exp_f32 v41, v41
  v_add_f32 v247, v247, v40
  v_exp_f32 v42, v42
  v_add_f32 v247, v247, v41
  v_mfma_f32_32x32x16_bf16 v[96:111], a[228:231], a[196:199], v[96:111]
  v_cvt_pk_bf16_f32 v36, v40, v41
  v_exp_f32 v43, v43
  v_add_f32 v247, v247, v42
  s_waitcnt lgkmcnt(2)
  v_mfma_f32_32x32x16_bf16 v[64:79], a[232:235], v[120:123], v[64:79]
  ds_read_b128 a[248:251], v230 offset:32768
  ds_read_b128 a[252:255], v231 offset:32768
  v_exp_f32 v44, v44
  v_mfma_f32_32x32x16_bf16 v[80:95], a[232:235], v[152:155], v[80:95]
  v_add_f32 v247, v247, v43
  v_cvt_pk_bf16_f32 v37, v42, v43
  v_exp_f32 v45, v45
  v_add_f32 v247, v247, v44
  v_exp_f32 v46, v46
  v_mfma_f32_32x32x16_bf16 v[96:111], a[232:235], a[200:203], v[96:111]
  buffer_load_dwordx4 v253, s[28:31], s47 offen offset:1024 nt lds
  v_add_f32 v247, v247, v45
  v_cvt_pk_bf16_f32 v38, v44, v45
  v_mfma_f32_32x32x16_bf16 v[64:79], a[236:239], v[124:127], v[64:79]
  v_exp_f32 v47, v47
  v_add_f32 v247, v247, v46
  v_add_f32 v247, v247, v47
  v_cvt_pk_bf16_f32 v39, v46, v47
  v_mfma_f32_32x32x16_bf16 v[80:95], a[236:239], v[156:159], v[80:95]
  v_exp_f32 v48, v48
  v_exp_f32 v49, v49
  v_add_f32 v248, v248, v48
  v_exp_f32 v50, v50
  v_mfma_f32_32x32x16_bf16 v[96:111], a[236:239], a[204:207], v[96:111]
  v_add_f32 v248, v248, v49
  v_cvt_pk_bf16_f32 v48, v48, v49
  v_exp_f32 v51, v51
  s_waitcnt lgkmcnt(2)
  v_mfma_f32_32x32x16_bf16 v[64:79], a[240:243], v[128:131], v[64:79]
  s_waitcnt vmcnt(10)
  s_barrier
  ds_read_b64_tr_b16 a[224:225], v232
  ds_read_b64_tr_b16 a[226:227], v233 offset:2048
  ds_read_b64_tr_b16 a[228:229], v234
  ds_read_b64_tr_b16 a[230:231], v235 offset:2048
  v_mfma_f32_32x32x16_bf16 v[80:95], a[240:243], v[160:163], v[80:95]
  v_add_f32 v248, v248, v50
  v_exp_f32 v52, v52
  v_add_f32 v248, v248, v51
  v_cvt_pk_bf16_f32 v49, v50, v51
  v_mfma_f32_32x32x16_bf16 v[96:111], a[240:243], a[208:211], v[96:111]
  buffer_load_dwordx4 v254, s[28:31], s47 offen offset:2048 nt lds
  v_exp_f32 v53, v53
  v_add_f32 v248, v248, v52
  v_mfma_f32_32x32x16_bf16 v[64:79], a[244:247], v[132:135], v[64:79]
  v_exp_f32 v54, v54
  v_add_f32 v248, v248, v53
  v_cvt_pk_bf16_f32 v50, v52, v53
  v_exp_f32 v55, v55
  v_add_f32 v248, v248, v54
  v_mfma_f32_32x32x16_bf16 v[80:95], a[244:247], v[164:167], v[80:95]
  v_exp_f32 v56, v56
  v_add_f32 v248, v248, v55
  v_cvt_pk_bf16_f32 v51, v54, v55
  v_exp_f32 v57, v57
  v_mfma_f32_32x32x16_bf16 v[96:111], a[244:247], a[212:215], v[96:111]
  v_add_f32 v248, v248, v56
  v_exp_f32 v58, v58
  v_add_f32 v248, v248, v57
  s_waitcnt lgkmcnt(4)
  v_mfma_f32_32x32x16_bf16 v[64:79], a[248:251], v[136:139], v[64:79]
  ds_read_b64_tr_b16 a[232:233], v236
  ds_read_b64_tr_b16 a[234:235], v237 offset:2048
  ds_read_b64_tr_b16 a[236:237], v238
  ds_read_b64_tr_b16 a[238:239], v239 offset:2048
  v_mfma_f32_32x32x16_bf16 v[80:95], a[248:251], v[168:171], v[80:95]
  v_cvt_pk_bf16_f32 v52, v56, v57
  v_exp_f32 v59, v59
  v_add_f32 v248, v248, v58
  v_exp_f32 v60, v60
  v_mfma_f32_32x32x16_bf16 v[96:111], a[248:251], a[216:219], v[96:111]
  buffer_load_dwordx4 v255, s[28:31], s47 offen offset:3072 nt lds
  v_add_f32 v248, v248, v59
  v_cvt_pk_bf16_f32 v53, v58, v59
  v_mfma_f32_32x32x16_bf16 v[64:79], a[252:255], v[140:143], v[64:79]
  v_exp_f32 v61, v61
  v_add_f32 v248, v248, v60
  v_exp_f32 v62, v62
  v_add_f32 v248, v248, v61
  v_mfma_f32_32x32x16_bf16 v[80:95], a[252:255], v[172:175], v[80:95]
  v_cvt_pk_bf16_f32 v54, v60, v61
  v_exp_f32 v63, v63
  v_add_f32 v248, v248, v62
  v_add_f32 v248, v248, v63
  v_cvt_pk_bf16_f32 v55, v62, v63
  v_mfma_f32_32x32x16_bf16 v[96:111], a[252:255], a[220:223], v[96:111]
  s_cmp_eq_u32 s52, 0
  s_cbranch_scc0 L_attn_rs4
L_attn_rsret4:
  s_waitcnt lgkmcnt(4)
  v_mfma_f32_32x32x16_bf16 a[0:15], a[224:227], v[16:19], a[0:15]
  ds_read_b64_tr_b16 a[240:241], v232 offset:4096
  ds_read_b64_tr_b16 a[242:243], v233 offset:6144
  ds_read_b64_tr_b16 a[244:245], v234 offset:4096
  ds_read_b64_tr_b16 a[246:247], v235 offset:6144
  v_mfma_f32_32x32x16_bf16 a[64:79], a[224:227], v[32:35], a[64:79]
  v_max3_f32 v249, v64, v65, v66
  v_max3_f32 v250, v67, v68, v69
  v_max3_f32 v249, v249, v70, v71
  v_max3_f32 v250, v250, v72, v73
  v_max3_f32 v249, v249, v74, v75
  v_mfma_f32_32x32x16_bf16 a[128:143], a[224:227], v[48:51], a[128:143]
  s_add_u32 m0, s46, 98304
  s_add_u32 s47, s46, 98304
  buffer_load_dwordx4 v252, s[32:35], s47 offen nt lds
  v_max3_f32 v250, v250, v76, v77
  v_mfma_f32_32x32x16_bf16 a[16:31], a[228:231], v[16:19], a[16:31]
  v_max3_f32 v249, v249, v78, v79
  v_max3_f32 v250, v250, v80, v81
  v_max3_f32 v249, v249, v82, v83
  v_max3_f32 v250, v250, v84, v85
  v_max3_f32 v249, v249, v86, v87
  v_mfma_f32_32x32x16_bf16 a[80:95], a[228:231], v[32:35], a[80:95]
  v_max3_f32 v250, v250, v88, v89
  v_max3_f32 v249, v249, v90, v91
  v_max3_f32 v250, v250, v92, v93
  v_max3_f32 v249, v249, v94, v95
  v_max3_f32 v250, v250, v96, v97
  v_max3_f32 v249, v249, v98, v99
  v_mfma_f32_32x32x16_bf16 a[144:159], a[228:231], v[48:51], a[144:159]
  v_max3_f32 v250, v250, v100, v101
  v_max3_f32 v249, v249, v102, v103
  v_max3_f32 v250, v250, v104, v105
  v_max3_f32 v249, v249, v106, v107
  v_max3_f32 v250, v250, v108, v109
  s_waitcnt lgkmcnt(4)
  v_mfma_f32_32x32x16_bf16 a[32:47], a[232:235], v[16:19], a[32:47]
  ds_read_b64_tr_b16 a[248:249], v236 offset:4096
  ds_read_b64_tr_b16 a[250:251], v237 offset:6144
  ds_read_b64_tr_b16 a[252:253], v238 offset:4096
  ds_read_b64_tr_b16 a[254:255], v239 offset:6144
  v_mfma_f32_32x32x16_bf16 a[96:111], a[232:235], v[32:35], a[96:111]
  v_max3_f32 v249, v249, v110, v111
  v_max_f32 v249, v249, v250
  v_cmp_lt_f32 vcc, 1090519040, v249
  s_cbranch_vccnz L_attn_rare5
L_attn_ret5:
  v_mfma_f32_32x32x16_bf16 a[160:175], a[232:235], v[48:51], a[160:175]
  buffer_load_dwordx4 v253, s[32:35], s47 offen offset:1024 nt lds
  v_exp_f32 v64, v64
  v_exp_f32 v65, v65
  v_mfma_f32_32x32x16_bf16 a[48:63], a[236:239], v[16:19], a[48:63]
  v_add_f32 v246, v246, v64
  v_exp_f32 v66, v66
  v_add_f32 v246, v246, v65
  v_cvt_pk_bf16_f32 v64, v64, v65
  v_mfma_f32_32x32x16_bf16 a[112:127], a[236:239], v[32:35], a[112:127]
  v_exp_f32 v67, v67
  v_add_f32 v246, v246, v66
  v_exp_f32 v68, v68
  v_add_f32 v246, v246, v67
  v_mfma_f32_32x32x16_bf16 a[176:191], a[236:239], v[48:51], a[176:191]
  v_cvt_pk_bf16_f32 v65, v66, v67
  v_exp_f32 v69, v69
  v_add_f32 v246, v246, v68
  s_waitcnt lgkmcnt(4)
  v_mfma_f32_32x32x16_bf16 a[0:15], a[240:243], v[20:23], a[0:15]
  s_waitcnt vmcnt(10)
  s_barrier
  ds_read_b128 a[224:227], v224 offset:49152
  ds_read_b128 a[228:231], v225 offset:49152
  v_mfma_f32_32x32x16_bf16 a[64:79], a[240:243], v[36:39], a[64:79]
  v_exp_f32 v70, v70
  v_add_f32 v246, v246, v69
  v_cvt_pk_bf16_f32 v66, v68, v69
  v_exp_f32 v71, v71
  v_add_f32 v246, v246, v70
  v_mfma_f32_32x32x16_bf16 a[128:143], a[240:243], v[52:55], a[128:143]
  buffer_load_dwordx4 v254, s[32:35], s47 offen offset:2048 nt lds
  v_exp_f32 v72, v72
  v_add_f32 v246, v246, v71
  v_mfma_f32_32x32x16_bf16 a[16:31], a[244:247], v[20:23], a[16:31]
  v_cvt_pk_bf16_f32 v67, v70, v71
  v_exp_f32 v73, v73
  v_add_f32 v246, v246, v72
  v_exp_f32 v74, v74
  v_mfma_f32_32x32x16_bf16 a[80:95], a[244:247], v[36:39], a[80:95]
  v_add_f32 v246, v246, v73
  v_cvt_pk_bf16_f32 v68, v72, v73
  v_exp_f32 v75, v75
  v_add_f32 v246, v246, v74
  v_mfma_f32_32x32x16_bf16 a[144:159], a[244:247], v[52:55], a[144:159]
  v_exp_f32 v76, v76
  v_add_f32 v246, v246, v75
  v_cvt_pk_bf16_f32 v69, v74, v75
  s_waitcnt lgkmcnt(2)
  v_mfma_f32_32x32x16_bf16 a[32:47], a[248:251], v[20:23], a[32:47]
  ds_read_b128 a[232:235], v226 offset:49152
  ds_read_b128 a[236:239], v227 offset:49152
  v_exp_f32 v77, v77
  v_add_f32 v246, v246, v76
  v_mfma_f32_32x32x16_bf16 a[96:111], a[248:251], v[36:39], a[96:111]
  v_exp_f32 v78, v78
  v_add_f32 v246, v246, v77
  v_cvt_pk_bf16_f32 v70, v76, v77
  v_exp_f32 v79, v79
  v_mfma_f32_32x32x16_bf16 a[160:175], a[248:251], v[52:55], a[160:175]
  buffer_load_dwordx4 v255, s[32:35], s47 offen offset:3072 nt lds
  v_add_f32 v246, v246, v78
  v_add_f32 v246, v246, v79
  v_mfma_f32_32x32x16_bf16 a[48:63], a[252:255], v[20:23], a[48:63]
  v_cvt_pk_bf16_f32 v71, v78, v79
  v_exp_f32 v80, v80
  v_exp_f32 v81, v81
  v_add_f32 v247, v247, v80
  v_mfma_f32_32x32x16_bf16 a[112:127], a[252:255], v[36:39], a[112:127]
  v_exp_f32 v82, v82
  v_add_f32 v247, v247, v81
  v_cvt_pk_bf16_f32 v80, v80, v81
  v_exp_f32 v83, v83
  v_mfma_f32_32x32x16_bf16 a[176:191], a[252:255], v[52:55], a[176:191]
  v_add_f32 v247, v247, v82
  v_exp_f32 v84, v84
  v_add_f32 v247, v247, v83
  v_cvt_pk_bf16_f32 v81, v82, v83
  s_waitcnt lgkmcnt(2)
  v_mfma_f32_32x32x16_bf16 v[16:31], a[224:227], v[112:115], v[176:191]
  ds_read_b128 a[240:243], v228 offset:49152
  ds_read_b128 a[244:247], v229 offset:49152
  v_exp_f32 v85, v85
  v_mfma_f32_32x32x16_bf16 v[32:47], a[224:227], v[144:147], v[192:207]
  v_add_f32 v247, v247, v84
  v_exp_f32 v86, v86
  v_add_f32 v247, v247, v85
  v_cvt_pk_bf16_f32 v82, v84, v85
  v_mfma_f32_32x32x16_bf16 v[48:63], a[224:227], a[192:195], v[208:223]
  s_add_u32 m0, s46, 114688
  s_add_u32 s47, s46, 114688
  buffer_load_dwordx4 v252, s[32:35], s47 offen nt lds
  v_exp_f32 v87, v87
  v_mfma_f32_32x32x16_bf16 v[16:31], a[228:231], v[116:119], v[16:31]
  v_add_f32 v247, v247, v86
  v_exp_f32 v88, v88
  v_add_f32 v247, v247, v87
  v_cvt_pk_bf16_f32 v83, v86, v87
  v_mfma_f32_32x32x16_bf16 v[32:47], a[228:231], v[148:151], v[32:47]
  v_exp_f32 v89, v89
  v_add_f32 v247, v247, v88
  v_exp_f32 v90, v90
  v_add_f32 v247, v247, v89
  v_mfma_f32_32x32x16_bf16 v[48:63], a[228:231], a[196:199], v[48:63]
  v_cvt_pk_bf16_f32 v84, v88, v89
  v_exp_f32 v91, v91
  v_add_f32 v247, v247, v90
  s_waitcnt lgkmcnt(2)
  v_mfma_f32_32x32x16_bf16 v[16:31], a[232:235], v[120:123], v[16:31]
  ds_read_b128 a[248:251], v230 offset:49152
  ds_read_b128 a[252:255], v231 offset:49152
  v_exp_f32 v92, v92
  v_mfma_f32_32x32x16_bf16 v[32:47], a[232:235], v[152:155], v[32:47]
  v_add_f32 v247, v247, v91
  v_cvt_pk_bf16_f32 v85, v90, v91
  v_exp_f32 v93, v93
  v_add_f32 v247, v247, v92
  v_exp_f32 v94, v94
  v_mfma_f32_32x32x16_bf16 v[48:63], a[232:235], a[200:203], v[48:63]
  buffer_load_dwordx4 v253, s[32:35], s47 offen offset:1024 nt lds
  v_add_f32 v247, v247, v93
  v_cvt_pk_bf16_f32 v86, v92, v93
  v_mfma_f32_32x32x16_bf16 v[16:31], a[236:239], v[124:127], v[16:31]
  v_exp_f32 v95, v95
  v_add_f32 v247, v247, v94
  v_add_f32 v247, v247, v95
  v_cvt_pk_bf16_f32 v87, v94, v95
  v_mfma_f32_32x32x16_bf16 v[32:47], a[236:239], v[156:159], v[32:47]
  v_exp_f32 v96, v96
  v_exp_f32 v97, v97
  v_add_f32 v248, v248, v96
  v_exp_f32 v98, v98
  v_mfma_f32_32x32x16_bf16 v[48:63], a[236:239], a[204:207], v[48:63]
  v_add_f32 v248, v248, v97
  v_cvt_pk_bf16_f32 v96, v96, v97
  v_exp_f32 v99, v99
  s_waitcnt lgkmcnt(2)
  v_mfma_f32_32x32x16_bf16 v[16:31], a[240:243], v[128:131], v[16:31]
  s_waitcnt vmcnt(10)
  s_barrier
  ds_read_b64_tr_b16 a[224:225], v232 offset:16384
  ds_read_b64_tr_b16 a[226:227], v233 offset:18432
  ds_read_b64_tr_b16 a[228:229], v234 offset:16384
  ds_read_b64_tr_b16 a[230:231], v235 offset:18432
  v_mfma_f32_32x32x16_bf16 v[32:47], a[240:243], v[160:163], v[32:47]
  v_add_f32 v248, v248, v98
  v_exp_f32 v100, v100
  v_add_f32 v248, v248, v99
  v_cvt_pk_bf16_f32 v97, v98, v99
  v_mfma_f32_32x32x16_bf16 v[48:63], a[240:243], a[208:211], v[48:63]
  buffer_load_dwordx4 v254, s[32:35], s47 offen offset:2048 nt lds
  v_exp_f32 v101, v101
  v_add_f32 v248, v248, v100
  v_mfma_f32_32x32x16_bf16 v[16:31], a[244:247], v[132:135], v[16:31]
  v_exp_f32 v102, v102
  v_add_f32 v248, v248, v101
  v_cvt_pk_bf16_f32 v98, v100, v101
  v_exp_f32 v103, v103
  v_add_f32 v248, v248, v102
  v_mfma_f32_32x32x16_bf16 v[32:47], a[244:247], v[164:167], v[32:47]
  v_exp_f32 v104, v104
  v_add_f32 v248, v248, v103
  v_cvt_pk_bf16_f32 v99, v102, v103
  v_exp_f32 v105, v105
  v_mfma_f32_32x32x16_bf16 v[48:63], a[244:247], a[212:215], v[48:63]
  v_add_f32 v248, v248, v104
  v_exp_f32 v106, v106
  v_add_f32 v248, v248, v105
  s_waitcnt lgkmcnt(4)
  v_mfma_f32_32x32x16_bf16 v[16:31], a[248:251], v[136:139], v[16:31]
  ds_read_b64_tr_b16 a[232:233], v236 offset:16384
  ds_read_b64_tr_b16 a[234:235], v237 offset:18432
  ds_read_b64_tr_b16 a[236:237], v238 offset:16384
  ds_read_b64_tr_b16 a[238:239], v239 offset:18432
  v_mfma_f32_32x32x16_bf16 v[32:47], a[248:251], v[168:171], v[32:47]
  v_cvt_pk_bf16_f32 v100, v104, v105
  v_exp_f32 v107, v107
  v_add_f32 v248, v248, v106
  v_exp_f32 v108, v108
  v_mfma_f32_32x32x16_bf16 v[48:63], a[248:251], a[216:219], v[48:63]
  buffer_load_dwordx4 v255, s[32:35], s47 offen offset:3072 nt lds
  v_add_f32 v248, v248, v107
  v_cvt_pk_bf16_f32 v101, v106, v107
  v_mfma_f32_32x32x16_bf16 v[16:31], a[252:255], v[140:143], v[16:31]
  v_exp_f32 v109, v109
  v_add_f32 v248, v248, v108
  v_exp_f32 v110, v110
  v_add_f32 v248, v248, v109
  v_mfma_f32_32x32x16_bf16 v[32:47], a[252:255], v[172:175], v[32:47]
  v_cvt_pk_bf16_f32 v102, v108, v109
  v_exp_f32 v111, v111
  v_add_f32 v248, v248, v110
  v_add_f32 v248, v248, v111
  v_cvt_pk_bf16_f32 v103, v110, v111
  v_mfma_f32_32x32x16_bf16 v[48:63], a[252:255], a[220:223], v[48:63]
  s_cmp_eq_u32 s52, 0
  s_cbranch_scc0 L_attn_rs5
L_attn_rsret5:
  s_waitcnt lgkmcnt(4)
  v_mfma_f32_32x32x16_bf16 a[0:15], a[224:227], v[64:67], a[0:15]
  ds_read_b64_tr_b16 a[240:241], v232 offset:20480
  ds_read_b64_tr_b16 a[242:243], v233 offset:22528
  ds_read_b64_tr_b16 a[244:245], v234 offset:20480
  ds_read_b64_tr_b16 a[246:247], v235 offset:22528
  v_mfma_f32_32x32x16_bf16 a[64:79], a[224:227], v[80:83], a[64:79]
  v_max3_f32 v249, v16, v17, v18
  v_max3_f32 v250, v19, v20, v21
  v_max3_f32 v249, v249, v22, v23
  v_mfma_f32_32x32x16_bf16 a[128:143], a[224:227], v[96:99], a[128:143]
  v_max3_f32 v250, v250, v24, v25
  v_max3_f32 v249, v249, v26, v27
  v_max3_f32 v250, v250, v28, v29
  v_max3_f32 v249, v249, v30, v31
  v_max3_f32 v250, v250, v32, v33
  v_mfma_f32_32x32x16_bf16 a[16:31], a[228:231], v[64:67], a[16:31]
  v_max3_f32 v249, v249, v34, v35
  v_max3_f32 v250, v250, v36, v37
  v_max3_f32 v249, v249, v38, v39
  v_max3_f32 v250, v250, v40, v41
  v_max3_f32 v249, v249, v42, v43
  v_mfma_f32_32x32x16_bf16 a[80:95], a[228:231], v[80:83], a[80:95]
  v_max3_f32 v250, v250, v44, v45
  v_max3_f32 v249, v249, v46, v47
  v_max3_f32 v250, v250, v48, v49
  v_max3_f32 v249, v249, v50, v51
  v_max3_f32 v250, v250, v52, v53
  v_max3_f32 v249, v249, v54, v55
  v_mfma_f32_32x32x16_bf16 a[144:159], a[228:231], v[96:99], a[144:159]
  v_max3_f32 v250, v250, v56, v57
  v_max3_f32 v249, v249, v58, v59
  v_max3_f32 v250, v250, v60, v61
  v_max3_f32 v249, v249, v62, v63
  s_waitcnt lgkmcnt(4)
  v_mfma_f32_32x32x16_bf16 a[32:47], a[232:235], v[64:67], a[32:47]
  ds_read_b64_tr_b16 a[248:249], v236 offset:20480
  ds_read_b64_tr_b16 a[250:251], v237 offset:22528
  ds_read_b64_tr_b16 a[252:253], v238 offset:20480
  ds_read_b64_tr_b16 a[254:255], v239 offset:22528
  v_mfma_f32_32x32x16_bf16 a[96:111], a[232:235], v[80:83], a[96:111]
  v_max_f32 v249, v249, v250
  v_cmp_lt_f32 vcc, 1090519040, v249
  s_cbranch_vccnz L_attn_rare6
L_attn_ret6:
  v_mfma_f32_32x32x16_bf16 a[160:175], a[232:235], v[96:99], a[160:175]
  v_exp_f32 v16, v16
  v_exp_f32 v17, v17
  v_add_f32 v246, v246, v16
  v_mfma_f32_32x32x16_bf16 a[48:63], a[236:239], v[64:67], a[48:63]
  v_exp_f32 v18, v18
  v_add_f32 v246, v246, v17
  v_cvt_pk_bf16_f32 v16, v16, v17
  v_exp_f32 v19, v19
  v_mfma_f32_32x32x16_bf16 a[112:127], a[236:239], v[80:83], a[112:127]
  v_add_f32 v246, v246, v18
  v_exp_f32 v20, v20
  v_add_f32 v246, v246, v19
  v_cvt_pk_bf16_f32 v17, v18, v19
  v_mfma_f32_32x32x16_bf16 a[176:191], a[236:239], v[96:99], a[176:191]
  v_exp_f32 v21, v21
  v_add_f32 v246, v246, v20
  v_exp_f32 v22, v22
  s_waitcnt lgkmcnt(4)
  v_mfma_f32_32x32x16_bf16 a[0:15], a[240:243], v[68:71], a[0:15]
  s_waitcnt vmcnt(8)
  s_barrier
  ds_read_b128 a[224:227], v224
  ds_read_b128 a[228:231], v225
  v_mfma_f32_32x32x16_bf16 a[64:79], a[240:243], v[84:87], a[64:79]
  v_add_f32 v246, v246, v21
  v_cvt_pk_bf16_f32 v18, v20, v21
  v_exp_f32 v23, v23
  v_mfma_f32_32x32x16_bf16 a[128:143], a[240:243], v[100:103], a[128:143]
  v_add_f32 v246, v246, v22
  v_exp_f32 v24, v24
  v_add_f32 v246, v246, v23
  v_cvt_pk_bf16_f32 v19, v22, v23
  v_mfma_f32_32x32x16_bf16 a[16:31], a[244:247], v[68:71], a[16:31]
  v_exp_f32 v25, v25
  v_add_f32 v246, v246, v24
  v_exp_f32 v26, v26
  v_add_f32 v246, v246, v25
  v_mfma_f32_32x32x16_bf16 a[80:95], a[244:247], v[84:87], a[80:95]
  v_cvt_pk_bf16_f32 v20, v24, v25
  v_exp_f32 v27, v27
  v_add_f32 v246, v246, v26
  v_mfma_f32_32x32x16_bf16 a[144:159], a[244:247], v[100:103], a[144:159]
  v_exp_f32 v28, v28
  v_add_f32 v246, v246, v27
  v_cvt_pk_bf16_f32 v21, v26, v27
  s_waitcnt lgkmcnt(2)
  v_mfma_f32_32x32x16_bf16 a[32:47], a[248:251], v[68:71], a[32:47]
  ds_read_b128 a[232:235], v226
  ds_read_b128 a[236:239], v227
  v_exp_f32 v29, v29
  v_add_f32 v246, v246, v28
  v_mfma_f32_32x32x16_bf16 a[96:111], a[248:251], v[84:87], a[96:111]
  v_exp_f32 v30, v30
  v_add_f32 v246, v246, v29
  v_cvt_pk_bf16_f32 v22, v28, v29
  v_mfma_f32_32x32x16_bf16 a[160:175], a[248:251], v[100:103], a[160:175]
  v_exp_f32 v31, v31
  v_add_f32 v246, v246, v30
  v_add_f32 v246, v246, v31
  v_cvt_pk_bf16_f32 v23, v30, v31
  v_mfma_f32_32x32x16_bf16 a[48:63], a[252:255], v[68:71], a[48:63]
  v_exp_f32 v32, v32
  v_exp_f32 v33, v33
  v_add_f32 v247, v247, v32
  v_mfma_f32_32x32x16_bf16 a[112:127], a[252:255], v[84:87], a[112:127]
  v_exp_f32 v34, v34
  v_add_f32 v247, v247, v33
  v_cvt_pk_bf16_f32 v32, v32, v33
  v_exp_f32 v35, v35
  v_mfma_f32_32x32x16_bf16 a[176:191], a[252:255], v[100:103], a[176:191]
  v_add_f32 v247, v247, v34
  v_exp_f32 v36, v36
  v_add_f32 v247, v247, v35
  s_waitcnt lgkmcnt(2)
  v_mfma_f32_32x32x16_bf16 v[64:79], a[224:227], v[112:115], v[176:191]
  ds_read_b128 a[240:243], v228
  ds_read_b128 a[244:247], v229
  v_cvt_pk_bf16_f32 v33, v34, v35
  v_mfma_f32_32x32x16_bf16 v[80:95], a[224:227], v[144:147], v[192:207]
  v_exp_f32 v37, v37
  v_add_f32 v247, v247, v36
  v_exp_f32 v38, v38
  v_add_f32 v247, v247, v37
  v_mfma_f32_32x32x16_bf16 v[96:111], a[224:227], a[192:195], v[208:223]
  v_cvt_pk_bf16_f32 v34, v36, v37
  v_exp_f32 v39, v39
  v_add_f32 v247, v247, v38
  v_mfma_f32_32x32x16_bf16 v[64:79], a[228:231], v[116:119], v[64:79]
  v_exp_f32 v40, v40
  v_add_f32 v247, v247, v39
  v_cvt_pk_bf16_f32 v35, v38, v39
  v_exp_f32 v41, v41
  v_mfma_f32_32x32x16_bf16 v[80:95], a[228:231], v[148:151], v[80:95]
  v_add_f32 v247, v247, v40
  v_exp_f32 v42, v42
  v_add_f32 v247, v247, v41
  v_cvt_pk_bf16_f32 v36, v40, v41
  v_mfma_f32_32x32x16_bf16 v[96:111], a[228:231], a[196:199], v[96:111]
  v_exp_f32 v43, v43
  v_add_f32 v247, v247, v42
  v_exp_f32 v44, v44
  s_waitcnt lgkmcnt(2)
  v_mfma_f32_32x32x16_bf16 v[64:79], a[232:235], v[120:123], v[64:79]
  ds_read_b128 a[248:251], v230
  ds_read_b128 a[252:255], v231
  v_add_f32 v247, v247, v43
  v_mfma_f32_32x32x16_bf16 v[80:95], a[232:235], v[152:155], v[80:95]
  v_cvt_pk_bf16_f32 v37, v42, v43
  v_exp_f32 v45, v45
  v_add_f32 v247, v247, v44
  v_exp_f32 v46, v46
  v_mfma_f32_32x32x16_bf16 v[96:111], a[232:235], a[200:203], v[96:111]
  v_add_f32 v247, v247, v45
  v_cvt_pk_bf16_f32 v38, v44, v45
  v_exp_f32 v47, v47
  v_mfma_f32_32x32x16_bf16 v[64:79], a[236:239], v[124:127], v[64:79]
  v_add_f32 v247, v247, v46
  v_add_f32 v247, v247, v47
  v_cvt_pk_bf16_f32 v39, v46, v47
  v_exp_f32 v48, v48
  v_mfma_f32_32x32x16_bf16 v[80:95], a[236:239], v[156:159], v[80:95]
  v_exp_f32 v49, v49
  v_add_f32 v248, v248, v48
  v_exp_f32 v50, v50
  v_mfma_f32_32x32x16_bf16 v[96:111], a[236:239], a[204:207], v[96:111]
  v_add_f32 v248, v248, v49
  v_cvt_pk_bf16_f32 v48, v48, v49
  v_exp_f32 v51, v51
  s_waitcnt lgkmcnt(2)
  v_mfma_f32_32x32x16_bf16 v[64:79], a[240:243], v[128:131], v[64:79]
  s_waitcnt vmcnt(4)
  s_barrier
  ds_read_b64_tr_b16 a[224:225], v232 offset:32768
  ds_read_b64_tr_b16 a[226:227], v233 offset:34816
  ds_read_b64_tr_b16 a[228:229], v234 offset:32768
  ds_read_b64_tr_b16 a[230:231], v235 offset:34816
  v_mfma_f32_32x32x16_bf16 v[80:95], a[240:243], v[160:163], v[80:95]
  v_add_f32 v248, v248, v50
  v_exp_f32 v52, v52
  v_add_f32 v248, v248, v51
  v_cvt_pk_bf16_f32 v49, v50, v51
  v_mfma_f32_32x32x16_bf16 v[96:111], a[240:243], a[208:211], v[96:111]
  v_exp_f32 v53, v53
  v_add_f32 v248, v248, v52
  v_exp_f32 v54, v54
  v_mfma_f32_32x32x16_bf16 v[64:79], a[244:247], v[132:135], v[64:79]
  v_add_f32 v248, v248, v53
  v_cvt_pk_bf16_f32 v50, v52, v53
  v_exp_f32 v55, v55
  v_add_f32 v248, v248, v54
  v_mfma_f32_32x32x16_bf16 v[80:95], a[244:247], v[164:167], v[80:95]
  v_exp_f32 v56, v56
  v_add_f32 v248, v248, v55
  v_cvt_pk_bf16_f32 v51, v54, v55
  v_exp_f32 v57, v57
  v_mfma_f32_32x32x16_bf16 v[96:111], a[244:247], a[212:215], v[96:111]
  v_add_f32 v248, v248, v56
  v_exp_f32 v58, v58
  v_add_f32 v248, v248, v57
  s_waitcnt lgkmcnt(4)
  v_mfma_f32_32x32x16_bf16 v[64:79], a[248:251], v[136:139], v[64:79]
  ds_read_b64_tr_b16 a[232:233], v236 offset:32768
  ds_read_b64_tr_b16 a[234:235], v237 offset:34816
  ds_read_b64_tr_b16 a[236:237], v238 offset:32768
  ds_read_b64_tr_b16 a[238:239], v239 offset:34816
  v_mfma_f32_32x32x16_bf16 v[80:95], a[248:251], v[168:171], v[80:95]
  v_cvt_pk_bf16_f32 v52, v56, v57
  v_exp_f32 v59, v59
  v_add_f32 v248, v248, v58
  v_mfma_f32_32x32x16_bf16 v[96:111], a[248:251], a[216:219], v[96:111]
  v_exp_f32 v60, v60
  v_add_f32 v248, v248, v59
  v_cvt_pk_bf16_f32 v53, v58, v59
  v_exp_f32 v61, v61
  v_mfma_f32_32x32x16_bf16 v[64:79], a[252:255], v[140:143], v[64:79]
  v_add_f32 v248, v248, v60
  v_exp_f32 v62, v62
  v_add_f32 v248, v248, v61
  v_cvt_pk_bf16_f32 v54, v60, v61
  v_mfma_f32_32x32x16_bf16 v[80:95], a[252:255], v[172:175], v[80:95]
  v_exp_f32 v63, v63
  v_add_f32 v248, v248, v62
  v_add_f32 v248, v248, v63
  v_cvt_pk_bf16_f32 v55, v62, v63
  v_mfma_f32_32x32x16_bf16 v[96:111], a[252:255], a[220:223], v[96:111]
  s_cmp_eq_u32 s52, 0
  s_cbranch_scc0 L_attn_rs6
L_attn_rsret6:
  v_max3_f32 v249, v64, v65, v66
  v_max3_f32 v250, v67, v68, v69
  v_max3_f32 v249, v249, v70, v71
  s_waitcnt lgkmcnt(4)
  v_mfma_f32_32x32x16_bf16 a[0:15], a[224:227], v[16:19], a[0:15]
  ds_read_b64_tr_b16 a[240:241], v232 offset:36864
  ds_read_b64_tr_b16 a[242:243], v233 offset:38912
  ds_read_b64_tr_b16 a[244:245], v234 offset:36864
  ds_read_b64_tr_b16 a[246:247], v235 offset:38912
  v_max3_f32 v250, v250, v72, v73
  v_max3_f32 v249, v249, v74, v75
  v_max3_f32 v250, v250, v76, v77
  v_mfma_f32_32x32x16_bf16 a[64:79], a[224:227], v[32:35], a[64:79]
  v_max3_f32 v249, v249, v78, v79
  v_max3_f32 v250, v250, v80, v81
  v_max3_f32 v249, v249, v82, v83
  v_max3_f32 v250, v250, v84, v85
  v_max3_f32 v249, v249, v86, v87
  v_max3_f32 v250, v250, v88, v89
  v_max3_f32 v249, v249, v90, v91
  v_max3_f32 v250, v250, v92, v93
  v_max3_f32 v249, v249, v94, v95
  v_max3_f32 v250, v250, v96, v97
  v_mfma_f32_32x32x16_bf16 a[128:143], a[224:227], v[48:51], a[128:143]
  v_max3_f32 v249, v249, v98, v99
  v_max3_f32 v250, v250, v100, v101
  v_max3_f32 v249, v249, v102, v103
  v_max3_f32 v250, v250, v104, v105
  v_max3_f32 v249, v249, v106, v107
  v_max3_f32 v250, v250, v108, v109
  v_max3_f32 v249, v249, v110, v111
  v_max_f32 v249, v249, v250
  v_cmp_lt_f32 vcc, 1090519040, v249
  v_mfma_f32_32x32x16_bf16 a[16:31], a[228:231], v[16:19], a[16:31]
  s_cbranch_vccnz L_attn_rare7
L_attn_ret7:
  v_exp_f32 v64, v64
  v_exp_f32 v65, v65
  v_add_f32 v246, v246, v64
  v_exp_f32 v66, v66
  v_add_f32 v246, v246, v65
  v_mfma_f32_32x32x16_bf16 a[80:95], a[228:231], v[32:35], a[80:95]
  v_cvt_pk_bf16_f32 v64, v64, v65
  v_exp_f32 v67, v67
  v_add_f32 v246, v246, v66
  v_exp_f32 v68, v68
  v_add_f32 v246, v246, v67
  v_cvt_pk_bf16_f32 v65, v66, v67
  v_exp_f32 v69, v69
  v_mfma_f32_32x32x16_bf16 a[144:159], a[228:231], v[48:51], a[144:159]
  v_add_f32 v246, v246, v68
  v_exp_f32 v70, v70
  v_add_f32 v246, v246, v69
  v_cvt_pk_bf16_f32 v66, v68, v69
  v_exp_f32 v71, v71
  v_add_f32 v246, v246, v70
  s_waitcnt lgkmcnt(4)
  v_mfma_f32_32x32x16_bf16 a[32:47], a[232:235], v[16:19], a[32:47]
  ds_read_b64_tr_b16 a[248:249], v236 offset:36864
  ds_read_b64_tr_b16 a[250:251], v237 offset:38912
  ds_read_b64_tr_b16 a[252:253], v238 offset:36864
  ds_read_b64_tr_b16 a[254:255], v239 offset:38912
  v_exp_f32 v72, v72
  v_add_f32 v246, v246, v71
  v_mfma_f32_32x32x16_bf16 a[96:111], a[232:235], v[32:35], a[96:111]
  v_cvt_pk_bf16_f32 v67, v70, v71
  v_exp_f32 v73, v73
  v_add_f32 v246, v246, v72
  v_exp_f32 v74, v74
  v_add_f32 v246, v246, v73
  v_cvt_pk_bf16_f32 v68, v72, v73
  v_exp_f32 v75, v75
  v_mfma_f32_32x32x16_bf16 a[160:175], a[232:235], v[48:51], a[160:175]
  v_add_f32 v246, v246, v74
  v_exp_f32 v76, v76
  v_add_f32 v246, v246, v75
  v_cvt_pk_bf16_f32 v69, v74, v75
  v_exp_f32 v77, v77
  v_add_f32 v246, v246, v76
  v_exp_f32 v78, v78
  v_mfma_f32_32x32x16_bf16 a[48:63], a[236:239], v[16:19], a[48:63]
  v_add_f32 v246, v246, v77
  v_cvt_pk_bf16_f32 v70, v76, v77
  v_exp_f32 v79, v79
  v_add_f32 v246, v246, v78
  v_add_f32 v246, v246, v79
  v_cvt_pk_bf16_f32 v71, v78, v79
  v_exp_f32 v80, v80
  v_mfma_f32_32x32x16_bf16 a[112:127], a[236:239], v[32:35], a[112:127]
  v_exp_f32 v81, v81
  v_add_f32 v247, v247, v80
  v_exp_f32 v82, v82
  v_add_f32 v247, v247, v81
  v_cvt_pk_bf16_f32 v80, v80, v81
  v_exp_f32 v83, v83
  v_add_f32 v247, v247, v82
  v_mfma_f32_32x32x16_bf16 a[176:191], a[236:239], v[48:51], a[176:191]
  v_exp_f32 v84, v84
  v_add_f32 v247, v247, v83
  v_cvt_pk_bf16_f32 v81, v82, v83
  v_exp_f32 v85, v85
  v_add_f32 v247, v247, v84
  v_exp_f32 v86, v86
  s_waitcnt lgkmcnt(4)
  v_mfma_f32_32x32x16_bf16 a[0:15], a[240:243], v[20:23], a[0:15]
  s_waitcnt vmcnt(0)
  s_barrier
  ds_read_b64_tr_b16 a[224:225], v236 offset:49152
  ds_read_b64_tr_b16 a[226:227], v237 offset:51200
  ds_read_b64_tr_b16 a[228:229], v236 offset:53248
  ds_read_b64_tr_b16 a[230:231], v237 offset:55296
  v_add_f32 v247, v247, v85
  v_cvt_pk_bf16_f32 v82, v84, v85
  v_mfma_f32_32x32x16_bf16 a[64:79], a[240:243], v[36:39], a[64:79]
  v_exp_f32 v87, v87
  v_add_f32 v247, v247, v86
  v_exp_f32 v88, v88
  v_add_f32 v247, v247, v87
  v_cvt_pk_bf16_f32 v83, v86, v87
  v_exp_f32 v89, v89
  v_add_f32 v247, v247, v88
  v_mfma_f32_32x32x16_bf16 a[128:143], a[240:243], v[52:55], a[128:143]
  v_exp_f32 v90, v90
  v_add_f32 v247, v247, v89
  v_cvt_pk_bf16_f32 v84, v88, v89
  v_exp_f32 v91, v91
  v_add_f32 v247, v247, v90
  v_exp_f32 v92, v92
  v_add_f32 v247, v247, v91
  v_mfma_f32_32x32x16_bf16 a[16:31], a[244:247], v[20:23], a[16:31]
  v_cvt_pk_bf16_f32 v85, v90, v91
  v_exp_f32 v93, v93
  v_add_f32 v247, v247, v92
  v_exp_f32 v94, v94
  v_add_f32 v247, v247, v93
  v_cvt_pk_bf16_f32 v86, v92, v93
  v_exp_f32 v95, v95
  v_mfma_f32_32x32x16_bf16 a[80:95], a[244:247], v[36:39], a[80:95]
  v_add_f32 v247, v247, v94
  v_add_f32 v247, v247, v95
  v_cvt_pk_bf16_f32 v87, v94, v95
  v_exp_f32 v96, v96
  v_exp_f32 v97, v97
  v_add_f32 v248, v248, v96
  v_mfma_f32_32x32x16_bf16 a[144:159], a[244:247], v[52:55], a[144:159]
  v_exp_f32 v98, v98
  v_add_f32 v248, v248, v97
  v_cvt_pk_bf16_f32 v96, v96, v97
  v_exp_f32 v99, v99
  v_add_f32 v248, v248, v98
  v_exp_f32 v100, v100
  s_waitcnt lgkmcnt(4)
  v_mfma_f32_32x32x16_bf16 a[32:47], a[248:251], v[20:23], a[32:47]
  ds_read_b64_tr_b16 a[232:233], v238 offset:49152
  ds_read_b64_tr_b16 a[234:235], v239 offset:51200
  ds_read_b64_tr_b16 a[236:237], v238 offset:53248
  ds_read_b64_tr_b16 a[238:239], v239 offset:55296
  v_add_f32 v248, v248, v99
  v_cvt_pk_bf16_f32 v97, v98, v99
  v_exp_f32 v101, v101
  v_mfma_f32_32x32x16_bf16 a[96:111], a[248:251], v[36:39], a[96:111]
  v_add_f32 v248, v248, v100
  v_exp_f32 v102, v102
  v_add_f32 v248, v248, v101
  v_cvt_pk_bf16_f32 v98, v100, v101
  v_exp_f32 v103, v103
  v_add_f32 v248, v248, v102
  v_exp_f32 v104, v104
  v_mfma_f32_32x32x16_bf16 a[160:175], a[248:251], v[52:55], a[160:175]
  v_add_f32 v248, v248, v103
  v_cvt_pk_bf16_f32 v99, v102, v103
  v_exp_f32 v105, v105
  v_add_f32 v248, v248, v104
  v_exp_f32 v106, v106
  v_add_f32 v248, v248, v105
  v_cvt_pk_bf16_f32 v100, v104, v105
  v_mfma_f32_32x32x16_bf16 a[48:63], a[252:255], v[20:23], a[48:63]
  v_exp_f32 v107, v107
  v_add_f32 v248, v248, v106
  v_exp_f32 v108, v108
  v_add_f32 v248, v248, v107
  v_cvt_pk_bf16_f32 v101, v106, v107
  v_exp_f32 v109, v109
  v_mfma_f32_32x32x16_bf16 a[112:127], a[252:255], v[36:39], a[112:127]
  v_add_f32 v248, v248, v108
  v_exp_f32 v110, v110
  v_add_f32 v248, v248, v109
  v_cvt_pk_bf16_f32 v102, v108, v109
  v_exp_f32 v111, v111
  v_add_f32 v248, v248, v110
  v_add_f32 v248, v248, v111
  v_cvt_pk_bf16_f32 v103, v110, v111
  v_mfma_f32_32x32x16_bf16 a[176:191], a[252:255], v[52:55], a[176:191]
  s_cmp_eq_u32 s52, 0
  s_cbranch_scc0 L_attn_rs7
L_attn_rsret7:
  v_lshlrev_b32 v11, 4, v1
  v_mul_u32_u24 v12, 24576, v2
  v_add_u32 v224, v11, v12
  v_xor_b32 v13, 1, v2
  v_mul_u32_u24 v12, 24576, v13
  v_add_u32 v225, v11, v12
  v_mul_u32_u24 v12, 24576, v10
  v_lshl_add_u32 v12, v9, 12, v12
  v_add_u32 v228, v11, v12
  v_lshlrev_b32 v11, 2, v1
  v_lshl_add_u32 v226, v2, 11, v11
  v_add_u32 v226, 155648, v226
  v_lshl_add_u32 v227, v13, 11, v11
  s_waitcnt lgkmcnt(4)
  v_mfma_f32_32x32x16_bf16 a[32:47], a[224:227], v[64:67], a[32:47]
  ds_read_b64_tr_b16 a[240:241], v232 offset:49152
  ds_read_b64_tr_b16 a[242:243], v233 offset:51200
  ds_read_b64_tr_b16 a[244:245], v232 offset:53248
  ds_read_b64_tr_b16 a[246:247], v233 offset:55296
  v_add_u32 v227, 155648, v227
  v_mov_b32 v249, v246
  v_mov_b32 v250, v247
  v_mov_b32 v251, v248
  v_permlane32_swap_b32 v246, v249
  v_permlane32_swap_b32 v247, v250
  v_permlane32_swap_b32 v248, v251
  v_add_f32 v246, v246, v249
  v_mfma_f32_32x32x16_bf16 a[96:111], a[224:227], v[80:83], a[96:111]
  v_add_f32 v247, v247, v250
  v_add_f32 v248, v248, v251
  ds_write_b32 v226, v240
  ds_write_b32 v226, v246 offset:768
  ds_write_b32 v226, v241 offset:256
  ds_write_b32 v226, v247 offset:1024
  ds_write_b32 v226, v242 offset:512
  ds_write_b32 v226, v248 offset:1280
  v_mfma_f32_32x32x16_bf16 a[160:175], a[224:227], v[96:99], a[160:175]
  s_mul_i32 s5, s15, 43
  s_lshr_b32 s5, s5, 8
  s_mul_i32 s4, s5, 6
  s_sub_u32 s4, s15, s4
  s_add_u32 s8, s4, s5
  s_and_b32 s6, s14, 1
  s_mul_i32 s6, s6, 6
  s_add_u32 s4, s4, s6
  s_bfe_u32 s6, s14, 65537
  s_mul_i32 s6, s6, 5
  s_add_u32 s5, s5, s6
  s_lshr_b32 s7, s14, 2
  s_mul_i32 s40, s7, 6291456
  s_lshl_b32 s41, s4, 15
  s_add_u32 s40, s40, s41
  s_sub_u32 s22, 12582912, s40
  s_add_u32 s40, s40, 0
  s_add_u32 s20, s12, s40
  s_addc_u32 s21, s13, 0
  s_mov_b32 s23, 131072
  s_mul_i32 s40, s7, 2621440
  s_lshl_b32 s41, s5, 7
  s_add_u32 s40, s40, s41
  s_add_u32 s24, s54, s40
  s_addc_u32 s25, s55, 0
  s_sub_u32 s26, 5242880, s40
  s_mov_b32 s27, 131072
  s_lshl_b32 s9, s7, 6
  v_mfma_f32_32x32x16_bf16 a[32:47], a[228:231], v[68:71], a[32:47]
  s_mov_b32 s56, s90
  s_mov_b32 s57, s91
  s_mov_b32 s58, 4
  s_mov_b32 s59, 131072
  v_mov_b32 v223, 0
  buffer_load_dword v255, v223, s[56:59], 0 offen sc0 sc1
  v_mfma_f32_32x32x16_bf16 a[96:111], a[228:231], v[84:87], a[96:111]
  v_lshlrev_b32 v253, 4, v1
  v_lshl_add_u32 v253, v2, 13, v253
  v_add_u32 v254, 4096, v253
  v_lshrrev_b32 v220, 3, v1
  v_and_b32 v221, 7, v1
  v_lshl_add_u32 v222, v2, 3, v220
  v_mul_u32_u24 v252, 1280, v222
  v_bfe_u32 v222, v220, 1, 1
  v_lshlrev_b32 v222, 2, v222
  v_xor_b32 v222, v222, v221
  v_lshl_add_u32 v252, v222, 4, v252
  v_mfma_f32_32x32x16_bf16 a[160:175], a[228:231], v[100:103], a[160:175]
  s_waitcnt lgkmcnt(4)
  v_mfma_f32_32x32x16_bf16 a[48:63], a[232:235], v[64:67], a[48:63]
  ds_read_b64_tr_b16 a[248:249], v234 offset:49152
  ds_read_b64_tr_b16 a[250:251], v235 offset:51200
  ds_read_b64_tr_b16 a[252:253], v234 offset:53248
  ds_read_b64_tr_b16 a[254:255], v235 offset:55296
  ds_write_b128 v224, a[32:35]
  v_mfma_f32_32x32x16_bf16 a[112:127], a[232:235], v[80:83], a[112:127]
  ds_write_b128 v224, a[36:39] offset:1024
  v_mfma_f32_32x32x16_bf16 a[176:191], a[232:235], v[96:99], a[176:191]
  ds_write_b128 v224, a[40:43] offset:2048
  ds_write_b128 v224, a[44:47] offset:3072
  v_mfma_f32_32x32x16_bf16 a[48:63], a[236:239], v[68:71], a[48:63]
  ds_write_b128 v224, a[96:99] offset:8192
  ds_write_b128 v224, a[100:103] offset:9216
  v_mfma_f32_32x32x16_bf16 a[112:127], a[236:239], v[84:87], a[112:127]
  ds_write_b128 v224, a[104:107] offset:10240
  ds_write_b128 v224, a[108:111] offset:11264
  v_mfma_f32_32x32x16_bf16 a[176:191], a[236:239], v[100:103], a[176:191]
  ds_write_b128 v224, a[160:163] offset:16384
  s_waitcnt lgkmcnt(4)
  v_mfma_f32_32x32x16_bf16 a[0:15], a[240:243], v[64:67], a[0:15]
  ds_write_b128 v224, a[164:167] offset:17408
  ds_write_b128 v224, a[168:171] offset:18432
  v_mfma_f32_32x32x16_bf16 a[64:79], a[240:243], v[80:83], a[64:79]
  ds_write_b128 v224, a[172:175] offset:19456
  v_mfma_f32_32x32x16_bf16 a[128:143], a[240:243], v[96:99], a[128:143]
  ds_write_b128 v224, a[48:51] offset:4096
  v_mfma_f32_32x32x16_bf16 a[0:15], a[244:247], v[68:71], a[0:15]
  ds_write_b128 v224, a[52:55] offset:5120
  ds_write_b128 v224, a[56:59] offset:6144
  v_mfma_f32_32x32x16_bf16 a[64:79], a[244:247], v[84:87], a[64:79]
  ds_write_b128 v224, a[60:63] offset:7168
  v_mfma_f32_32x32x16_bf16 a[128:143], a[244:247], v[100:103], a[128:143]
  ds_write_b128 v224, a[112:115] offset:12288
  s_waitcnt lgkmcnt(0)
  v_mfma_f32_32x32x16_bf16 a[16:31], a[248:251], v[64:67], a[16:31]
  ds_write_b128 v224, a[116:119] offset:13312
  ds_write_b128 v224, a[120:123] offset:14336
  v_mfma_f32_32x32x16_bf16 a[80:95], a[248:251], v[80:83], a[80:95]
  ds_write_b128 v224, a[124:127] offset:15360
  v_mfma_f32_32x32x16_bf16 a[144:159], a[248:251], v[96:99], a[144:159]
  ds_write_b128 v224, a[176:179] offset:20480
  v_mfma_f32_32x32x16_bf16 a[16:31], a[252:255], v[68:71], a[16:31]
  ds_write_b128 v224, a[180:183] offset:21504
  ds_write_b128 v224, a[184:187] offset:22528
  v_mfma_f32_32x32x16_bf16 a[80:95], a[252:255], v[84:87], a[80:95]
  ds_write_b128 v224, a[188:191] offset:23552
  v_mfma_f32_32x32x16_bf16 a[144:159], a[252:255], v[100:103], a[144:159]
  v_accvgpr_read_b32 v16, a0
  v_accvgpr_read_b32 v17, a1
  v_accvgpr_read_b32 v18, a2
  v_accvgpr_read_b32 v19, a3
  v_accvgpr_read_b32 v20, a4
  v_accvgpr_read_b32 v21, a5
  v_accvgpr_read_b32 v22, a6
  v_accvgpr_read_b32 v23, a7
  v_accvgpr_read_b32 v24, a8
  v_accvgpr_read_b32 v25, a9
  v_accvgpr_read_b32 v26, a10
  v_accvgpr_read_b32 v27, a11
  v_accvgpr_read_b32 v28, a12
  v_accvgpr_read_b32 v29, a13
  v_accvgpr_read_b32 v30, a14
  v_accvgpr_read_b32 v31, a15
  v_accvgpr_read_b32 v48, a64
  v_accvgpr_read_b32 v49, a65
  v_accvgpr_read_b32 v50, a66
  v_accvgpr_read_b32 v51, a67
  v_accvgpr_read_b32 v52, a68
  v_accvgpr_read_b32 v53, a69
  v_accvgpr_read_b32 v54, a70
  v_accvgpr_read_b32 v55, a71
  v_accvgpr_read_b32 v56, a72
  v_accvgpr_read_b32 v57, a73
  v_accvgpr_read_b32 v58, a74
  v_accvgpr_read_b32 v59, a75
  v_accvgpr_read_b32 v60, a76
  v_accvgpr_read_b32 v61, a77
  v_accvgpr_read_b32 v62, a78
  v_accvgpr_read_b32 v63, a79
  v_accvgpr_read_b32 v80, a128
  v_accvgpr_read_b32 v81, a129
  v_accvgpr_read_b32 v82, a130
  v_accvgpr_read_b32 v83, a131
  v_accvgpr_read_b32 v84, a132
  v_accvgpr_read_b32 v85, a133
  v_accvgpr_read_b32 v86, a134
  v_accvgpr_read_b32 v87, a135
  v_accvgpr_read_b32 v88, a136
  v_accvgpr_read_b32 v89, a137
  v_accvgpr_read_b32 v90, a138
  v_accvgpr_read_b32 v91, a139
  v_accvgpr_read_b32 v92, a140
  v_accvgpr_read_b32 v93, a141
  v_accvgpr_read_b32 v94, a142
  v_accvgpr_read_b32 v95, a143
  s_waitcnt lgkmcnt(0)
  s_barrier
  s_add_u32 s43, s8, 0
  s_and_b32 s43, s43, 1
  s_add_u32 s43, s43, 0
  s_mul_i32 s43, s43, 163840
  s_add_u32 m0, s48, 98304
  s_nop 0
  buffer_load_dwordx4 v252, s[24:27], s43 offen lds
  s_add_u32 m0, s48, 102400
  s_add_u32 s43, s43, 40960
  buffer_load_dwordx4 v252, s[24:27], s43 offen lds
  s_add_u32 m0, s48, 106496
  s_add_u32 s43, s43, 40960
  buffer_load_dwordx4 v252, s[24:27], s43 offen lds
  s_add_u32 m0, s48, 110592
  s_add_u32 s43, s43, 40960
  buffer_load_dwordx4 v252, s[24:27], s43 offen lds
  s_add_u32 s43, s8, 1
  s_and_b32 s43, s43, 1
  s_add_u32 s43, s43, 0
  s_mul_i32 s43, s43, 163840
  s_add_u32 m0, s48, 114688
  s_nop 0
  buffer_load_dwordx4 v252, s[24:27], s43 offen lds
  s_add_u32 m0, s48, 118784
  s_add_u32 s43, s43, 40960
  buffer_load_dwordx4 v252, s[24:27], s43 offen lds
  s_add_u32 m0, s48, 122880
  s_add_u32 s43, s43, 40960
  buffer_load_dwordx4 v252, s[24:27], s43 offen lds
  s_add_u32 m0, s48, 126976
  s_add_u32 s43, s43, 40960
  buffer_load_dwordx4 v252, s[24:27], s43 offen lds
  s_add_u32 s43, s8, 0
  s_and_b32 s43, s43, 1
  s_add_u32 s43, s43, 2
  s_mul_i32 s43, s43, 163840
  s_add_u32 m0, s48, 131072
  s_nop 0
  buffer_load_dwordx4 v252, s[24:27], s43 offen lds
  s_add_u32 m0, s48, 135168
  s_add_u32 s43, s43, 40960
  buffer_load_dwordx4 v252, s[24:27], s43 offen lds
  s_add_u32 m0, s48, 139264
  s_add_u32 s43, s43, 40960
  buffer_load_dwordx4 v252, s[24:27], s43 offen lds
  s_add_u32 m0, s48, 143360
  s_add_u32 s43, s43, 40960
  buffer_load_dwordx4 v252, s[24:27], s43 offen lds
  ds_read_b32 v208, v227
  ds_read_b32 v211, v227 offset:768
  ds_read_b32 v209, v227 offset:256
  ds_read_b32 v212, v227 offset:1024
  ds_read_b32 v210, v227 offset:512
  ds_read_b32 v213, v227 offset:1280
  ds_read_b128 v[112:115], v225
  ds_read_b128 v[116:119], v225 offset:1024
  ds_read_b128 v[120:123], v225 offset:2048
  ds_read_b128 v[124:127], v225 offset:3072
  ds_read_b128 v[128:131], v225 offset:4096
  ds_read_b128 v[132:135], v225 offset:5120
  ds_read_b128 v[136:139], v225 offset:6144
  ds_read_b128 v[140:143], v225 offset:7168
  ds_read_b128 v[144:147], v225 offset:8192
  ds_read_b128 v[148:151], v225 offset:9216
  ds_read_b128 v[152:155], v225 offset:10240
  ds_read_b128 v[156:159], v225 offset:11264
  ds_read_b128 v[160:163], v225 offset:12288
  ds_read_b128 v[164:167], v225 offset:13312
  ds_read_b128 v[168:171], v225 offset:14336
  ds_read_b128 v[172:175], v225 offset:15360
  ds_read_b128 v[176:179], v225 offset:16384
  ds_read_b128 v[180:183], v225 offset:17408
  ds_read_b128 v[184:187], v225 offset:18432
  ds_read_b128 v[188:191], v225 offset:19456
  ds_read_b128 v[192:195], v225 offset:20480
  ds_read_b128 v[196:199], v225 offset:21504
  ds_read_b128 v[200:203], v225 offset:22528
  ds_read_b128 v[204:207], v225 offset:23552
  v_accvgpr_read_b32 v32, a16
  v_accvgpr_read_b32 v33, a17
  v_accvgpr_read_b32 v34, a18
  v_accvgpr_read_b32 v35, a19
  v_accvgpr_read_b32 v36, a20
  v_accvgpr_read_b32 v37, a21
  v_accvgpr_read_b32 v38, a22
  v_accvgpr_read_b32 v39, a23
  v_accvgpr_read_b32 v40, a24
  v_accvgpr_read_b32 v41, a25
  v_accvgpr_read_b32 v42, a26
  v_accvgpr_read_b32 v43, a27
  v_accvgpr_read_b32 v44, a28
  v_accvgpr_read_b32 v45, a29
  v_accvgpr_read_b32 v46, a30
  v_accvgpr_read_b32 v47, a31
  v_accvgpr_read_b32 v64, a80
  v_accvgpr_read_b32 v65, a81
  v_accvgpr_read_b32 v66, a82
  v_accvgpr_read_b32 v67, a83
  v_accvgpr_read_b32 v68, a84
  v_accvgpr_read_b32 v69, a85
  v_accvgpr_read_b32 v70, a86
  v_accvgpr_read_b32 v71, a87
  v_accvgpr_read_b32 v72, a88
  v_accvgpr_read_b32 v73, a89
  v_accvgpr_read_b32 v74, a90
  v_accvgpr_read_b32 v75, a91
  v_accvgpr_read_b32 v76, a92
  v_accvgpr_read_b32 v77, a93
  v_accvgpr_read_b32 v78, a94
  v_accvgpr_read_b32 v79, a95
  v_accvgpr_read_b32 v96, a144
  v_accvgpr_read_b32 v97, a145
  v_accvgpr_read_b32 v98, a146
  v_accvgpr_read_b32 v99, a147
  v_accvgpr_read_b32 v100, a148
  v_accvgpr_read_b32 v101, a149
  v_accvgpr_read_b32 v102, a150
  v_accvgpr_read_b32 v103, a151
  v_accvgpr_read_b32 v104, a152
  v_accvgpr_read_b32 v105, a153
  v_accvgpr_read_b32 v106, a154
  v_accvgpr_read_b32 v107, a155
  v_accvgpr_read_b32 v108, a156
  v_accvgpr_read_b32 v109, a157
  v_accvgpr_read_b32 v110, a158
  v_accvgpr_read_b32 v111, a159
  s_waitcnt lgkmcnt(15)
  v_max_f32 v251, v240, v208
  v_sub_f32 v14, v240, v251
  v_sub_f32 v249, v208, v251
  v_exp_f32 v14, v14
  v_exp_f32 v249, v249
  v_mul_f32 v251, v246, v14
  v_fma_f32 v251, v211, v249, v251
  v_rcp_f32 v251, v251
  s_nop 0
  v_mul_f32 v214, v14, v251
  v_mul_f32 v232, v249, v251
  v_mov_b32 v215, v214
  v_mov_b32 v233, v232
  v_max_f32 v251, v241, v209
  v_sub_f32 v14, v241, v251
  v_sub_f32 v249, v209, v251
  v_exp_f32 v14, v14
  v_exp_f32 v249, v249
  v_mul_f32 v251, v247, v14
  v_fma_f32 v251, v212, v249, v251
  v_rcp_f32 v251, v251
  s_nop 0
  v_mul_f32 v216, v14, v251
  v_mul_f32 v234, v249, v251
  v_mov_b32 v217, v216
  v_mov_b32 v235, v234
  v_max_f32 v251, v242, v210
  v_sub_f32 v14, v242, v251
  v_sub_f32 v249, v210, v251
  v_exp_f32 v14, v14
  v_exp_f32 v249, v249
  v_mul_f32 v251, v248, v14
  v_fma_f32 v251, v213, v249, v251
  v_rcp_f32 v251, v251
  s_nop 0
  v_mul_f32 v218, v14, v251
  v_mul_f32 v236, v249, v251
  v_mov_b32 v219, v218
  v_mov_b32 v237, v236
  s_waitcnt lgkmcnt(15)
  s_waitcnt lgkmcnt(15)
  v_pk_mul_f32 v[16:17], v[16:17], v[214:215]
  v_pk_mul_f32 v[18:19], v[18:19], v[214:215]
  v_pk_mul_f32 v[20:21], v[20:21], v[214:215]
  v_pk_mul_f32 v[22:23], v[22:23], v[214:215]
  v_pk_mul_f32 v[24:25], v[24:25], v[214:215]
  v_pk_mul_f32 v[26:27], v[26:27], v[214:215]
  v_pk_mul_f32 v[28:29], v[28:29], v[214:215]
  v_pk_mul_f32 v[30:31], v[30:31], v[214:215]
  v_pk_fma_f32 v[16:17], v[112:113], v[232:233], v[16:17]
  v_pk_fma_f32 v[18:19], v[114:115], v[232:233], v[18:19]
  v_pk_fma_f32 v[20:21], v[116:117], v[232:233], v[20:21]
  v_pk_fma_f32 v[22:23], v[118:119], v[232:233], v[22:23]
  v_pk_fma_f32 v[24:25], v[120:121], v[232:233], v[24:25]
  v_pk_fma_f32 v[26:27], v[122:123], v[232:233], v[26:27]
  v_pk_fma_f32 v[28:29], v[124:125], v[232:233], v[28:29]
  v_pk_fma_f32 v[30:31], v[126:127], v[232:233], v[30:31]
  v_cvt_pk_bf16_f32 v16, v16, v17
  v_cvt_pk_bf16_f32 v17, v18, v19
  v_cvt_pk_bf16_f32 v18, v20, v21
  v_cvt_pk_bf16_f32 v19, v22, v23
  v_cvt_pk_bf16_f32 v20, v24, v25
  v_cvt_pk_bf16_f32 v21, v26, v27
  v_cvt_pk_bf16_f32 v22, v28, v29
  v_cvt_pk_bf16_f32 v23, v30, v31
  s_mov_b32 s47, 0
  buffer_store_dwordx4 v[16:19], v228, s[36:39], s47 offen sc0 sc1
  s_mov_b32 s47, 1024
  buffer_store_dwordx4 v[20:23], v228, s[36:39], s47 offen sc0 sc1
  s_waitcnt lgkmcnt(15)
  s_waitcnt lgkmcnt(15)
  v_pk_mul_f32 v[32:33], v[32:33], v[214:215]
  v_pk_mul_f32 v[34:35], v[34:35], v[214:215]
  v_pk_mul_f32 v[36:37], v[36:37], v[214:215]
  v_pk_mul_f32 v[38:39], v[38:39], v[214:215]
  v_pk_mul_f32 v[40:41], v[40:41], v[214:215]
  v_pk_mul_f32 v[42:43], v[42:43], v[214:215]
  v_pk_mul_f32 v[44:45], v[44:45], v[214:215]
  v_pk_mul_f32 v[46:47], v[46:47], v[214:215]
  v_pk_fma_f32 v[32:33], v[128:129], v[232:233], v[32:33]
  v_pk_fma_f32 v[34:35], v[130:131], v[232:233], v[34:35]
  v_pk_fma_f32 v[36:37], v[132:133], v[232:233], v[36:37]
  v_pk_fma_f32 v[38:39], v[134:135], v[232:233], v[38:39]
  v_pk_fma_f32 v[40:41], v[136:137], v[232:233], v[40:41]
  v_pk_fma_f32 v[42:43], v[138:139], v[232:233], v[42:43]
  v_pk_fma_f32 v[44:45], v[140:141], v[232:233], v[44:45]
  v_pk_fma_f32 v[46:47], v[142:143], v[232:233], v[46:47]
  v_cvt_pk_bf16_f32 v32, v32, v33
  v_cvt_pk_bf16_f32 v33, v34, v35
  v_cvt_pk_bf16_f32 v34, v36, v37
  v_cvt_pk_bf16_f32 v35, v38, v39
  v_cvt_pk_bf16_f32 v36, v40, v41
  v_cvt_pk_bf16_f32 v37, v42, v43
  v_cvt_pk_bf16_f32 v38, v44, v45
  v_cvt_pk_bf16_f32 v39, v46, v47
  s_mov_b32 s47, 2048
  buffer_store_dwordx4 v[32:35], v228, s[36:39], s47 offen sc0 sc1
  s_mov_b32 s47, 3072
  buffer_store_dwordx4 v[36:39], v228, s[36:39], s47 offen sc0 sc1
  s_waitcnt lgkmcnt(12)
  v_pk_mul_f32 v[48:49], v[48:49], v[216:217]
  v_pk_mul_f32 v[50:51], v[50:51], v[216:217]
  v_pk_mul_f32 v[52:53], v[52:53], v[216:217]
  v_pk_mul_f32 v[54:55], v[54:55], v[216:217]
  v_pk_mul_f32 v[56:57], v[56:57], v[216:217]
  v_pk_mul_f32 v[58:59], v[58:59], v[216:217]
  v_pk_mul_f32 v[60:61], v[60:61], v[216:217]
  v_pk_mul_f32 v[62:63], v[62:63], v[216:217]
  v_pk_fma_f32 v[48:49], v[144:145], v[234:235], v[48:49]
  v_pk_fma_f32 v[50:51], v[146:147], v[234:235], v[50:51]
  v_pk_fma_f32 v[52:53], v[148:149], v[234:235], v[52:53]
  v_pk_fma_f32 v[54:55], v[150:151], v[234:235], v[54:55]
  v_pk_fma_f32 v[56:57], v[152:153], v[234:235], v[56:57]
  v_pk_fma_f32 v[58:59], v[154:155], v[234:235], v[58:59]
  v_pk_fma_f32 v[60:61], v[156:157], v[234:235], v[60:61]
  v_pk_fma_f32 v[62:63], v[158:159], v[234:235], v[62:63]
  v_cvt_pk_bf16_f32 v48, v48, v49
  v_cvt_pk_bf16_f32 v49, v50, v51
  v_cvt_pk_bf16_f32 v50, v52, v53
  v_cvt_pk_bf16_f32 v51, v54, v55
  v_cvt_pk_bf16_f32 v52, v56, v57
  v_cvt_pk_bf16_f32 v53, v58, v59
  v_cvt_pk_bf16_f32 v54, v60, v61
  v_cvt_pk_bf16_f32 v55, v62, v63
  s_mov_b32 s47, 8192
  buffer_store_dwordx4 v[48:51], v228, s[36:39], s47 offen sc0 sc1
  s_mov_b32 s47, 9216
  buffer_store_dwordx4 v[52:55], v228, s[36:39], s47 offen sc0 sc1
  s_waitcnt lgkmcnt(8)
  v_pk_mul_f32 v[64:65], v[64:65], v[216:217]
  v_pk_mul_f32 v[66:67], v[66:67], v[216:217]
  v_pk_mul_f32 v[68:69], v[68:69], v[216:217]
  v_pk_mul_f32 v[70:71], v[70:71], v[216:217]
  v_pk_mul_f32 v[72:73], v[72:73], v[216:217]
  v_pk_mul_f32 v[74:75], v[74:75], v[216:217]
  v_pk_mul_f32 v[76:77], v[76:77], v[216:217]
  v_pk_mul_f32 v[78:79], v[78:79], v[216:217]
  v_pk_fma_f32 v[64:65], v[160:161], v[234:235], v[64:65]
  v_pk_fma_f32 v[66:67], v[162:163], v[234:235], v[66:67]
  v_pk_fma_f32 v[68:69], v[164:165], v[234:235], v[68:69]
  v_pk_fma_f32 v[70:71], v[166:167], v[234:235], v[70:71]
  v_pk_fma_f32 v[72:73], v[168:169], v[234:235], v[72:73]
  v_pk_fma_f32 v[74:75], v[170:171], v[234:235], v[74:75]
  v_pk_fma_f32 v[76:77], v[172:173], v[234:235], v[76:77]
  v_pk_fma_f32 v[78:79], v[174:175], v[234:235], v[78:79]
  v_cvt_pk_bf16_f32 v64, v64, v65
  v_cvt_pk_bf16_f32 v65, v66, v67
  v_cvt_pk_bf16_f32 v66, v68, v69
  v_cvt_pk_bf16_f32 v67, v70, v71
  v_cvt_pk_bf16_f32 v68, v72, v73
  v_cvt_pk_bf16_f32 v69, v74, v75
  v_cvt_pk_bf16_f32 v70, v76, v77
  v_cvt_pk_bf16_f32 v71, v78, v79
  s_mov_b32 s47, 10240
  buffer_store_dwordx4 v[64:67], v228, s[36:39], s47 offen sc0 sc1
  s_mov_b32 s47, 11264
  buffer_store_dwordx4 v[68:71], v228, s[36:39], s47 offen sc0 sc1
  s_waitcnt lgkmcnt(4)
  v_pk_mul_f32 v[80:81], v[80:81], v[218:219]
  v_pk_mul_f32 v[82:83], v[82:83], v[218:219]
  v_pk_mul_f32 v[84:85], v[84:85], v[218:219]
  v_pk_mul_f32 v[86:87], v[86:87], v[218:219]
  v_pk_mul_f32 v[88:89], v[88:89], v[218:219]
  v_pk_mul_f32 v[90:91], v[90:91], v[218:219]
  v_pk_mul_f32 v[92:93], v[92:93], v[218:219]
  v_pk_mul_f32 v[94:95], v[94:95], v[218:219]
  v_pk_fma_f32 v[80:81], v[176:177], v[236:237], v[80:81]
  v_pk_fma_f32 v[82:83], v[178:179], v[236:237], v[82:83]
  v_pk_fma_f32 v[84:85], v[180:181], v[236:237], v[84:85]
  v_pk_fma_f32 v[86:87], v[182:183], v[236:237], v[86:87]
  v_pk_fma_f32 v[88:89], v[184:185], v[236:237], v[88:89]
  v_pk_fma_f32 v[90:91], v[186:187], v[236:237], v[90:91]
  v_pk_fma_f32 v[92:93], v[188:189], v[236:237], v[92:93]
  v_pk_fma_f32 v[94:95], v[190:191], v[236:237], v[94:95]
  v_cvt_pk_bf16_f32 v80, v80, v81
  v_cvt_pk_bf16_f32 v81, v82, v83
  v_cvt_pk_bf16_f32 v82, v84, v85
  v_cvt_pk_bf16_f32 v83, v86, v87
  v_cvt_pk_bf16_f32 v84, v88, v89
  v_cvt_pk_bf16_f32 v85, v90, v91
  v_cvt_pk_bf16_f32 v86, v92, v93
  v_cvt_pk_bf16_f32 v87, v94, v95
  s_mov_b32 s47, 16384
  buffer_store_dwordx4 v[80:83], v228, s[36:39], s47 offen sc0 sc1
  s_mov_b32 s47, 17408
  buffer_store_dwordx4 v[84:87], v228, s[36:39], s47 offen sc0 sc1
  s_waitcnt lgkmcnt(0)
  v_pk_mul_f32 v[96:97], v[96:97], v[218:219]
  v_pk_mul_f32 v[98:99], v[98:99], v[218:219]
  v_pk_mul_f32 v[100:101], v[100:101], v[218:219]
  v_pk_mul_f32 v[102:103], v[102:103], v[218:219]
  v_pk_mul_f32 v[104:105], v[104:105], v[218:219]
  v_pk_mul_f32 v[106:107], v[106:107], v[218:219]
  v_pk_mul_f32 v[108:109], v[108:109], v[218:219]
  v_pk_mul_f32 v[110:111], v[110:111], v[218:219]
  v_pk_fma_f32 v[96:97], v[192:193], v[236:237], v[96:97]
  v_pk_fma_f32 v[98:99], v[194:195], v[236:237], v[98:99]
  v_pk_fma_f32 v[100:101], v[196:197], v[236:237], v[100:101]
  v_pk_fma_f32 v[102:103], v[198:199], v[236:237], v[102:103]
  v_pk_fma_f32 v[104:105], v[200:201], v[236:237], v[104:105]
  v_pk_fma_f32 v[106:107], v[202:203], v[236:237], v[106:107]
  v_pk_fma_f32 v[108:109], v[204:205], v[236:237], v[108:109]
  v_pk_fma_f32 v[110:111], v[206:207], v[236:237], v[110:111]
  v_cvt_pk_bf16_f32 v96, v96, v97
  v_cvt_pk_bf16_f32 v97, v98, v99
  v_cvt_pk_bf16_f32 v98, v100, v101
  v_cvt_pk_bf16_f32 v99, v102, v103
  v_cvt_pk_bf16_f32 v100, v104, v105
  v_cvt_pk_bf16_f32 v101, v106, v107
  v_cvt_pk_bf16_f32 v102, v108, v109
  v_cvt_pk_bf16_f32 v103, v110, v111
  s_mov_b32 s47, 18432
  buffer_store_dwordx4 v[96:99], v228, s[36:39], s47 offen sc0 sc1
  s_mov_b32 s47, 19456
  buffer_store_dwordx4 v[100:103], v228, s[36:39], s47 offen sc0 sc1
  s_waitcnt vmcnt(0)
  s_barrier
  s_add_u32 s56, s12, 33554432
  s_addc_u32 s57, s13, 0
  s_mov_b32 s58, 65536
  s_mov_b32 s59, 131072
  s_mov_b32 s45, 30000
L_p2_n0:
  v_readfirstlane_b32 s10, v255
  s_cmp_lg_u32 s10, 0
  s_cbranch_scc1 L_p2_n1
  s_mov_b32 s40, s90
  s_mov_b32 s41, s91
  s_mov_b32 s42, 4
  s_mov_b32 s43, 131072
  v_mov_b32 v5, 0
  buffer_load_dword v255, v5, s[40:43], 0 offen sc0 sc1
  s_waitcnt vmcnt(0)
  s_sub_u32 s45, s45, 1
  s_cmp_lg_u32 s45, 0
  s_cbranch_scc1 L_p2_n0
L_p2_n1:
  s_cmp_lg_u32 s19, 0
  s_cbranch_scc1 L_p2_w1
  s_lshl_b32 s40, s16, 5
  s_add_u32 s40, s40, s17
  s_lshl_b32 s40, s40, 7
  v_mov_b32 v5, s40
  s_mov_b64 exec, 1
  buffer_store_dword v255, v5, s[56:59], 0 offen sc0 sc1
  s_mov_b64 exec, -1
L_p2_w1:
  s_cmp_ge_u32 s2, 240
  s_cbranch_scc1 L_attn_end
  s_mul_i32 s11, s4, 10
  s_add_u32 s11, s11, s5
  s_lshl_b32 s41, s11, 15
  s_add_u32 s41, s41, 16777216
  s_add_u32 s28, s12, s41
  s_addc_u32 s29, s13, 0
  s_mov_b32 s30, 32768
  s_mov_b32 s31, 131072
  s_mul_i32 s41, s4, 163840
  s_lshl_b32 s40, s5, 7
  s_add_u32 s40, s40, s9
  s_add_u32 s41, s41, s40
  s_add_u32 s32, s88, s41
  s_addc_u32 s33, s89, 0
  s_sub_u32 s34, 163840, s40
  s_mov_b32 s35, 131072
  v_lshrrev_b32 v5, 5, v1
  v_bfe_u32 v6, v1, 2, 2
  v_lshl_add_u32 v5, v5, 2, v6
  v_bfe_u32 v7, v1, 4, 1
  v_bfe_u32 v8, v1, 1, 1
  v_lshl_add_u32 v7, v7, 1, v8
  v_bfe_u32 v8, v1, 3, 1
  v_lshl_add_u32 v7, v8, 2, v7
  v_lshlrev_b32 v7, 4, v7
  v_xor_b32 v7, s9, v7
  v_lshl_add_u32 v5, v5, 7, v7
  v_and_b32 v8, 1, v1
  v_lshl_add_u32 v232, v8, 3, v5
  v_xor_b32 v233, 64, v232
  v_add_u32 v234, 65536, v232
  v_add_u32 v235, 65536, v233
  v_add_u32 v236, 131072, v232
  v_add_u32 v237, 131072, v233
  s_add_u32 s43, s8, 1
  s_and_b32 s43, s43, 1
  s_add_u32 s43, s43, 2
  s_mul_i32 s43, s43, 163840
  s_add_u32 m0, s48, 0
  s_nop 0
  buffer_load_dwordx4 v252, s[24:27], s43 offen lds
  s_add_u32 m0, s48, 4096
  s_add_u32 s43, s43, 40960
  buffer_load_dwordx4 v252, s[24:27], s43 offen lds
  s_add_u32 m0, s48, 8192
  s_add_u32 s43, s43, 40960
  buffer_load_dwordx4 v252, s[24:27], s43 offen lds
  s_add_u32 m0, s48, 12288
  s_add_u32 s43, s43, 40960
  buffer_load_dwordx4 v252, s[24:27], s43 offen lds
  s_add_u32 s43, s8, 0
  s_and_b32 s43, s43, 1
  s_add_u32 s43, s43, 4
  s_mul_i32 s43, s43, 163840
  s_add_u32 m0, s48, 16384
  s_nop 0
  buffer_load_dwordx4 v252, s[24:27], s43 offen lds
  s_add_u32 m0, s48, 20480
  s_add_u32 s43, s43, 40960
  buffer_load_dwordx4 v252, s[24:27], s43 offen lds
  s_add_u32 m0, s48, 24576
  s_add_u32 s43, s43, 40960
  buffer_load_dwordx4 v252, s[24:27], s43 offen lds
  s_add_u32 m0, s48, 28672
  s_add_u32 s43, s43, 40960
  buffer_load_dwordx4 v252, s[24:27], s43 offen lds
  s_add_u32 s43, s8, 1
  s_and_b32 s43, s43, 1
  s_add_u32 s43, s43, 4
  s_mul_i32 s43, s43, 163840
  s_add_u32 m0, s48, 32768
  s_nop 0
  buffer_load_dwordx4 v252, s[24:27], s43 offen lds
  s_add_u32 m0, s48, 36864
  s_add_u32 s43, s43, 40960
  buffer_load_dwordx4 v252, s[24:27], s43 offen lds
  s_add_u32 m0, s48, 40960
  s_add_u32 s43, s43, 40960
  buffer_load_dwordx4 v252, s[24:27], s43 offen lds
  s_add_u32 m0, s48, 45056
  s_add_u32 s43, s43, 40960
  buffer_load_dwordx4 v252, s[24:27], s43 offen lds
  s_add_u32 s43, s8, 0
  s_and_b32 s43, s43, 1
  s_add_u32 s43, s43, 6
  s_mul_i32 s43, s43, 163840
  s_add_u32 m0, s48, 49152
  s_nop 0
  buffer_load_dwordx4 v252, s[24:27], s43 offen lds
  s_add_u32 m0, s48, 53248
  s_add_u32 s43, s43, 40960
  buffer_load_dwordx4 v252, s[24:27], s43 offen lds
  s_add_u32 m0, s48, 57344
  s_add_u32 s43, s43, 40960
  buffer_load_dwordx4 v252, s[24:27], s43 offen lds
  s_add_u32 m0, s48, 61440
  s_add_u32 s43, s43, 40960
  buffer_load_dwordx4 v252, s[24:27], s43 offen lds
  s_add_u32 s43, s8, 1
  s_and_b32 s43, s43, 1
  s_add_u32 s43, s43, 6
  s_mul_i32 s43, s43, 163840
  s_add_u32 m0, s48, 65536
  s_nop 0
  buffer_load_dwordx4 v252, s[24:27], s43 offen lds
  s_add_u32 m0, s48, 69632
  s_add_u32 s43, s43, 40960
  buffer_load_dwordx4 v252, s[24:27], s43 offen lds
  s_add_u32 m0, s48, 73728
  s_add_u32 s43, s43, 40960
  buffer_load_dwordx4 v252, s[24:27], s43 offen lds
  s_add_u32 m0, s48, 77824
  s_add_u32 s43, s43, 40960
  buffer_load_dwordx4 v252, s[24:27], s43 offen lds
  s_add_u32 s43, s8, 0
  s_and_b32 s43, s43, 1
  s_add_u32 s43, s43, 8
  s_mul_i32 s43, s43, 163840
  s_add_u32 m0, s48, 81920
  s_nop 0
  buffer_load_dwordx4 v252, s[24:27], s43 offen lds
  s_add_u32 m0, s48, 86016
  s_add_u32 s43, s43, 40960
  buffer_load_dwordx4 v252, s[24:27], s43 offen lds
  s_add_u32 m0, s48, 90112
  s_add_u32 s43, s43, 40960
  buffer_load_dwordx4 v252, s[24:27], s43 offen lds
  s_add_u32 m0, s48, 94208
  s_add_u32 s43, s43, 40960
  buffer_load_dwordx4 v252, s[24:27], s43 offen lds
  s_add_u32 s43, s8, 1
  s_and_b32 s43, s43, 1
  s_add_u32 s43, s43, 8
  s_mul_i32 s43, s43, 163840
  s_add_u32 m0, s48, 147456
  s_nop 0
  buffer_load_dwordx4 v252, s[24:27], s43 offen lds
  s_add_u32 m0, s48, 151552
  s_add_u32 s43, s43, 40960
  buffer_load_dwordx4 v252, s[24:27], s43 offen lds
  s_add_u32 m0, s48, 155648
  s_add_u32 s43, s43, 40960
  buffer_load_dwordx4 v252, s[24:27], s43 offen lds
  s_add_u32 m0, s48, 159744
  s_add_u32 s43, s43, 40960
  buffer_load_dwordx4 v252, s[24:27], s43 offen lds
  v_lshlrev_b32 v14, 4, v1
  v_lshl_add_u32 v14, v2, 10, v14
  v_add_u32 v15, 65536, v14
  v_add_u32 v9, 131072, v14
  s_cmp_lg_u32 s19, 0
  s_cbranch_scc1 L_p2_w2
  s_lshl_b32 s40, s4, 1
  s_mul_i32 s41, s40, 43
  s_lshr_b32 s41, s41, 7
  s_add_u32 s40, s40, 1
  s_mul_i32 s40, s40, 43
  s_lshr_b32 s40, s40, 7
  v_mov_b32 v5, s41
  v_mov_b32 v6, s40
  v_cmp_gt_u32 vcc, 16, v1
  s_nop 1
  v_cndmask_b32 v5, v6, v5, vcc
  v_lshlrev_b32 v5, 5, v5
  v_and_b32 v6, 15, v1
  v_add_u32 v5, v5, v6
  s_lshl_b32 s40, s7, 4
  v_add_u32 v5, s40, v5
  v_lshlrev_b32 v5, 7, v5
  s_mov_b64 exec, 0xffffffff
  s_mov_b32 s45, 30000
L_p2_p0:
  buffer_load_dword v6, v5, s[56:59], 0 offen sc0 sc1
  s_waitcnt vmcnt(0)
  v_cmp_ne_u32 vcc, v6, v255
  s_cbranch_vccz L_p2_p1
  s_sleep 1
  s_sub_u32 s45, s45, 1
  s_cmp_lg_u32 s45, 0
  s_cbranch_scc1 L_p2_p0
L_p2_p1:
  s_mov_b64 exec, -1
L_p2_w2:
  s_barrier
  s_add_u32 s44, s8, 0
  s_and_b32 s44, s44, 1
  s_add_u32 s44, s44, 0
  s_mul_i32 s44, s44, 393216
  buffer_load_dwordx4 v[64:67], v253, s[20:23], s44 offen sc1
  buffer_load_dwordx4 v[68:71], v253, s[20:23], s44 offen offset:1024 sc1
  buffer_load_dwordx4 v[72:75], v253, s[20:23], s44 offen offset:2048 sc1
  buffer_load_dwordx4 v[76:79], v253, s[20:23], s44 offen offset:3072 sc1
  buffer_load_dwordx4 v[80:83], v254, s[20:23], s44 offen sc1
  buffer_load_dwordx4 v[84:87], v254, s[20:23], s44 offen offset:1024 sc1
  buffer_load_dwordx4 v[88:91], v254, s[20:23], s44 offen offset:2048 sc1
  buffer_load_dwordx4 v[92:95], v254, s[20:23], s44 offen offset:3072 sc1
  s_add_u32 s44, s8, 1
  s_and_b32 s44, s44, 1
  s_add_u32 s44, s44, 0
  s_mul_i32 s44, s44, 393216
  buffer_load_dwordx4 v[96:99], v253, s[20:23], s44 offen sc1
  buffer_load_dwordx4 v[100:103], v253, s[20:23], s44 offen offset:1024 sc1
  buffer_load_dwordx4 v[104:107], v253, s[20:23], s44 offen offset:2048 sc1
  buffer_load_dwordx4 v[108:111], v253, s[20:23], s44 offen offset:3072 sc1
  buffer_load_dwordx4 v[112:115], v254, s[20:23], s44 offen sc1
  buffer_load_dwordx4 v[116:119], v254, s[20:23], s44 offen offset:1024 sc1
  buffer_load_dwordx4 v[120:123], v254, s[20:23], s44 offen offset:2048 sc1
  buffer_load_dwordx4 v[124:127], v254, s[20:23], s44 offen offset:3072 sc1
  s_waitcnt vmcnt(8)
  s_barrier
  ds_read_b64_tr_b16 v[192:193], v234 offset:32768
  ds_read_b64_tr_b16 v[194:195], v234 offset:33792
  ds_read_b64_tr_b16 v[196:197], v235 offset:32768
  ds_read_b64_tr_b16 v[198:199], v235 offset:33792
  ds_read_b64_tr_b16 v[200:201], v234 offset:34816
  ds_read_b64_tr_b16 v[202:203], v234 offset:35840
  ds_read_b64_tr_b16 v[204:205], v235 offset:34816
  ds_read_b64_tr_b16 v[206:207], v235 offset:35840
  s_waitcnt lgkmcnt(0)
  v_mfma_f32_32x32x16_bf16 v[48:63], v[196:199], v[64:67], 0
  ds_read_b64_tr_b16 v[208:209], v234 offset:36864
  ds_read_b64_tr_b16 v[210:211], v234 offset:37888
  ds_read_b64_tr_b16 v[212:213], v235 offset:36864
  ds_read_b64_tr_b16 v[214:215], v235 offset:37888
  v_mfma_f32_32x32x16_bf16 v[32:47], v[192:195], v[64:67], 0
  ds_read_b64_tr_b16 v[216:217], v234 offset:38912
  ds_read_b64_tr_b16 v[218:219], v234 offset:39936
  ds_read_b64_tr_b16 v[220:221], v235 offset:38912
  ds_read_b64_tr_b16 v[222:223], v235 offset:39936
  v_mfma_f32_32x32x16_bf16 v[48:63], v[204:207], v[68:71], v[48:63]
  s_add_u32 s44, s8, 0
  s_and_b32 s44, s44, 1
  s_add_u32 s44, s44, 2
  s_mul_i32 s44, s44, 393216
  buffer_load_dwordx4 v[128:131], v253, s[20:23], s44 offen sc1
  v_mfma_f32_32x32x16_bf16 v[32:47], v[200:203], v[68:71], v[32:47]
  buffer_load_dwordx4 v[132:135], v253, s[20:23], s44 offen offset:1024 sc1
  s_waitcnt lgkmcnt(0)
  v_mfma_f32_32x32x16_bf16 v[48:63], v[212:215], v[72:75], v[48:63]
  ds_read_b64_tr_b16 v[192:193], v234 offset:40960
  ds_read_b64_tr_b16 v[194:195], v234 offset:41984
  ds_read_b64_tr_b16 v[196:197], v235 offset:40960
  ds_read_b64_tr_b16 v[198:199], v235 offset:41984
  v_mfma_f32_32x32x16_bf16 v[32:47], v[208:211], v[72:75], v[32:47]
  ds_read_b64_tr_b16 v[200:201], v234 offset:43008
  ds_read_b64_tr_b16 v[202:203], v234 offset:44032
  ds_read_b64_tr_b16 v[204:205], v235 offset:43008
  ds_read_b64_tr_b16 v[206:207], v235 offset:44032
  v_mfma_f32_32x32x16_bf16 v[48:63], v[220:223], v[76:79], v[48:63]
  buffer_load_dwordx4 v[136:139], v253, s[20:23], s44 offen offset:2048 sc1
  v_mfma_f32_32x32x16_bf16 v[32:47], v[216:219], v[76:79], v[32:47]
  buffer_load_dwordx4 v[140:143], v253, s[20:23], s44 offen offset:3072 sc1
  s_waitcnt lgkmcnt(0)
  v_mfma_f32_32x32x16_bf16 v[48:63], v[196:199], v[80:83], v[48:63]
  ds_read_b64_tr_b16 v[208:209], v234 offset:45056
  ds_read_b64_tr_b16 v[210:211], v234 offset:46080
  ds_read_b64_tr_b16 v[212:213], v235 offset:45056
  ds_read_b64_tr_b16 v[214:215], v235 offset:46080
  v_mfma_f32_32x32x16_bf16 v[32:47], v[192:195], v[80:83], v[32:47]
  ds_read_b64_tr_b16 v[216:217], v234 offset:47104
  ds_read_b64_tr_b16 v[218:219], v234 offset:48128
  ds_read_b64_tr_b16 v[220:221], v235 offset:47104
  ds_read_b64_tr_b16 v[222:223], v235 offset:48128
  v_mfma_f32_32x32x16_bf16 v[48:63], v[204:207], v[84:87], v[48:63]
  buffer_load_dwordx4 v[144:147], v254, s[20:23], s44 offen sc1
  v_mfma_f32_32x32x16_bf16 v[32:47], v[200:203], v[84:87], v[32:47]
  buffer_load_dwordx4 v[148:151], v254, s[20:23], s44 offen offset:1024 sc1
  s_waitcnt lgkmcnt(0)
  v_mfma_f32_32x32x16_bf16 v[48:63], v[212:215], v[88:91], v[48:63]
  s_waitcnt vmcnt(6)
  s_barrier
  ds_read_b64_tr_b16 v[192:193], v234 offset:49152
  ds_read_b64_tr_b16 v[194:195], v234 offset:50176
  ds_read_b64_tr_b16 v[196:197], v235 offset:49152
  ds_read_b64_tr_b16 v[198:199], v235 offset:50176
  v_mfma_f32_32x32x16_bf16 v[32:47], v[208:211], v[88:91], v[32:47]
  ds_read_b64_tr_b16 v[200:201], v234 offset:51200
  ds_read_b64_tr_b16 v[202:203], v234 offset:52224
  ds_read_b64_tr_b16 v[204:205], v235 offset:51200
  ds_read_b64_tr_b16 v[206:207], v235 offset:52224
  buffer_load_dwordx4 v[152:155], v254, s[20:23], s44 offen offset:2048 sc1
  v_mfma_f32_32x32x16_bf16 v[48:63], v[220:223], v[92:95], v[48:63]
  buffer_load_dwordx4 v[156:159], v254, s[20:23], s44 offen offset:3072 sc1
  v_mfma_f32_32x32x16_bf16 v[32:47], v[216:219], v[92:95], v[32:47]
  s_add_u32 s43, s8, 0
  s_and_b32 s43, s43, 1
  s_add_u32 s43, s43, 10
  s_mul_i32 s43, s43, 163840
  s_add_u32 m0, s48, 98304
  s_nop 0
  buffer_load_dwordx4 v252, s[24:27], s43 offen lds
  s_waitcnt lgkmcnt(0)
  v_mfma_f32_32x32x16_bf16 v[48:63], v[196:199], v[96:99], v[48:63]
  ds_read_b64_tr_b16 v[208:209], v234 offset:53248
  ds_read_b64_tr_b16 v[210:211], v234 offset:54272
  ds_read_b64_tr_b16 v[212:213], v235 offset:53248
  ds_read_b64_tr_b16 v[214:215], v235 offset:54272
  v_mfma_f32_32x32x16_bf16 v[32:47], v[192:195], v[96:99], v[32:47]
  ds_read_b64_tr_b16 v[216:217], v234 offset:55296
  ds_read_b64_tr_b16 v[218:219], v234 offset:56320
  ds_read_b64_tr_b16 v[220:221], v235 offset:55296
  ds_read_b64_tr_b16 v[222:223], v235 offset:56320
  v_mfma_f32_32x32x16_bf16 v[48:63], v[204:207], v[100:103], v[48:63]
  s_add_u32 s44, s8, 1
  s_and_b32 s44, s44, 1
  s_add_u32 s44, s44, 2
  s_mul_i32 s44, s44, 393216
  buffer_load_dwordx4 v[160:163], v253, s[20:23], s44 offen sc1
  v_mfma_f32_32x32x16_bf16 v[32:47], v[200:203], v[100:103], v[32:47]
  buffer_load_dwordx4 v[164:167], v253, s[20:23], s44 offen offset:1024 sc1
  s_add_u32 m0, s48, 102400
  s_add_u32 s43, s43, 40960
  buffer_load_dwordx4 v252, s[24:27], s43 offen lds
  s_waitcnt lgkmcnt(0)
  v_mfma_f32_32x32x16_bf16 v[48:63], v[212:215], v[104:107], v[48:63]
  ds_read_b64_tr_b16 v[192:193], v234 offset:57344
  ds_read_b64_tr_b16 v[194:195], v234 offset:58368
  ds_read_b64_tr_b16 v[196:197], v235 offset:57344
  ds_read_b64_tr_b16 v[198:199], v235 offset:58368
  v_mfma_f32_32x32x16_bf16 v[32:47], v[208:211], v[104:107], v[32:47]
  ds_read_b64_tr_b16 v[200:201], v234 offset:59392
  ds_read_b64_tr_b16 v[202:203], v234 offset:60416
  ds_read_b64_tr_b16 v[204:205], v235 offset:59392
  ds_read_b64_tr_b16 v[206:207], v235 offset:60416
  v_mfma_f32_32x32x16_bf16 v[48:63], v[220:223], v[108:111], v[48:63]
  buffer_load_dwordx4 v[168:171], v253, s[20:23], s44 offen offset:2048 sc1
  buffer_load_dwordx4 v[172:175], v253, s[20:23], s44 offen offset:3072 sc1
  v_mfma_f32_32x32x16_bf16 v[32:47], v[216:219], v[108:111], v[32:47]
  s_add_u32 m0, s48, 106496
  s_add_u32 s43, s43, 40960
  buffer_load_dwordx4 v252, s[24:27], s43 offen lds
  s_waitcnt lgkmcnt(0)
  v_mfma_f32_32x32x16_bf16 v[48:63], v[196:199], v[112:115], v[48:63]
  ds_read_b64_tr_b16 v[208:209], v234 offset:61440
  ds_read_b64_tr_b16 v[210:211], v234 offset:62464
  ds_read_b64_tr_b16 v[212:213], v235 offset:61440
  ds_read_b64_tr_b16 v[214:215], v235 offset:62464
  v_mfma_f32_32x32x16_bf16 v[32:47], v[192:195], v[112:115], v[32:47]
  ds_read_b64_tr_b16 v[216:217], v234 offset:63488
  ds_read_b64_tr_b16 v[218:219], v234 offset:64512
  ds_read_b64_tr_b16 v[220:221], v235 offset:63488
  ds_read_b64_tr_b16 v[222:223], v235 offset:64512
  v_mfma_f32_32x32x16_bf16 v[48:63], v[204:207], v[116:119], v[48:63]
  buffer_load_dwordx4 v[176:179], v254, s[20:23], s44 offen sc1
  buffer_load_dwordx4 v[180:183], v254, s[20:23], s44 offen offset:1024 sc1
  v_mfma_f32_32x32x16_bf16 v[32:47], v[200:203], v[116:119], v[32:47]
  s_add_u32 m0, s48, 110592
  s_add_u32 s43, s43, 40960
  buffer_load_dwordx4 v252, s[24:27], s43 offen lds
  s_waitcnt lgkmcnt(0)
  v_mfma_f32_32x32x16_bf16 v[48:63], v[212:215], v[120:123], v[48:63]
  s_waitcnt vmcnt(10)
  s_barrier
  ds_read_b64_tr_b16 v[192:193], v236
  ds_read_b64_tr_b16 v[194:195], v236 offset:1024
  ds_read_b64_tr_b16 v[196:197], v237
  ds_read_b64_tr_b16 v[198:199], v237 offset:1024
  v_mfma_f32_32x32x16_bf16 v[32:47], v[208:211], v[120:123], v[32:47]
  ds_read_b64_tr_b16 v[200:201], v236 offset:2048
  ds_read_b64_tr_b16 v[202:203], v236 offset:3072
  ds_read_b64_tr_b16 v[204:205], v237 offset:2048
  ds_read_b64_tr_b16 v[206:207], v237 offset:3072
  buffer_load_dwordx4 v[184:187], v254, s[20:23], s44 offen offset:2048 sc1
  v_mfma_f32_32x32x16_bf16 v[48:63], v[220:223], v[124:127], v[48:63]
  buffer_load_dwordx4 v[188:191], v254, s[20:23], s44 offen offset:3072 sc1
  v_mfma_f32_32x32x16_bf16 v[32:47], v[216:219], v[124:127], v[32:47]
  s_add_u32 s43, s8, 1
  s_and_b32 s43, s43, 1
  s_add_u32 s43, s43, 10
  s_mul_i32 s43, s43, 163840
  s_add_u32 m0, s48, 114688
  s_nop 0
  buffer_load_dwordx4 v252, s[24:27], s43 offen lds
  s_waitcnt lgkmcnt(0)
  v_mfma_f32_32x32x16_bf16 v[48:63], v[196:199], v[128:131], v[48:63]
  ds_read_b64_tr_b16 v[208:209], v236 offset:4096
  ds_read_b64_tr_b16 v[210:211], v236 offset:5120
  ds_read_b64_tr_b16 v[212:213], v237 offset:4096
  ds_read_b64_tr_b16 v[214:215], v237 offset:5120
  v_mfma_f32_32x32x16_bf16 v[32:47], v[192:195], v[128:131], v[32:47]
  ds_read_b64_tr_b16 v[216:217], v236 offset:6144
  ds_read_b64_tr_b16 v[218:219], v236 offset:7168
  ds_read_b64_tr_b16 v[220:221], v237 offset:6144
  ds_read_b64_tr_b16 v[222:223], v237 offset:7168
  v_mfma_f32_32x32x16_bf16 v[48:63], v[204:207], v[132:135], v[48:63]
  s_add_u32 s44, s8, 0
  s_and_b32 s44, s44, 1
  s_add_u32 s44, s44, 4
  s_mul_i32 s44, s44, 393216
  buffer_load_dwordx4 v[64:67], v253, s[20:23], s44 offen sc1
  v_mfma_f32_32x32x16_bf16 v[32:47], v[200:203], v[132:135], v[32:47]
  buffer_load_dwordx4 v[68:71], v253, s[20:23], s44 offen offset:1024 sc1
  s_add_u32 m0, s48, 118784
  s_add_u32 s43, s43, 40960
  buffer_load_dwordx4 v252, s[24:27], s43 offen lds
  s_waitcnt lgkmcnt(0)
  v_mfma_f32_32x32x16_bf16 v[48:63], v[212:215], v[136:139], v[48:63]
  ds_read_b64_tr_b16 v[192:193], v236 offset:8192
  ds_read_b64_tr_b16 v[194:195], v236 offset:9216
  ds_read_b64_tr_b16 v[196:197], v237 offset:8192
  ds_read_b64_tr_b16 v[198:199], v237 offset:9216
  v_mfma_f32_32x32x16_bf16 v[32:47], v[208:211], v[136:139], v[32:47]
  ds_read_b64_tr_b16 v[200:201], v236 offset:10240
  ds_read_b64_tr_b16 v[202:203], v236 offset:11264
  ds_read_b64_tr_b16 v[204:205], v237 offset:10240
  ds_read_b64_tr_b16 v[206:207], v237 offset:11264
  v_mfma_f32_32x32x16_bf16 v[48:63], v[220:223], v[140:143], v[48:63]
  buffer_load_dwordx4 v[72:75], v253, s[20:23], s44 offen offset:2048 sc1
  buffer_load_dwordx4 v[76:79], v253, s[20:23], s44 offen offset:3072 sc1
  v_mfma_f32_32x32x16_bf16 v[32:47], v[216:219], v[140:143], v[32:47]
  s_add_u32 m0, s48, 122880
  s_add_u32 s43, s43, 40960
  buffer_load_dwordx4 v252, s[24:27], s43 offen lds
  s_waitcnt lgkmcnt(0)
  v_mfma_f32_32x32x16_bf16 v[48:63], v[196:199], v[144:147], v[48:63]
  ds_read_b64_tr_b16 v[208:209], v236 offset:12288
  ds_read_b64_tr_b16 v[210:211], v236 offset:13312
  ds_read_b64_tr_b16 v[212:213], v237 offset:12288
  ds_read_b64_tr_b16 v[214:215], v237 offset:13312
  v_mfma_f32_32x32x16_bf16 v[32:47], v[192:195], v[144:147], v[32:47]
  ds_read_b64_tr_b16 v[216:217], v236 offset:14336
  ds_read_b64_tr_b16 v[218:219], v236 offset:15360
  ds_read_b64_tr_b16 v[220:221], v237 offset:14336
  ds_read_b64_tr_b16 v[222:223], v237 offset:15360
  v_mfma_f32_32x32x16_bf16 v[48:63], v[204:207], v[148:151], v[48:63]
  buffer_load_dwordx4 v[80:83], v254, s[20:23], s44 offen sc1
  buffer_load_dwordx4 v[84:87], v254, s[20:23], s44 offen offset:1024 sc1
  v_mfma_f32_32x32x16_bf16 v[32:47], v[200:203], v[148:151], v[32:47]
  s_add_u32 m0, s48, 126976
  s_add_u32 s43, s43, 40960
  buffer_load_dwordx4 v252, s[24:27], s43 offen lds
  s_waitcnt lgkmcnt(0)
  v_mfma_f32_32x32x16_bf16 v[48:63], v[212:215], v[152:155], v[48:63]
  s_waitcnt vmcnt(10)
  s_barrier
  ds_read_b64_tr_b16 v[192:193], v232
  ds_read_b64_tr_b16 v[194:195], v232 offset:1024
  ds_read_b64_tr_b16 v[196:197], v233
  ds_read_b64_tr_b16 v[198:199], v233 offset:1024
  v_mfma_f32_32x32x16_bf16 v[32:47], v[208:211], v[152:155], v[32:47]
  ds_read_b64_tr_b16 v[200:201], v232 offset:2048
  ds_read_b64_tr_b16 v[202:203], v232 offset:3072
  ds_read_b64_tr_b16 v[204:205], v233 offset:2048
  ds_read_b64_tr_b16 v[206:207], v233 offset:3072
  buffer_load_dwordx4 v[88:91], v254, s[20:23], s44 offen offset:2048 sc1
  v_mfma_f32_32x32x16_bf16 v[48:63], v[220:223], v[156:159], v[48:63]
  buffer_load_dwordx4 v[92:95], v254, s[20:23], s44 offen offset:3072 sc1
  v_mfma_f32_32x32x16_bf16 v[32:47], v[216:219], v[156:159], v[32:47]
  s_add_u32 s43, s8, 0
  s_and_b32 s43, s43, 1
  s_add_u32 s43, s43, 12
  s_mul_i32 s43, s43, 163840
  s_add_u32 m0, s48, 131072
  s_nop 0
  buffer_load_dwordx4 v252, s[24:27], s43 offen lds
  s_waitcnt lgkmcnt(0)
  v_mfma_f32_32x32x16_bf16 v[48:63], v[196:199], v[160:163], v[48:63]
  ds_read_b64_tr_b16 v[208:209], v232 offset:4096
  ds_read_b64_tr_b16 v[210:211], v232 offset:5120
  ds_read_b64_tr_b16 v[212:213], v233 offset:4096
  ds_read_b64_tr_b16 v[214:215], v233 offset:5120
  v_mfma_f32_32x32x16_bf16 v[32:47], v[192:195], v[160:163], v[32:47]
  ds_read_b64_tr_b16 v[216:217], v232 offset:6144
  ds_read_b64_tr_b16 v[218:219], v232 offset:7168
  ds_read_b64_tr_b16 v[220:221], v233 offset:6144
  ds_read_b64_tr_b16 v[222:223], v233 offset:7168
  v_mfma_f32_32x32x16_bf16 v[48:63], v[204:207], v[164:167], v[48:63]
  s_add_u32 s44, s8, 1
  s_and_b32 s44, s44, 1
  s_add_u32 s44, s44, 4
  s_mul_i32 s44, s44, 393216
  buffer_load_dwordx4 v[96:99], v253, s[20:23], s44 offen sc1
  v_mfma_f32_32x32x16_bf16 v[32:47], v[200:203], v[164:167], v[32:47]
  buffer_load_dwordx4 v[100:103], v253, s[20:23], s44 offen offset:1024 sc1
  s_add_u32 m0, s48, 135168
  s_add_u32 s43, s43, 40960
  buffer_load_dwordx4 v252, s[24:27], s43 offen lds
  s_waitcnt lgkmcnt(0)
  v_mfma_f32_32x32x16_bf16 v[48:63], v[212:215], v[168:171], v[48:63]
  ds_read_b64_tr_b16 v[192:193], v232 offset:8192
  ds_read_b64_tr_b16 v[194:195], v232 offset:9216
  ds_read_b64_tr_b16 v[196:197], v233 offset:8192
  ds_read_b64_tr_b16 v[198:199], v233 offset:9216
  v_mfma_f32_32x32x16_bf16 v[32:47], v[208:211], v[168:171], v[32:47]
  ds_read_b64_tr_b16 v[200:201], v232 offset:10240
  ds_read_b64_tr_b16 v[202:203], v232 offset:11264
  ds_read_b64_tr_b16 v[204:205], v233 offset:10240
  ds_read_b64_tr_b16 v[206:207], v233 offset:11264
  v_mfma_f32_32x32x16_bf16 v[48:63], v[220:223], v[172:175], v[48:63]
  buffer_load_dwordx4 v[104:107], v253, s[20:23], s44 offen offset:2048 sc1
  buffer_load_dwordx4 v[108:111], v253, s[20:23], s44 offen offset:3072 sc1
  v_mfma_f32_32x32x16_bf16 v[32:47], v[216:219], v[172:175], v[32:47]
  s_add_u32 m0, s48, 139264
  s_add_u32 s43, s43, 40960
  buffer_load_dwordx4 v252, s[24:27], s43 offen lds
  s_waitcnt lgkmcnt(0)
  v_mfma_f32_32x32x16_bf16 v[48:63], v[196:199], v[176:179], v[48:63]
  ds_read_b64_tr_b16 v[208:209], v232 offset:12288
  ds_read_b64_tr_b16 v[210:211], v232 offset:13312
  ds_read_b64_tr_b16 v[212:213], v233 offset:12288
  ds_read_b64_tr_b16 v[214:215], v233 offset:13312
  v_mfma_f32_32x32x16_bf16 v[32:47], v[192:195], v[176:179], v[32:47]
  ds_read_b64_tr_b16 v[216:217], v232 offset:14336
  ds_read_b64_tr_b16 v[218:219], v232 offset:15360
  ds_read_b64_tr_b16 v[220:221], v233 offset:14336
  ds_read_b64_tr_b16 v[222:223], v233 offset:15360
  v_mfma_f32_32x32x16_bf16 v[48:63], v[204:207], v[180:183], v[48:63]
  buffer_load_dwordx4 v[112:115], v254, s[20:23], s44 offen sc1
  buffer_load_dwordx4 v[116:119], v254, s[20:23], s44 offen offset:1024 sc1
  v_mfma_f32_32x32x16_bf16 v[32:47], v[200:203], v[180:183], v[32:47]
  s_add_u32 m0, s48, 143360
  s_add_u32 s43, s43, 40960
  buffer_load_dwordx4 v252, s[24:27], s43 offen lds
  s_waitcnt lgkmcnt(0)
  v_mfma_f32_32x32x16_bf16 v[48:63], v[212:215], v[184:187], v[48:63]
  s_waitcnt vmcnt(10)
  s_barrier
  ds_read_b64_tr_b16 v[192:193], v232 offset:16384
  ds_read_b64_tr_b16 v[194:195], v232 offset:17408
  ds_read_b64_tr_b16 v[196:197], v233 offset:16384
  ds_read_b64_tr_b16 v[198:199], v233 offset:17408
  v_mfma_f32_32x32x16_bf16 v[32:47], v[208:211], v[184:187], v[32:47]
  ds_read_b64_tr_b16 v[200:201], v232 offset:18432
  ds_read_b64_tr_b16 v[202:203], v232 offset:19456
  ds_read_b64_tr_b16 v[204:205], v233 offset:18432
  ds_read_b64_tr_b16 v[206:207], v233 offset:19456
  buffer_load_dwordx4 v[120:123], v254, s[20:23], s44 offen offset:2048 sc1
  v_mfma_f32_32x32x16_bf16 v[48:63], v[220:223], v[188:191], v[48:63]
  buffer_load_dwordx4 v[124:127], v254, s[20:23], s44 offen offset:3072 sc1
  v_mfma_f32_32x32x16_bf16 v[32:47], v[216:219], v[188:191], v[32:47]
  s_add_u32 s43, s8, 1
  s_and_b32 s43, s43, 1
  s_add_u32 s43, s43, 12
  s_mul_i32 s43, s43, 163840
  s_add_u32 m0, s48, 0
  s_nop 0
  buffer_load_dwordx4 v252, s[24:27], s43 offen lds
  s_waitcnt lgkmcnt(0)
  v_mfma_f32_32x32x16_bf16 v[48:63], v[196:199], v[64:67], v[48:63]
  ds_read_b64_tr_b16 v[208:209], v232 offset:20480
  ds_read_b64_tr_b16 v[210:211], v232 offset:21504
  ds_read_b64_tr_b16 v[212:213], v233 offset:20480
  ds_read_b64_tr_b16 v[214:215], v233 offset:21504
  v_mfma_f32_32x32x16_bf16 v[32:47], v[192:195], v[64:67], v[32:47]
  ds_read_b64_tr_b16 v[216:217], v232 offset:22528
  ds_read_b64_tr_b16 v[218:219], v232 offset:23552
  ds_read_b64_tr_b16 v[220:221], v233 offset:22528
  ds_read_b64_tr_b16 v[222:223], v233 offset:23552
  v_mfma_f32_32x32x16_bf16 v[48:63], v[204:207], v[68:71], v[48:63]
  s_add_u32 s44, s8, 0
  s_and_b32 s44, s44, 1
  s_add_u32 s44, s44, 6
  s_mul_i32 s44, s44, 393216
  buffer_load_dwordx4 v[128:131], v253, s[20:23], s44 offen sc1
  v_mfma_f32_32x32x16_bf16 v[32:47], v[200:203], v[68:71], v[32:47]
  buffer_load_dwordx4 v[132:135], v253, s[20:23], s44 offen offset:1024 sc1
  s_add_u32 m0, s48, 4096
  s_add_u32 s43, s43, 40960
  buffer_load_dwordx4 v252, s[24:27], s43 offen lds
  s_waitcnt lgkmcnt(0)
  v_mfma_f32_32x32x16_bf16 v[48:63], v[212:215], v[72:75], v[48:63]
  ds_read_b64_tr_b16 v[192:193], v232 offset:24576
  ds_read_b64_tr_b16 v[194:195], v232 offset:25600
  ds_read_b64_tr_b16 v[196:197], v233 offset:24576
  ds_read_b64_tr_b16 v[198:199], v233 offset:25600
  v_mfma_f32_32x32x16_bf16 v[32:47], v[208:211], v[72:75], v[32:47]
  ds_read_b64_tr_b16 v[200:201], v232 offset:26624
  ds_read_b64_tr_b16 v[202:203], v232 offset:27648
  ds_read_b64_tr_b16 v[204:205], v233 offset:26624
  ds_read_b64_tr_b16 v[206:207], v233 offset:27648
  v_mfma_f32_32x32x16_bf16 v[48:63], v[220:223], v[76:79], v[48:63]
  buffer_load_dwordx4 v[136:139], v253, s[20:23], s44 offen offset:2048 sc1
  buffer_load_dwordx4 v[140:143], v253, s[20:23], s44 offen offset:3072 sc1
  v_mfma_f32_32x32x16_bf16 v[32:47], v[216:219], v[76:79], v[32:47]
  s_add_u32 m0, s48, 8192
  s_add_u32 s43, s43, 40960
  buffer_load_dwordx4 v252, s[24:27], s43 offen lds
  s_waitcnt lgkmcnt(0)
  v_mfma_f32_32x32x16_bf16 v[48:63], v[196:199], v[80:83], v[48:63]
  ds_read_b64_tr_b16 v[208:209], v232 offset:28672
  ds_read_b64_tr_b16 v[210:211], v232 offset:29696
  ds_read_b64_tr_b16 v[212:213], v233 offset:28672
  ds_read_b64_tr_b16 v[214:215], v233 offset:29696
  v_mfma_f32_32x32x16_bf16 v[32:47], v[192:195], v[80:83], v[32:47]
  ds_read_b64_tr_b16 v[216:217], v232 offset:30720
  ds_read_b64_tr_b16 v[218:219], v232 offset:31744
  ds_read_b64_tr_b16 v[220:221], v233 offset:30720
  ds_read_b64_tr_b16 v[222:223], v233 offset:31744
  v_mfma_f32_32x32x16_bf16 v[48:63], v[204:207], v[84:87], v[48:63]
  buffer_load_dwordx4 v[144:147], v254, s[20:23], s44 offen sc1
  buffer_load_dwordx4 v[148:151], v254, s[20:23], s44 offen offset:1024 sc1
  v_mfma_f32_32x32x16_bf16 v[32:47], v[200:203], v[84:87], v[32:47]
  s_add_u32 m0, s48, 12288
  s_add_u32 s43, s43, 40960
  buffer_load_dwordx4 v252, s[24:27], s43 offen lds
  s_waitcnt lgkmcnt(0)
  v_mfma_f32_32x32x16_bf16 v[48:63], v[212:215], v[88:91], v[48:63]
  s_waitcnt vmcnt(10)
  s_barrier
  ds_read_b64_tr_b16 v[192:193], v232 offset:32768
  ds_read_b64_tr_b16 v[194:195], v232 offset:33792
  ds_read_b64_tr_b16 v[196:197], v233 offset:32768
  ds_read_b64_tr_b16 v[198:199], v233 offset:33792
  v_mfma_f32_32x32x16_bf16 v[32:47], v[208:211], v[88:91], v[32:47]
  ds_read_b64_tr_b16 v[200:201], v232 offset:34816
  ds_read_b64_tr_b16 v[202:203], v232 offset:35840
  ds_read_b64_tr_b16 v[204:205], v233 offset:34816
  ds_read_b64_tr_b16 v[206:207], v233 offset:35840
  buffer_load_dwordx4 v[152:155], v254, s[20:23], s44 offen offset:2048 sc1
  v_mfma_f32_32x32x16_bf16 v[48:63], v[220:223], v[92:95], v[48:63]
  buffer_load_dwordx4 v[156:159], v254, s[20:23], s44 offen offset:3072 sc1
  v_mfma_f32_32x32x16_bf16 v[32:47], v[216:219], v[92:95], v[32:47]
  s_add_u32 s43, s8, 0
  s_and_b32 s43, s43, 1
  s_add_u32 s43, s43, 14
  s_mul_i32 s43, s43, 163840
  s_add_u32 m0, s48, 16384
  s_nop 0
  buffer_load_dwordx4 v252, s[24:27], s43 offen lds
  s_waitcnt lgkmcnt(0)
  v_mfma_f32_32x32x16_bf16 v[48:63], v[196:199], v[96:99], v[48:63]
  ds_read_b64_tr_b16 v[208:209], v232 offset:36864
  ds_read_b64_tr_b16 v[210:211], v232 offset:37888
  ds_read_b64_tr_b16 v[212:213], v233 offset:36864
  ds_read_b64_tr_b16 v[214:215], v233 offset:37888
  v_mfma_f32_32x32x16_bf16 v[32:47], v[192:195], v[96:99], v[32:47]
  ds_read_b64_tr_b16 v[216:217], v232 offset:38912
  ds_read_b64_tr_b16 v[218:219], v232 offset:39936
  ds_read_b64_tr_b16 v[220:221], v233 offset:38912
  ds_read_b64_tr_b16 v[222:223], v233 offset:39936
  v_mfma_f32_32x32x16_bf16 v[48:63], v[204:207], v[100:103], v[48:63]
  s_add_u32 s44, s8, 1
  s_and_b32 s44, s44, 1
  s_add_u32 s44, s44, 6
  s_mul_i32 s44, s44, 393216
  buffer_load_dwordx4 v[160:163], v253, s[20:23], s44 offen sc1
  v_mfma_f32_32x32x16_bf16 v[32:47], v[200:203], v[100:103], v[32:47]
  buffer_load_dwordx4 v[164:167], v253, s[20:23], s44 offen offset:1024 sc1
  s_add_u32 m0, s48, 20480
  s_add_u32 s43, s43, 40960
  buffer_load_dwordx4 v252, s[24:27], s43 offen lds
  s_waitcnt lgkmcnt(0)
  v_mfma_f32_32x32x16_bf16 v[48:63], v[212:215], v[104:107], v[48:63]
  ds_read_b64_tr_b16 v[192:193], v232 offset:40960
  ds_read_b64_tr_b16 v[194:195], v232 offset:41984
  ds_read_b64_tr_b16 v[196:197], v233 offset:40960
  ds_read_b64_tr_b16 v[198:199], v233 offset:41984
  v_mfma_f32_32x32x16_bf16 v[32:47], v[208:211], v[104:107], v[32:47]
  ds_read_b64_tr_b16 v[200:201], v232 offset:43008
  ds_read_b64_tr_b16 v[202:203], v232 offset:44032
  ds_read_b64_tr_b16 v[204:205], v233 offset:43008
  ds_read_b64_tr_b16 v[206:207], v233 offset:44032
  v_mfma_f32_32x32x16_bf16 v[48:63], v[220:223], v[108:111], v[48:63]
  buffer_load_dwordx4 v[168:171], v253, s[20:23], s44 offen offset:2048 sc1
  buffer_load_dwordx4 v[172:175], v253, s[20:23], s44 offen offset:3072 sc1
  v_mfma_f32_32x32x16_bf16 v[32:47], v[216:219], v[108:111], v[32:47]
  s_add_u32 m0, s48, 24576
  s_add_u32 s43, s43, 40960
  buffer_load_dwordx4 v252, s[24:27], s43 offen lds
  s_waitcnt lgkmcnt(0)
  v_mfma_f32_32x32x16_bf16 v[48:63], v[196:199], v[112:115], v[48:63]
  ds_read_b64_tr_b16 v[208:209], v232 offset:45056
  ds_read_b64_tr_b16 v[210:211], v232 offset:46080
  ds_read_b64_tr_b16 v[212:213], v233 offset:45056
  ds_read_b64_tr_b16 v[214:215], v233 offset:46080
  v_mfma_f32_32x32x16_bf16 v[32:47], v[192:195], v[112:115], v[32:47]
  ds_read_b64_tr_b16 v[216:217], v232 offset:47104
  ds_read_b64_tr_b16 v[218:219], v232 offset:48128
  ds_read_b64_tr_b16 v[220:221], v233 offset:47104
  ds_read_b64_tr_b16 v[222:223], v233 offset:48128
  v_mfma_f32_32x32x16_bf16 v[48:63], v[204:207], v[116:119], v[48:63]
  buffer_load_dwordx4 v[176:179], v254, s[20:23], s44 offen sc1
  buffer_load_dwordx4 v[180:183], v254, s[20:23], s44 offen offset:1024 sc1
  v_mfma_f32_32x32x16_bf16 v[32:47], v[200:203], v[116:119], v[32:47]
  s_add_u32 m0, s48, 28672
  s_add_u32 s43, s43, 40960
  buffer_load_dwordx4 v252, s[24:27], s43 offen lds
  s_waitcnt lgkmcnt(0)
  v_mfma_f32_32x32x16_bf16 v[48:63], v[212:215], v[120:123], v[48:63]
  s_waitcnt vmcnt(10)
  s_barrier
  ds_read_b64_tr_b16 v[192:193], v232 offset:49152
  ds_read_b64_tr_b16 v[194:195], v232 offset:50176
  ds_read_b64_tr_b16 v[196:197], v233 offset:49152
  ds_read_b64_tr_b16 v[198:199], v233 offset:50176
  v_mfma_f32_32x32x16_bf16 v[32:47], v[208:211], v[120:123], v[32:47]
  ds_read_b64_tr_b16 v[200:201], v232 offset:51200
  ds_read_b64_tr_b16 v[202:203], v232 offset:52224
  ds_read_b64_tr_b16 v[204:205], v233 offset:51200
  ds_read_b64_tr_b16 v[206:207], v233 offset:52224
  buffer_load_dwordx4 v[184:187], v254, s[20:23], s44 offen offset:2048 sc1
  v_mfma_f32_32x32x16_bf16 v[48:63], v[220:223], v[124:127], v[48:63]
  buffer_load_dwordx4 v[188:191], v254, s[20:23], s44 offen offset:3072 sc1
  v_mfma_f32_32x32x16_bf16 v[32:47], v[216:219], v[124:127], v[32:47]
  s_add_u32 s43, s8, 1
  s_and_b32 s43, s43, 1
  s_add_u32 s43, s43, 14
  s_mul_i32 s43, s43, 163840
  s_add_u32 m0, s48, 32768
  s_nop 0
  buffer_load_dwordx4 v252, s[24:27], s43 offen lds
  s_waitcnt lgkmcnt(0)
  v_mfma_f32_32x32x16_bf16 v[48:63], v[196:199], v[128:131], v[48:63]
  ds_read_b64_tr_b16 v[208:209], v232 offset:53248
  ds_read_b64_tr_b16 v[210:211], v232 offset:54272
  ds_read_b64_tr_b16 v[212:213], v233 offset:53248
  ds_read_b64_tr_b16 v[214:215], v233 offset:54272
  v_mfma_f32_32x32x16_bf16 v[32:47], v[192:195], v[128:131], v[32:47]
  ds_read_b64_tr_b16 v[216:217], v232 offset:55296
  ds_read_b64_tr_b16 v[218:219], v232 offset:56320
  ds_read_b64_tr_b16 v[220:221], v233 offset:55296
  ds_read_b64_tr_b16 v[222:223], v233 offset:56320
  v_mfma_f32_32x32x16_bf16 v[48:63], v[204:207], v[132:135], v[48:63]
  s_add_u32 s44, s8, 0
  s_and_b32 s44, s44, 1
  s_add_u32 s44, s44, 8
  s_mul_i32 s44, s44, 393216
  buffer_load_dwordx4 v[64:67], v253, s[20:23], s44 offen sc1
  v_mfma_f32_32x32x16_bf16 v[32:47], v[200:203], v[132:135], v[32:47]
  buffer_load_dwordx4 v[68:71], v253, s[20:23], s44 offen offset:1024 sc1
  s_add_u32 m0, s48, 36864
  s_add_u32 s43, s43, 40960
  buffer_load_dwordx4 v252, s[24:27], s43 offen lds
  s_waitcnt lgkmcnt(0)
  v_mfma_f32_32x32x16_bf16 v[48:63], v[212:215], v[136:139], v[48:63]
  ds_read_b64_tr_b16 v[192:193], v232 offset:57344
  ds_read_b64_tr_b16 v[194:195], v232 offset:58368
  ds_read_b64_tr_b16 v[196:197], v233 offset:57344
  ds_read_b64_tr_b16 v[198:199], v233 offset:58368
  v_mfma_f32_32x32x16_bf16 v[32:47], v[208:211], v[136:139], v[32:47]
  ds_read_b64_tr_b16 v[200:201], v232 offset:59392
  ds_read_b64_tr_b16 v[202:203], v232 offset:60416
  ds_read_b64_tr_b16 v[204:205], v233 offset:59392
  ds_read_b64_tr_b16 v[206:207], v233 offset:60416
  v_mfma_f32_32x32x16_bf16 v[48:63], v[220:223], v[140:143], v[48:63]
  buffer_load_dwordx4 v[72:75], v253, s[20:23], s44 offen offset:2048 sc1
  buffer_load_dwordx4 v[76:79], v253, s[20:23], s44 offen offset:3072 sc1
  v_mfma_f32_32x32x16_bf16 v[32:47], v[216:219], v[140:143], v[32:47]
  s_add_u32 m0, s48, 40960
  s_add_u32 s43, s43, 40960
  buffer_load_dwordx4 v252, s[24:27], s43 offen lds
  s_waitcnt lgkmcnt(0)
  v_mfma_f32_32x32x16_bf16 v[48:63], v[196:199], v[144:147], v[48:63]
  ds_read_b64_tr_b16 v[208:209], v232 offset:61440
  ds_read_b64_tr_b16 v[210:211], v232 offset:62464
  ds_read_b64_tr_b16 v[212:213], v233 offset:61440
  ds_read_b64_tr_b16 v[214:215], v233 offset:62464
  v_mfma_f32_32x32x16_bf16 v[32:47], v[192:195], v[144:147], v[32:47]
  ds_read_b64_tr_b16 v[216:217], v232 offset:63488
  ds_read_b64_tr_b16 v[218:219], v232 offset:64512
  ds_read_b64_tr_b16 v[220:221], v233 offset:63488
  ds_read_b64_tr_b16 v[222:223], v233 offset:64512
  v_mfma_f32_32x32x16_bf16 v[48:63], v[204:207], v[148:151], v[48:63]
  buffer_load_dwordx4 v[80:83], v254, s[20:23], s44 offen sc1
  buffer_load_dwordx4 v[84:87], v254, s[20:23], s44 offen offset:1024 sc1
  v_mfma_f32_32x32x16_bf16 v[32:47], v[200:203], v[148:151], v[32:47]
  s_add_u32 m0, s48, 45056
  s_add_u32 s43, s43, 40960
  buffer_load_dwordx4 v252, s[24:27], s43 offen lds
  s_waitcnt lgkmcnt(0)
  v_mfma_f32_32x32x16_bf16 v[48:63], v[212:215], v[152:155], v[48:63]
  s_waitcnt vmcnt(10)
  s_barrier
  ds_read_b64_tr_b16 v[192:193], v234
  ds_read_b64_tr_b16 v[194:195], v234 offset:1024
  ds_read_b64_tr_b16 v[196:197], v235
  ds_read_b64_tr_b16 v[198:199], v235 offset:1024
  v_mfma_f32_32x32x16_bf16 v[32:47], v[208:211], v[152:155], v[32:47]
  ds_read_b64_tr_b16 v[200:201], v234 offset:2048
  ds_read_b64_tr_b16 v[202:203], v234 offset:3072
  ds_read_b64_tr_b16 v[204:205], v235 offset:2048
  ds_read_b64_tr_b16 v[206:207], v235 offset:3072
  v_mfma_f32_32x32x16_bf16 v[48:63], v[220:223], v[156:159], v[48:63]
  buffer_load_dwordx4 v[88:91], v254, s[20:23], s44 offen offset:2048 sc1
  v_mfma_f32_32x32x16_bf16 v[32:47], v[216:219], v[156:159], v[32:47]
  buffer_load_dwordx4 v[92:95], v254, s[20:23], s44 offen offset:3072 sc1
  s_waitcnt lgkmcnt(0)
  v_mfma_f32_32x32x16_bf16 v[48:63], v[196:199], v[160:163], v[48:63]
  ds_read_b64_tr_b16 v[208:209], v234 offset:4096
  ds_read_b64_tr_b16 v[210:211], v234 offset:5120
  ds_read_b64_tr_b16 v[212:213], v235 offset:4096
  ds_read_b64_tr_b16 v[214:215], v235 offset:5120
  v_mfma_f32_32x32x16_bf16 v[32:47], v[192:195], v[160:163], v[32:47]
  ds_read_b64_tr_b16 v[216:217], v234 offset:6144
  ds_read_b64_tr_b16 v[218:219], v234 offset:7168
  ds_read_b64_tr_b16 v[220:221], v235 offset:6144
  ds_read_b64_tr_b16 v[222:223], v235 offset:7168
  v_mfma_f32_32x32x16_bf16 v[48:63], v[204:207], v[164:167], v[48:63]
  s_add_u32 s44, s8, 1
  s_and_b32 s44, s44, 1
  s_add_u32 s44, s44, 8
  s_mul_i32 s44, s44, 393216
  buffer_load_dwordx4 v[96:99], v253, s[20:23], s44 offen sc1
  v_mfma_f32_32x32x16_bf16 v[32:47], v[200:203], v[164:167], v[32:47]
  buffer_load_dwordx4 v[100:103], v253, s[20:23], s44 offen offset:1024 sc1
  s_waitcnt lgkmcnt(0)
  v_mfma_f32_32x32x16_bf16 v[48:63], v[212:215], v[168:171], v[48:63]
  ds_read_b64_tr_b16 v[192:193], v234 offset:8192
  ds_read_b64_tr_b16 v[194:195], v234 offset:9216
  ds_read_b64_tr_b16 v[196:197], v235 offset:8192
  ds_read_b64_tr_b16 v[198:199], v235 offset:9216
  v_mfma_f32_32x32x16_bf16 v[32:47], v[208:211], v[168:171], v[32:47]
  ds_read_b64_tr_b16 v[200:201], v234 offset:10240
  ds_read_b64_tr_b16 v[202:203], v234 offset:11264
  ds_read_b64_tr_b16 v[204:205], v235 offset:10240
  ds_read_b64_tr_b16 v[206:207], v235 offset:11264
  v_mfma_f32_32x32x16_bf16 v[48:63], v[220:223], v[172:175], v[48:63]
  buffer_load_dwordx4 v[104:107], v253, s[20:23], s44 offen offset:2048 sc1
  v_mfma_f32_32x32x16_bf16 v[32:47], v[216:219], v[172:175], v[32:47]
  buffer_load_dwordx4 v[108:111], v253, s[20:23], s44 offen offset:3072 sc1
  s_waitcnt lgkmcnt(0)
  v_mfma_f32_32x32x16_bf16 v[48:63], v[196:199], v[176:179], v[48:63]
  ds_read_b64_tr_b16 v[208:209], v234 offset:12288
  ds_read_b64_tr_b16 v[210:211], v234 offset:13312
  ds_read_b64_tr_b16 v[212:213], v235 offset:12288
  ds_read_b64_tr_b16 v[214:215], v235 offset:13312
  v_mfma_f32_32x32x16_bf16 v[32:47], v[192:195], v[176:179], v[32:47]
  ds_read_b64_tr_b16 v[216:217], v234 offset:14336
  ds_read_b64_tr_b16 v[218:219], v234 offset:15360
  ds_read_b64_tr_b16 v[220:221], v235 offset:14336
  ds_read_b64_tr_b16 v[222:223], v235 offset:15360
  v_mfma_f32_32x32x16_bf16 v[48:63], v[204:207], v[180:183], v[48:63]
  buffer_load_dwordx4 v[112:115], v254, s[20:23], s44 offen sc1
  v_mfma_f32_32x32x16_bf16 v[32:47], v[200:203], v[180:183], v[32:47]
  buffer_load_dwordx4 v[116:119], v254, s[20:23], s44 offen offset:1024 sc1
  s_waitcnt lgkmcnt(0)
  v_mfma_f32_32x32x16_bf16 v[48:63], v[212:215], v[184:187], v[48:63]
  s_waitcnt vmcnt(6)
  s_barrier
  ds_read_b64_tr_b16 v[192:193], v234 offset:16384
  ds_read_b64_tr_b16 v[194:195], v234 offset:17408
  ds_read_b64_tr_b16 v[196:197], v235 offset:16384
  ds_read_b64_tr_b16 v[198:199], v235 offset:17408
  v_mfma_f32_32x32x16_bf16 v[32:47], v[208:211], v[184:187], v[32:47]
  ds_read_b64_tr_b16 v[200:201], v234 offset:18432
  ds_read_b64_tr_b16 v[202:203], v234 offset:19456
  ds_read_b64_tr_b16 v[204:205], v235 offset:18432
  ds_read_b64_tr_b16 v[206:207], v235 offset:19456
  v_mfma_f32_32x32x16_bf16 v[48:63], v[220:223], v[188:191], v[48:63]
  buffer_load_dwordx4 v[120:123], v254, s[20:23], s44 offen offset:2048 sc1
  v_mfma_f32_32x32x16_bf16 v[32:47], v[216:219], v[188:191], v[32:47]
  buffer_load_dwordx4 v[124:127], v254, s[20:23], s44 offen offset:3072 sc1
  s_waitcnt lgkmcnt(0)
  v_mfma_f32_32x32x16_bf16 v[48:63], v[196:199], v[64:67], v[48:63]
  ds_read_b64_tr_b16 v[208:209], v234 offset:20480
  ds_read_b64_tr_b16 v[210:211], v234 offset:21504
  ds_read_b64_tr_b16 v[212:213], v235 offset:20480
  ds_read_b64_tr_b16 v[214:215], v235 offset:21504
  v_mfma_f32_32x32x16_bf16 v[32:47], v[192:195], v[64:67], v[32:47]
  ds_read_b64_tr_b16 v[216:217], v234 offset:22528
  ds_read_b64_tr_b16 v[218:219], v234 offset:23552
  ds_read_b64_tr_b16 v[220:221], v235 offset:22528
  ds_read_b64_tr_b16 v[222:223], v235 offset:23552
  v_mfma_f32_32x32x16_bf16 v[48:63], v[204:207], v[68:71], v[48:63]
  s_add_u32 s44, s8, 0
  s_and_b32 s44, s44, 1
  s_add_u32 s44, s44, 10
  s_mul_i32 s44, s44, 393216
  buffer_load_dwordx4 v[128:131], v253, s[20:23], s44 offen sc1
  v_mfma_f32_32x32x16_bf16 v[32:47], v[200:203], v[68:71], v[32:47]
  buffer_load_dwordx4 v[132:135], v253, s[20:23], s44 offen offset:1024 sc1
  s_waitcnt lgkmcnt(0)
  v_mfma_f32_32x32x16_bf16 v[48:63], v[212:215], v[72:75], v[48:63]
  ds_read_b64_tr_b16 v[192:193], v234 offset:24576
  ds_read_b64_tr_b16 v[194:195], v234 offset:25600
  ds_read_b64_tr_b16 v[196:197], v235 offset:24576
  ds_read_b64_tr_b16 v[198:199], v235 offset:25600
  v_mfma_f32_32x32x16_bf16 v[32:47], v[208:211], v[72:75], v[32:47]
  ds_read_b64_tr_b16 v[200:201], v234 offset:26624
  ds_read_b64_tr_b16 v[202:203], v234 offset:27648
  ds_read_b64_tr_b16 v[204:205], v235 offset:26624
  ds_read_b64_tr_b16 v[206:207], v235 offset:27648
  v_mfma_f32_32x32x16_bf16 v[48:63], v[220:223], v[76:79], v[48:63]
  buffer_load_dwordx4 v[136:139], v253, s[20:23], s44 offen offset:2048 sc1
  v_mfma_f32_32x32x16_bf16 v[32:47], v[216:219], v[76:79], v[32:47]
  buffer_load_dwordx4 v[140:143], v253, s[20:23], s44 offen offset:3072 sc1
  s_waitcnt lgkmcnt(0)
  v_mfma_f32_32x32x16_bf16 v[48:63], v[196:199], v[80:83], v[48:63]
  ds_read_b64_tr_b16 v[208:209], v234 offset:28672
  ds_read_b64_tr_b16 v[210:211], v234 offset:29696
  ds_read_b64_tr_b16 v[212:213], v235 offset:28672
  ds_read_b64_tr_b16 v[214:215], v235 offset:29696
  v_mfma_f32_32x32x16_bf16 v[32:47], v[192:195], v[80:83], v[32:47]
  ds_read_b64_tr_b16 v[216:217], v234 offset:30720
  ds_read_b64_tr_b16 v[218:219], v234 offset:31744
  ds_read_b64_tr_b16 v[220:221], v235 offset:30720
  ds_read_b64_tr_b16 v[222:223], v235 offset:31744
  v_mfma_f32_32x32x16_bf16 v[48:63], v[204:207], v[84:87], v[48:63]
  buffer_load_dwordx4 v[144:147], v254, s[20:23], s44 offen sc1
  v_mfma_f32_32x32x16_bf16 v[32:47], v[200:203], v[84:87], v[32:47]
  buffer_load_dwordx4 v[148:151], v254, s[20:23], s44 offen offset:1024 sc1
  s_waitcnt lgkmcnt(0)
  v_mfma_f32_32x32x16_bf16 v[48:63], v[212:215], v[88:91], v[48:63]
  s_waitcnt vmcnt(6)
  s_barrier
  ds_read_b64_tr_b16 v[192:193], v236 offset:16384
  ds_read_b64_tr_b16 v[194:195], v236 offset:17408
  ds_read_b64_tr_b16 v[196:197], v237 offset:16384
  ds_read_b64_tr_b16 v[198:199], v237 offset:17408
  v_mfma_f32_32x32x16_bf16 v[32:47], v[208:211], v[88:91], v[32:47]
  ds_read_b64_tr_b16 v[200:201], v236 offset:18432
  ds_read_b64_tr_b16 v[202:203], v236 offset:19456
  ds_read_b64_tr_b16 v[204:205], v237 offset:18432
  ds_read_b64_tr_b16 v[206:207], v237 offset:19456
  v_mfma_f32_32x32x16_bf16 v[48:63], v[220:223], v[92:95], v[48:63]
  buffer_load_dwordx4 v[152:155], v254, s[20:23], s44 offen offset:2048 sc1
  v_mfma_f32_32x32x16_bf16 v[32:47], v[216:219], v[92:95], v[32:47]
  buffer_load_dwordx4 v[156:159], v254, s[20:23], s44 offen offset:3072 sc1
  s_waitcnt lgkmcnt(0)
  v_mfma_f32_32x32x16_bf16 v[48:63], v[196:199], v[96:99], v[48:63]
  ds_read_b64_tr_b16 v[208:209], v236 offset:20480
  ds_read_b64_tr_b16 v[210:211], v236 offset:21504
  ds_read_b64_tr_b16 v[212:213], v237 offset:20480
  ds_read_b64_tr_b16 v[214:215], v237 offset:21504
  v_mfma_f32_32x32x16_bf16 v[32:47], v[192:195], v[96:99], v[32:47]
  ds_read_b64_tr_b16 v[216:217], v236 offset:22528
  ds_read_b64_tr_b16 v[218:219], v236 offset:23552
  ds_read_b64_tr_b16 v[220:221], v237 offset:22528
  ds_read_b64_tr_b16 v[222:223], v237 offset:23552
  v_mfma_f32_32x32x16_bf16 v[48:63], v[204:207], v[100:103], v[48:63]
  s_add_u32 s44, s8, 1
  s_and_b32 s44, s44, 1
  s_add_u32 s44, s44, 10
  s_mul_i32 s44, s44, 393216
  buffer_load_dwordx4 v[160:163], v253, s[20:23], s44 offen sc1
  v_mfma_f32_32x32x16_bf16 v[32:47], v[200:203], v[100:103], v[32:47]
  buffer_load_dwordx4 v[164:167], v253, s[20:23], s44 offen offset:1024 sc1
  s_waitcnt lgkmcnt(0)
  v_mfma_f32_32x32x16_bf16 v[48:63], v[212:215], v[104:107], v[48:63]
  ds_read_b64_tr_b16 v[192:193], v236 offset:24576
  ds_read_b64_tr_b16 v[194:195], v236 offset:25600
  ds_read_b64_tr_b16 v[196:197], v237 offset:24576
  ds_read_b64_tr_b16 v[198:199], v237 offset:25600
  v_mfma_f32_32x32x16_bf16 v[32:47], v[208:211], v[104:107], v[32:47]
  ds_read_b64_tr_b16 v[200:201], v236 offset:26624
  ds_read_b64_tr_b16 v[202:203], v236 offset:27648
  ds_read_b64_tr_b16 v[204:205], v237 offset:26624
  ds_read_b64_tr_b16 v[206:207], v237 offset:27648
  v_mfma_f32_32x32x16_bf16 v[48:63], v[220:223], v[108:111], v[48:63]
  buffer_load_dwordx4 v[168:171], v253, s[20:23], s44 offen offset:2048 sc1
  v_mfma_f32_32x32x16_bf16 v[32:47], v[216:219], v[108:111], v[32:47]
  buffer_load_dwordx4 v[172:175], v253, s[20:23], s44 offen offset:3072 sc1
  s_waitcnt lgkmcnt(0)
  v_mfma_f32_32x32x16_bf16 v[48:63], v[196:199], v[112:115], v[48:63]
  ds_read_b64_tr_b16 v[208:209], v236 offset:28672
  ds_read_b64_tr_b16 v[210:211], v236 offset:29696
  ds_read_b64_tr_b16 v[212:213], v237 offset:28672
  ds_read_b64_tr_b16 v[214:215], v237 offset:29696
  v_mfma_f32_32x32x16_bf16 v[32:47], v[192:195], v[112:115], v[32:47]
  ds_read_b64_tr_b16 v[216:217], v236 offset:30720
  ds_read_b64_tr_b16 v[218:219], v236 offset:31744
  ds_read_b64_tr_b16 v[220:221], v237 offset:30720
  ds_read_b64_tr_b16 v[222:223], v237 offset:31744
  v_mfma_f32_32x32x16_bf16 v[48:63], v[204:207], v[116:119], v[48:63]
  buffer_load_dwordx4 v[176:179], v254, s[20:23], s44 offen sc1
  v_mfma_f32_32x32x16_bf16 v[32:47], v[200:203], v[116:119], v[32:47]
  buffer_load_dwordx4 v[180:183], v254, s[20:23], s44 offen offset:1024 sc1
  s_waitcnt lgkmcnt(0)
  v_mfma_f32_32x32x16_bf16 v[48:63], v[212:215], v[120:123], v[48:63]
  s_waitcnt vmcnt(6)
  s_barrier
  ds_read_b64_tr_b16 v[192:193], v234 offset:32768
  ds_read_b64_tr_b16 v[194:195], v234 offset:33792
  ds_read_b64_tr_b16 v[196:197], v235 offset:32768
  ds_read_b64_tr_b16 v[198:199], v235 offset:33792
  v_mfma_f32_32x32x16_bf16 v[32:47], v[208:211], v[120:123], v[32:47]
  ds_read_b64_tr_b16 v[200:201], v234 offset:34816
  ds_read_b64_tr_b16 v[202:203], v234 offset:35840
  ds_read_b64_tr_b16 v[204:205], v235 offset:34816
  ds_read_b64_tr_b16 v[206:207], v235 offset:35840
  v_mfma_f32_32x32x16_bf16 v[48:63], v[220:223], v[124:127], v[48:63]
  buffer_load_dwordx4 v[184:187], v254, s[20:23], s44 offen offset:2048 sc1
  v_mfma_f32_32x32x16_bf16 v[32:47], v[216:219], v[124:127], v[32:47]
  buffer_load_dwordx4 v[188:191], v254, s[20:23], s44 offen offset:3072 sc1
  s_waitcnt lgkmcnt(0)
  v_mfma_f32_32x32x16_bf16 v[48:63], v[196:199], v[128:131], v[48:63]
  ds_read_b64_tr_b16 v[208:209], v234 offset:36864
  ds_read_b64_tr_b16 v[210:211], v234 offset:37888
  ds_read_b64_tr_b16 v[212:213], v235 offset:36864
  ds_read_b64_tr_b16 v[214:215], v235 offset:37888
  v_mfma_f32_32x32x16_bf16 v[32:47], v[192:195], v[128:131], v[32:47]
  ds_read_b64_tr_b16 v[216:217], v234 offset:38912
  ds_read_b64_tr_b16 v[218:219], v234 offset:39936
  ds_read_b64_tr_b16 v[220:221], v235 offset:38912
  ds_read_b64_tr_b16 v[222:223], v235 offset:39936
  v_mfma_f32_32x32x16_bf16 v[48:63], v[204:207], v[132:135], v[48:63]
  s_add_u32 s44, s8, 0
  s_and_b32 s44, s44, 1
  s_add_u32 s44, s44, 12
  s_mul_i32 s44, s44, 393216
  buffer_load_dwordx4 v[64:67], v253, s[20:23], s44 offen sc1
  v_mfma_f32_32x32x16_bf16 v[32:47], v[200:203], v[132:135], v[32:47]
  buffer_load_dwordx4 v[68:71], v253, s[20:23], s44 offen offset:1024 sc1
  s_waitcnt lgkmcnt(0)
  v_mfma_f32_32x32x16_bf16 v[48:63], v[212:215], v[136:139], v[48:63]
  ds_read_b64_tr_b16 v[192:193], v234 offset:40960
  ds_read_b64_tr_b16 v[194:195], v234 offset:41984
  ds_read_b64_tr_b16 v[196:197], v235 offset:40960
  ds_read_b64_tr_b16 v[198:199], v235 offset:41984
  v_mfma_f32_32x32x16_bf16 v[32:47], v[208:211], v[136:139], v[32:47]
  ds_read_b64_tr_b16 v[200:201], v234 offset:43008
  ds_read_b64_tr_b16 v[202:203], v234 offset:44032
  ds_read_b64_tr_b16 v[204:205], v235 offset:43008
  ds_read_b64_tr_b16 v[206:207], v235 offset:44032
  v_mfma_f32_32x32x16_bf16 v[48:63], v[220:223], v[140:143], v[48:63]
  buffer_load_dwordx4 v[72:75], v253, s[20:23], s44 offen offset:2048 sc1
  v_mfma_f32_32x32x16_bf16 v[32:47], v[216:219], v[140:143], v[32:47]
  buffer_load_dwordx4 v[76:79], v253, s[20:23], s44 offen offset:3072 sc1
  s_waitcnt lgkmcnt(0)
  v_mfma_f32_32x32x16_bf16 v[48:63], v[196:199], v[144:147], v[48:63]
  ds_read_b64_tr_b16 v[208:209], v234 offset:45056
  ds_read_b64_tr_b16 v[210:211], v234 offset:46080
  ds_read_b64_tr_b16 v[212:213], v235 offset:45056
  ds_read_b64_tr_b16 v[214:215], v235 offset:46080
  v_mfma_f32_32x32x16_bf16 v[32:47], v[192:195], v[144:147], v[32:47]
  ds_read_b64_tr_b16 v[216:217], v234 offset:47104
  ds_read_b64_tr_b16 v[218:219], v234 offset:48128
  ds_read_b64_tr_b16 v[220:221], v235 offset:47104
  ds_read_b64_tr_b16 v[222:223], v235 offset:48128
  v_mfma_f32_32x32x16_bf16 v[48:63], v[204:207], v[148:151], v[48:63]
  buffer_load_dwordx4 v[80:83], v254, s[20:23], s44 offen sc1
  v_mfma_f32_32x32x16_bf16 v[32:47], v[200:203], v[148:151], v[32:47]
  buffer_load_dwordx4 v[84:87], v254, s[20:23], s44 offen offset:1024 sc1
  s_waitcnt lgkmcnt(0)
  v_mfma_f32_32x32x16_bf16 v[48:63], v[212:215], v[152:155], v[48:63]
  s_waitcnt vmcnt(6)
  s_barrier
  ds_read_b64_tr_b16 v[192:193], v234 offset:49152
  ds_read_b64_tr_b16 v[194:195], v234 offset:50176
  ds_read_b64_tr_b16 v[196:197], v235 offset:49152
  ds_read_b64_tr_b16 v[198:199], v235 offset:50176
  v_mfma_f32_32x32x16_bf16 v[32:47], v[208:211], v[152:155], v[32:47]
  ds_read_b64_tr_b16 v[200:201], v234 offset:51200
  ds_read_b64_tr_b16 v[202:203], v234 offset:52224
  ds_read_b64_tr_b16 v[204:205], v235 offset:51200
  ds_read_b64_tr_b16 v[206:207], v235 offset:52224
  v_mfma_f32_32x32x16_bf16 v[48:63], v[220:223], v[156:159], v[48:63]
  buffer_load_dwordx4 v[88:91], v254, s[20:23], s44 offen offset:2048 sc1
  v_mfma_f32_32x32x16_bf16 v[32:47], v[216:219], v[156:159], v[32:47]
  buffer_load_dwordx4 v[92:95], v254, s[20:23], s44 offen offset:3072 sc1
  s_waitcnt lgkmcnt(0)
  v_mfma_f32_32x32x16_bf16 v[48:63], v[196:199], v[160:163], v[48:63]
  ds_read_b64_tr_b16 v[208:209], v234 offset:53248
  ds_read_b64_tr_b16 v[210:211], v234 offset:54272
  ds_read_b64_tr_b16 v[212:213], v235 offset:53248
  ds_read_b64_tr_b16 v[214:215], v235 offset:54272
  v_mfma_f32_32x32x16_bf16 v[32:47], v[192:195], v[160:163], v[32:47]
  ds_read_b64_tr_b16 v[216:217], v234 offset:55296
  ds_read_b64_tr_b16 v[218:219], v234 offset:56320
  ds_read_b64_tr_b16 v[220:221], v235 offset:55296
  ds_read_b64_tr_b16 v[222:223], v235 offset:56320
  v_mfma_f32_32x32x16_bf16 v[48:63], v[204:207], v[164:167], v[48:63]
  s_add_u32 s44, s8, 1
  s_and_b32 s44, s44, 1
  s_add_u32 s44, s44, 12
  s_mul_i32 s44, s44, 393216
  buffer_load_dwordx4 v[96:99], v253, s[20:23], s44 offen sc1
  v_mfma_f32_32x32x16_bf16 v[32:47], v[200:203], v[164:167], v[32:47]
  buffer_load_dwordx4 v[100:103], v253, s[20:23], s44 offen offset:1024 sc1
  s_waitcnt lgkmcnt(0)
  v_mfma_f32_32x32x16_bf16 v[48:63], v[212:215], v[168:171], v[48:63]
  ds_read_b64_tr_b16 v[192:193], v234 offset:57344
  ds_read_b64_tr_b16 v[194:195], v234 offset:58368
  ds_read_b64_tr_b16 v[196:197], v235 offset:57344
  ds_read_b64_tr_b16 v[198:199], v235 offset:58368
  v_mfma_f32_32x32x16_bf16 v[32:47], v[208:211], v[168:171], v[32:47]
  ds_read_b64_tr_b16 v[200:201], v234 offset:59392
  ds_read_b64_tr_b16 v[202:203], v234 offset:60416
  ds_read_b64_tr_b16 v[204:205], v235 offset:59392
  ds_read_b64_tr_b16 v[206:207], v235 offset:60416
  v_mfma_f32_32x32x16_bf16 v[48:63], v[220:223], v[172:175], v[48:63]
  buffer_load_dwordx4 v[104:107], v253, s[20:23], s44 offen offset:2048 sc1
  v_mfma_f32_32x32x16_bf16 v[32:47], v[216:219], v[172:175], v[32:47]
  buffer_load_dwordx4 v[108:111], v253, s[20:23], s44 offen offset:3072 sc1
  s_waitcnt lgkmcnt(0)
  v_mfma_f32_32x32x16_bf16 v[48:63], v[196:199], v[176:179], v[48:63]
  ds_read_b64_tr_b16 v[208:209], v234 offset:61440
  ds_read_b64_tr_b16 v[210:211], v234 offset:62464
  ds_read_b64_tr_b16 v[212:213], v235 offset:61440
  ds_read_b64_tr_b16 v[214:215], v235 offset:62464
  v_mfma_f32_32x32x16_bf16 v[32:47], v[192:195], v[176:179], v[32:47]
  ds_read_b64_tr_b16 v[216:217], v234 offset:63488
  ds_read_b64_tr_b16 v[218:219], v234 offset:64512
  ds_read_b64_tr_b16 v[220:221], v235 offset:63488
  ds_read_b64_tr_b16 v[222:223], v235 offset:64512
  v_mfma_f32_32x32x16_bf16 v[48:63], v[204:207], v[180:183], v[48:63]
  buffer_load_dwordx4 v[112:115], v254, s[20:23], s44 offen sc1
  v_mfma_f32_32x32x16_bf16 v[32:47], v[200:203], v[180:183], v[32:47]
  buffer_load_dwordx4 v[116:119], v254, s[20:23], s44 offen offset:1024 sc1
  s_waitcnt lgkmcnt(0)
  v_mfma_f32_32x32x16_bf16 v[48:63], v[212:215], v[184:187], v[48:63]
  s_waitcnt vmcnt(6)
  s_barrier
  ds_read_b64_tr_b16 v[192:193], v236
  ds_read_b64_tr_b16 v[194:195], v236 offset:1024
  ds_read_b64_tr_b16 v[196:197], v237
  ds_read_b64_tr_b16 v[198:199], v237 offset:1024
  v_mfma_f32_32x32x16_bf16 v[32:47], v[208:211], v[184:187], v[32:47]
  ds_read_b64_tr_b16 v[200:201], v236 offset:2048
  ds_read_b64_tr_b16 v[202:203], v236 offset:3072
  ds_read_b64_tr_b16 v[204:205], v237 offset:2048
  ds_read_b64_tr_b16 v[206:207], v237 offset:3072
  v_mfma_f32_32x32x16_bf16 v[48:63], v[220:223], v[188:191], v[48:63]
  buffer_load_dwordx4 v[120:123], v254, s[20:23], s44 offen offset:2048 sc1
  v_mfma_f32_32x32x16_bf16 v[32:47], v[216:219], v[188:191], v[32:47]
  buffer_load_dwordx4 v[124:127], v254, s[20:23], s44 offen offset:3072 sc1
  s_waitcnt lgkmcnt(0)
  v_mfma_f32_32x32x16_bf16 v[48:63], v[196:199], v[64:67], v[48:63]
  ds_read_b64_tr_b16 v[208:209], v236 offset:4096
  ds_read_b64_tr_b16 v[210:211], v236 offset:5120
  ds_read_b64_tr_b16 v[212:213], v237 offset:4096
  ds_read_b64_tr_b16 v[214:215], v237 offset:5120
  v_mfma_f32_32x32x16_bf16 v[32:47], v[192:195], v[64:67], v[32:47]
  ds_read_b64_tr_b16 v[216:217], v236 offset:6144
  ds_read_b64_tr_b16 v[218:219], v236 offset:7168
  ds_read_b64_tr_b16 v[220:221], v237 offset:6144
  ds_read_b64_tr_b16 v[222:223], v237 offset:7168
  v_mfma_f32_32x32x16_bf16 v[48:63], v[204:207], v[68:71], v[48:63]
  s_add_u32 s44, s8, 0
  s_and_b32 s44, s44, 1
  s_add_u32 s44, s44, 14
  s_mul_i32 s44, s44, 393216
  buffer_load_dwordx4 v[128:131], v253, s[20:23], s44 offen sc1
  v_mfma_f32_32x32x16_bf16 v[32:47], v[200:203], v[68:71], v[32:47]
  buffer_load_dwordx4 v[132:135], v253, s[20:23], s44 offen offset:1024 sc1
  s_waitcnt lgkmcnt(0)
  v_mfma_f32_32x32x16_bf16 v[48:63], v[212:215], v[72:75], v[48:63]
  ds_read_b64_tr_b16 v[192:193], v236 offset:8192
  ds_read_b64_tr_b16 v[194:195], v236 offset:9216
  ds_read_b64_tr_b16 v[196:197], v237 offset:8192
  ds_read_b64_tr_b16 v[198:199], v237 offset:9216
  v_mfma_f32_32x32x16_bf16 v[32:47], v[208:211], v[72:75], v[32:47]
  ds_read_b64_tr_b16 v[200:201], v236 offset:10240
  ds_read_b64_tr_b16 v[202:203], v236 offset:11264
  ds_read_b64_tr_b16 v[204:205], v237 offset:10240
  ds_read_b64_tr_b16 v[206:207], v237 offset:11264
  v_mfma_f32_32x32x16_bf16 v[48:63], v[220:223], v[76:79], v[48:63]
  buffer_load_dwordx4 v[136:139], v253, s[20:23], s44 offen offset:2048 sc1
  v_mfma_f32_32x32x16_bf16 v[32:47], v[216:219], v[76:79], v[32:47]
  buffer_load_dwordx4 v[140:143], v253, s[20:23], s44 offen offset:3072 sc1
  s_waitcnt lgkmcnt(0)
  v_mfma_f32_32x32x16_bf16 v[48:63], v[196:199], v[80:83], v[48:63]
  ds_read_b64_tr_b16 v[208:209], v236 offset:12288
  ds_read_b64_tr_b16 v[210:211], v236 offset:13312
  ds_read_b64_tr_b16 v[212:213], v237 offset:12288
  ds_read_b64_tr_b16 v[214:215], v237 offset:13312
  v_mfma_f32_32x32x16_bf16 v[32:47], v[192:195], v[80:83], v[32:47]
  ds_read_b64_tr_b16 v[216:217], v236 offset:14336
  ds_read_b64_tr_b16 v[218:219], v236 offset:15360
  ds_read_b64_tr_b16 v[220:221], v237 offset:14336
  ds_read_b64_tr_b16 v[222:223], v237 offset:15360
  v_mfma_f32_32x32x16_bf16 v[48:63], v[204:207], v[84:87], v[48:63]
  buffer_load_dwordx4 v[144:147], v254, s[20:23], s44 offen sc1
  v_mfma_f32_32x32x16_bf16 v[32:47], v[200:203], v[84:87], v[32:47]
  buffer_load_dwordx4 v[148:151], v254, s[20:23], s44 offen offset:1024 sc1
  s_waitcnt lgkmcnt(0)
  v_mfma_f32_32x32x16_bf16 v[48:63], v[212:215], v[88:91], v[48:63]
  s_waitcnt vmcnt(6)
  s_barrier
  ds_read_b64_tr_b16 v[192:193], v232
  ds_read_b64_tr_b16 v[194:195], v232 offset:1024
  ds_read_b64_tr_b16 v[196:197], v233
  ds_read_b64_tr_b16 v[198:199], v233 offset:1024
  v_mfma_f32_32x32x16_bf16 v[32:47], v[208:211], v[88:91], v[32:47]
  ds_read_b64_tr_b16 v[200:201], v232 offset:2048
  ds_read_b64_tr_b16 v[202:203], v232 offset:3072
  ds_read_b64_tr_b16 v[204:205], v233 offset:2048
  ds_read_b64_tr_b16 v[206:207], v233 offset:3072
  v_mfma_f32_32x32x16_bf16 v[48:63], v[220:223], v[92:95], v[48:63]
  buffer_load_dwordx4 v[152:155], v254, s[20:23], s44 offen offset:2048 sc1
  v_mfma_f32_32x32x16_bf16 v[32:47], v[216:219], v[92:95], v[32:47]
  buffer_load_dwordx4 v[156:159], v254, s[20:23], s44 offen offset:3072 sc1
  s_waitcnt lgkmcnt(0)
  v_mfma_f32_32x32x16_bf16 v[48:63], v[196:199], v[96:99], v[48:63]
  ds_read_b64_tr_b16 v[208:209], v232 offset:4096
  ds_read_b64_tr_b16 v[210:211], v232 offset:5120
  ds_read_b64_tr_b16 v[212:213], v233 offset:4096
  ds_read_b64_tr_b16 v[214:215], v233 offset:5120
  v_mfma_f32_32x32x16_bf16 v[32:47], v[192:195], v[96:99], v[32:47]
  ds_read_b64_tr_b16 v[216:217], v232 offset:6144
  ds_read_b64_tr_b16 v[218:219], v232 offset:7168
  ds_read_b64_tr_b16 v[220:221], v233 offset:6144
  ds_read_b64_tr_b16 v[222:223], v233 offset:7168
  v_mfma_f32_32x32x16_bf16 v[48:63], v[204:207], v[100:103], v[48:63]
  s_add_u32 s44, s8, 1
  s_and_b32 s44, s44, 1
  s_add_u32 s44, s44, 14
  s_mul_i32 s44, s44, 393216
  buffer_load_dwordx4 v[160:163], v253, s[20:23], s44 offen sc1
  v_mfma_f32_32x32x16_bf16 v[32:47], v[200:203], v[100:103], v[32:47]
  buffer_load_dwordx4 v[164:167], v253, s[20:23], s44 offen offset:1024 sc1
  s_waitcnt lgkmcnt(0)
  v_mfma_f32_32x32x16_bf16 v[48:63], v[212:215], v[104:107], v[48:63]
  ds_read_b64_tr_b16 v[192:193], v232 offset:8192
  ds_read_b64_tr_b16 v[194:195], v232 offset:9216
  ds_read_b64_tr_b16 v[196:197], v233 offset:8192
  ds_read_b64_tr_b16 v[198:199], v233 offset:9216
  v_mfma_f32_32x32x16_bf16 v[32:47], v[208:211], v[104:107], v[32:47]
  ds_read_b64_tr_b16 v[200:201], v232 offset:10240
  ds_read_b64_tr_b16 v[202:203], v232 offset:11264
  ds_read_b64_tr_b16 v[204:205], v233 offset:10240
  ds_read_b64_tr_b16 v[206:207], v233 offset:11264
  v_mfma_f32_32x32x16_bf16 v[48:63], v[220:223], v[108:111], v[48:63]
  buffer_load_dwordx4 v[168:171], v253, s[20:23], s44 offen offset:2048 sc1
  v_mfma_f32_32x32x16_bf16 v[32:47], v[216:219], v[108:111], v[32:47]
  buffer_load_dwordx4 v[172:175], v253, s[20:23], s44 offen offset:3072 sc1
  s_waitcnt lgkmcnt(0)
  v_mfma_f32_32x32x16_bf16 v[48:63], v[196:199], v[112:115], v[48:63]
  ds_read_b64_tr_b16 v[208:209], v232 offset:12288
  ds_read_b64_tr_b16 v[210:211], v232 offset:13312
  ds_read_b64_tr_b16 v[212:213], v233 offset:12288
  ds_read_b64_tr_b16 v[214:215], v233 offset:13312
  v_mfma_f32_32x32x16_bf16 v[32:47], v[192:195], v[112:115], v[32:47]
  ds_read_b64_tr_b16 v[216:217], v232 offset:14336
  ds_read_b64_tr_b16 v[218:219], v232 offset:15360
  ds_read_b64_tr_b16 v[220:221], v233 offset:14336
  ds_read_b64_tr_b16 v[222:223], v233 offset:15360
  v_mfma_f32_32x32x16_bf16 v[48:63], v[204:207], v[116:119], v[48:63]
  buffer_load_dwordx4 v[176:179], v254, s[20:23], s44 offen sc1
  v_mfma_f32_32x32x16_bf16 v[32:47], v[200:203], v[116:119], v[32:47]
  buffer_load_dwordx4 v[180:183], v254, s[20:23], s44 offen offset:1024 sc1
  s_waitcnt lgkmcnt(0)
  v_mfma_f32_32x32x16_bf16 v[48:63], v[212:215], v[120:123], v[48:63]
  s_waitcnt vmcnt(6)
  s_barrier
  ds_read_b64_tr_b16 v[192:193], v232 offset:16384
  ds_read_b64_tr_b16 v[194:195], v232 offset:17408
  ds_read_b64_tr_b16 v[196:197], v233 offset:16384
  ds_read_b64_tr_b16 v[198:199], v233 offset:17408
  v_mfma_f32_32x32x16_bf16 v[32:47], v[208:211], v[120:123], v[32:47]
  ds_read_b64_tr_b16 v[200:201], v232 offset:18432
  ds_read_b64_tr_b16 v[202:203], v232 offset:19456
  ds_read_b64_tr_b16 v[204:205], v233 offset:18432
  ds_read_b64_tr_b16 v[206:207], v233 offset:19456
  v_mfma_f32_32x32x16_bf16 v[48:63], v[220:223], v[124:127], v[48:63]
  buffer_load_dwordx4 v[184:187], v254, s[20:23], s44 offen offset:2048 sc1
  v_mfma_f32_32x32x16_bf16 v[32:47], v[216:219], v[124:127], v[32:47]
  buffer_load_dwordx4 v[188:191], v254, s[20:23], s44 offen offset:3072 sc1
  s_waitcnt lgkmcnt(0)
  v_mfma_f32_32x32x16_bf16 v[48:63], v[196:199], v[128:131], v[48:63]
  ds_read_b64_tr_b16 v[208:209], v232 offset:20480
  ds_read_b64_tr_b16 v[210:211], v232 offset:21504
  ds_read_b64_tr_b16 v[212:213], v233 offset:20480
  ds_read_b64_tr_b16 v[214:215], v233 offset:21504
  v_mfma_f32_32x32x16_bf16 v[32:47], v[192:195], v[128:131], v[32:47]
  v_mfma_f32_32x32x16_bf16 v[48:63], v[204:207], v[132:135], v[48:63]
  ds_read_b64_tr_b16 v[216:217], v232 offset:22528
  ds_read_b64_tr_b16 v[218:219], v232 offset:23552
  ds_read_b64_tr_b16 v[220:221], v233 offset:22528
  ds_read_b64_tr_b16 v[222:223], v233 offset:23552
  v_mfma_f32_32x32x16_bf16 v[32:47], v[200:203], v[132:135], v[32:47]
  s_waitcnt lgkmcnt(0)
  v_mfma_f32_32x32x16_bf16 v[48:63], v[212:215], v[136:139], v[48:63]
  ds_read_b64_tr_b16 v[192:193], v232 offset:24576
  ds_read_b64_tr_b16 v[194:195], v232 offset:25600
  ds_read_b64_tr_b16 v[196:197], v233 offset:24576
  ds_read_b64_tr_b16 v[198:199], v233 offset:25600
  v_mfma_f32_32x32x16_bf16 v[32:47], v[208:211], v[136:139], v[32:47]
  v_mfma_f32_32x32x16_bf16 v[48:63], v[220:223], v[140:143], v[48:63]
  ds_read_b64_tr_b16 v[200:201], v232 offset:26624
  ds_read_b64_tr_b16 v[202:203], v232 offset:27648
  ds_read_b64_tr_b16 v[204:205], v233 offset:26624
  ds_read_b64_tr_b16 v[206:207], v233 offset:27648
  v_mfma_f32_32x32x16_bf16 v[32:47], v[216:219], v[140:143], v[32:47]
  s_waitcnt lgkmcnt(0)
  v_mfma_f32_32x32x16_bf16 v[48:63], v[196:199], v[144:147], v[48:63]
  ds_read_b64_tr_b16 v[208:209], v232 offset:28672
  ds_read_b64_tr_b16 v[210:211], v232 offset:29696
  ds_read_b64_tr_b16 v[212:213], v233 offset:28672
  ds_read_b64_tr_b16 v[214:215], v233 offset:29696
  v_mfma_f32_32x32x16_bf16 v[32:47], v[192:195], v[144:147], v[32:47]
  v_mfma_f32_32x32x16_bf16 v[48:63], v[204:207], v[148:151], v[48:63]
  ds_read_b64_tr_b16 v[216:217], v232 offset:30720
  ds_read_b64_tr_b16 v[218:219], v232 offset:31744
  ds_read_b64_tr_b16 v[220:221], v233 offset:30720
  ds_read_b64_tr_b16 v[222:223], v233 offset:31744
  v_mfma_f32_32x32x16_bf16 v[32:47], v[200:203], v[148:151], v[32:47]
  s_waitcnt lgkmcnt(0)
  v_mfma_f32_32x32x16_bf16 v[48:63], v[212:215], v[152:155], v[48:63]
  s_waitcnt vmcnt(0)
  s_barrier
  ds_read_b64_tr_b16 v[192:193], v232 offset:32768
  ds_read_b64_tr_b16 v[194:195], v232 offset:33792
  ds_read_b64_tr_b16 v[196:197], v233 offset:32768
  ds_read_b64_tr_b16 v[198:199], v233 offset:33792
  v_mfma_f32_32x32x16_bf16 v[32:47], v[208:211], v[152:155], v[32:47]
  v_mfma_f32_32x32x16_bf16 v[48:63], v[220:223], v[156:159], v[48:63]
  ds_read_b64_tr_b16 v[200:201], v232 offset:34816
  ds_read_b64_tr_b16 v[202:203], v232 offset:35840
  ds_read_b64_tr_b16 v[204:205], v233 offset:34816
  ds_read_b64_tr_b16 v[206:207], v233 offset:35840
  v_mfma_f32_32x32x16_bf16 v[32:47], v[216:219], v[156:159], v[32:47]
  s_waitcnt lgkmcnt(0)
  v_mfma_f32_32x32x16_bf16 v[48:63], v[196:199], v[160:163], v[48:63]
  ds_read_b64_tr_b16 v[208:209], v232 offset:36864
  ds_read_b64_tr_b16 v[210:211], v232 offset:37888
  ds_read_b64_tr_b16 v[212:213], v233 offset:36864
  ds_read_b64_tr_b16 v[214:215], v233 offset:37888
  v_mfma_f32_32x32x16_bf16 v[32:47], v[192:195], v[160:163], v[32:47]
  v_mfma_f32_32x32x16_bf16 v[48:63], v[204:207], v[164:167], v[48:63]
  ds_read_b64_tr_b16 v[216:217], v232 offset:38912
  ds_read_b64_tr_b16 v[218:219], v232 offset:39936
  ds_read_b64_tr_b16 v[220:221], v233 offset:38912
  ds_read_b64_tr_b16 v[222:223], v233 offset:39936
  v_mfma_f32_32x32x16_bf16 v[32:47], v[200:203], v[164:167], v[32:47]
  s_waitcnt lgkmcnt(0)
  v_mfma_f32_32x32x16_bf16 v[48:63], v[212:215], v[168:171], v[48:63]
  ds_read_b64_tr_b16 v[192:193], v232 offset:40960
  ds_read_b64_tr_b16 v[194:195], v232 offset:41984
  ds_read_b64_tr_b16 v[196:197], v233 offset:40960
  ds_read_b64_tr_b16 v[198:199], v233 offset:41984
  v_mfma_f32_32x32x16_bf16 v[32:47], v[208:211], v[168:171], v[32:47]
  v_mfma_f32_32x32x16_bf16 v[48:63], v[220:223], v[172:175], v[48:63]
  ds_read_b64_tr_b16 v[200:201], v232 offset:43008
  ds_read_b64_tr_b16 v[202:203], v232 offset:44032
  ds_read_b64_tr_b16 v[204:205], v233 offset:43008
  ds_read_b64_tr_b16 v[206:207], v233 offset:44032
  v_mfma_f32_32x32x16_bf16 v[32:47], v[216:219], v[172:175], v[32:47]
  s_waitcnt lgkmcnt(0)
  v_mfma_f32_32x32x16_bf16 v[48:63], v[196:199], v[176:179], v[48:63]
  ds_read_b64_tr_b16 v[208:209], v232 offset:45056
  ds_read_b64_tr_b16 v[210:211], v232 offset:46080
  ds_read_b64_tr_b16 v[212:213], v233 offset:45056
  ds_read_b64_tr_b16 v[214:215], v233 offset:46080
  v_mfma_f32_32x32x16_bf16 v[32:47], v[192:195], v[176:179], v[32:47]
  v_mfma_f32_32x32x16_bf16 v[48:63], v[204:207], v[180:183], v[48:63]
  ds_read_b64_tr_b16 v[216:217], v232 offset:47104
  ds_read_b64_tr_b16 v[218:219], v232 offset:48128
  ds_read_b64_tr_b16 v[220:221], v233 offset:47104
  ds_read_b64_tr_b16 v[222:223], v233 offset:48128
  v_mfma_f32_32x32x16_bf16 v[32:47], v[200:203], v[180:183], v[32:47]
  s_waitcnt lgkmcnt(0)
  v_mfma_f32_32x32x16_bf16 v[48:63], v[212:215], v[184:187], v[48:63]
  v_mfma_f32_32x32x16_bf16 v[32:47], v[208:211], v[184:187], v[32:47]
  v_mfma_f32_32x32x16_bf16 v[48:63], v[220:223], v[188:191], v[48:63]
  v_mfma_f32_32x32x16_bf16 v[32:47], v[216:219], v[188:191], v[32:47]
  v_lshlrev_b32 v5, 4, v1
  v_lshl_add_u32 v5, v2, 12, v5
  s_xor_b32 s40, s7, 1
  s_lshl_b32 s41, s40, 14
  s_nop 6
  buffer_store_dwordx4 v[48:51], v5, s[28:31], s41 offen sc0 sc1
  buffer_store_dwordx4 v[52:55], v5, s[28:31], s41 offen offset:1024 sc0 sc1
  buffer_store_dwordx4 v[56:59], v5, s[28:31], s41 offen offset:2048 sc0 sc1
  buffer_store_dwordx4 v[60:63], v5, s[28:31], s41 offen offset:3072 sc0 sc1
  v_and_b32 v10, 31, v1
  v_mul_u32_u24 v10, 80, v10
  v_lshrrev_b32 v11, 5, v1
  v_lshl_add_u32 v10, v11, 3, v10
  v_lshl_add_u32 v6, v2, 12, v10
  v_add_u32 v6, 65536, v6
  v_lshrrev_b32 v10, 2, v1
  v_and_b32 v11, 3, v1
  v_mul_u32_u24 v12, 80, v10
  v_lshl_add_u32 v12, v11, 4, v12
  v_lshl_add_u32 v7, v2, 12, v12
  v_add_u32 v7, 65536, v7
  v_lshl_add_u32 v10, v2, 5, v10
  v_mul_u32_u24 v10, 1280, v10
  v_lshl_add_u32 v8, v11, 4, v10
  s_lshl_b32 s41, s11, 1
  s_add_u32 s41, s41, s7
  s_lshl_b32 s41, s41, 7
  s_add_u32 s41, s41, 32768
  s_lshl_b32 s40, s19, 4
  s_add_u32 s41, s41, s40
  v_mov_b32 v13, s41
  v_xor_b32 v14, 128, v13
  s_waitcnt vmcnt(0)
  s_mov_b64 exec, 1
  buffer_store_dword v255, v13, s[56:59], 0 offen sc0 sc1
  s_mov_b32 s45, 30000
L_p2_q0:
  buffer_load_dword v15, v14, s[56:59], 0 offen sc0 sc1
  s_waitcnt vmcnt(0)
  v_cmp_ne_u32 vcc, v15, v255
  s_cbranch_vccz L_p2_q1
  s_sleep 1
  s_sub_u32 s45, s45, 1
  s_cmp_lg_u32 s45, 0
  s_cbranch_scc1 L_p2_q0
L_p2_q1:
  s_mov_b64 exec, -1
  s_lshl_b32 s40, s7, 14
  buffer_load_dwordx4 v[64:67], v5, s[28:31], s40 offen sc0 sc1
  buffer_load_dwordx4 v[68:71], v5, s[28:31], s40 offen offset:1024 sc0 sc1
  buffer_load_dwordx4 v[72:75], v5, s[28:31], s40 offen offset:2048 sc0 sc1
  buffer_load_dwordx4 v[76:79], v5, s[28:31], s40 offen offset:3072 sc0 sc1
  s_waitcnt vmcnt(3)
  v_add_f32 v32, v32, v64
  v_add_f32 v33, v33, v65
  v_add_f32 v34, v34, v66
  v_add_f32 v35, v35, v67
  v_cvt_pk_bf16_f32 v32, v32, v33
  v_cvt_pk_bf16_f32 v33, v34, v35
  ds_write_b64 v6, v[32:33]
  s_waitcnt vmcnt(2)
  v_add_f32 v36, v36, v68
  v_add_f32 v37, v37, v69
  v_add_f32 v38, v38, v70
  v_add_f32 v39, v39, v71
  v_cvt_pk_bf16_f32 v36, v36, v37
  v_cvt_pk_bf16_f32 v37, v38, v39
  ds_write_b64 v6, v[36:37] offset:16
  s_waitcnt vmcnt(1)
  v_add_f32 v40, v40, v72
  v_add_f32 v41, v41, v73
  v_add_f32 v42, v42, v74
  v_add_f32 v43, v43, v75
  v_cvt_pk_bf16_f32 v40, v40, v41
  v_cvt_pk_bf16_f32 v41, v42, v43
  ds_write_b64 v6, v[40:41] offset:32
  s_waitcnt vmcnt(0)
  v_add_f32 v44, v44, v76
  v_add_f32 v45, v45, v77
  v_add_f32 v46, v46, v78
  v_add_f32 v47, v47, v79
  v_cvt_pk_bf16_f32 v44, v44, v45
  v_cvt_pk_bf16_f32 v45, v46, v47
  ds_write_b64 v6, v[44:45] offset:48
  s_waitcnt lgkmcnt(0)
  ds_read_b128 v[80:83], v7
  ds_read_b128 v[84:87], v7 offset:1280
  s_mov_b32 s40, 20480
  s_waitcnt lgkmcnt(1)
  buffer_store_dwordx4 v[80:83], v8, s[32:35], 0 offen
  s_waitcnt lgkmcnt(0)
  buffer_store_dwordx4 v[84:87], v8, s[32:35], s40 offen
L_attn_end:
  s_endpgm
L_attn_rare0:
  s_nop 3
  v_mov_b32 v14, v249
  s_nop 1
  v_permlane32_swap_b32 v249, v14
  v_max_f32 v240, v249, v14
  v_sub_f32 v16, v16, v240
  v_sub_f32 v17, v17, v240
  v_sub_f32 v18, v18, v240
  v_sub_f32 v19, v19, v240
  v_sub_f32 v20, v20, v240
  v_sub_f32 v21, v21, v240
  v_sub_f32 v22, v22, v240
  v_sub_f32 v23, v23, v240
  v_sub_f32 v24, v24, v240
  v_sub_f32 v25, v25, v240
  v_sub_f32 v26, v26, v240
  v_sub_f32 v27, v27, v240
  v_sub_f32 v28, v28, v240
  v_sub_f32 v29, v29, v240
  v_sub_f32 v30, v30, v240
  v_sub_f32 v31, v31, v240
  v_sub_f32 v176, 0, v240
  v_sub_f32 v177, 0, v240
  v_sub_f32 v178, 0, v240
  v_sub_f32 v179, 0, v240
  v_sub_f32 v180, 0, v240
  v_sub_f32 v181, 0, v240
  v_sub_f32 v182, 0, v240
  v_sub_f32 v183, 0, v240
  v_sub_f32 v184, 0, v240
  v_sub_f32 v185, 0, v240
  v_sub_f32 v186, 0, v240
  v_sub_f32 v187, 0, v240
  v_sub_f32 v188, 0, v240
  v_sub_f32 v189, 0, v240
  v_sub_f32 v190, 0, v240
  v_sub_f32 v191, 0, v240
  v_mov_b32 v14, v250
  s_nop 1
  v_permlane32_swap_b32 v250, v14
  v_max_f32 v241, v250, v14
  v_sub_f32 v32, v32, v241
  v_sub_f32 v33, v33, v241
  v_sub_f32 v34, v34, v241
  v_sub_f32 v35, v35, v241
  v_sub_f32 v36, v36, v241
  v_sub_f32 v37, v37, v241
  v_sub_f32 v38, v38, v241
  v_sub_f32 v39, v39, v241
  v_sub_f32 v40, v40, v241
  v_sub_f32 v41, v41, v241
  v_sub_f32 v42, v42, v241
  v_sub_f32 v43, v43, v241
  v_sub_f32 v44, v44, v241
  v_sub_f32 v45, v45, v241
  v_sub_f32 v46, v46, v241
  v_sub_f32 v47, v47, v241
  v_sub_f32 v192, 0, v241
  v_sub_f32 v193, 0, v241
  v_sub_f32 v194, 0, v241
  v_sub_f32 v195, 0, v241
  v_sub_f32 v196, 0, v241
  v_sub_f32 v197, 0, v241
  v_sub_f32 v198, 0, v241
  v_sub_f32 v199, 0, v241
  v_sub_f32 v200, 0, v241
  v_sub_f32 v201, 0, v241
  v_sub_f32 v202, 0, v241
  v_sub_f32 v203, 0, v241
  v_sub_f32 v204, 0, v241
  v_sub_f32 v205, 0, v241
  v_sub_f32 v206, 0, v241
  v_sub_f32 v207, 0, v241
  v_mov_b32 v14, v251
  s_nop 1
  v_permlane32_swap_b32 v251, v14
  v_max_f32 v242, v251, v14
  v_sub_f32 v48, v48, v242
  v_sub_f32 v49, v49, v242
  v_sub_f32 v50, v50, v242
  v_sub_f32 v51, v51, v242
  v_sub_f32 v52, v52, v242
  v_sub_f32 v53, v53, v242
  v_sub_f32 v54, v54, v242
  v_sub_f32 v55, v55, v242
  v_sub_f32 v56, v56, v242
  v_sub_f32 v57, v57, v242
  v_sub_f32 v58, v58, v242
  v_sub_f32 v59, v59, v242
  v_sub_f32 v60, v60, v242
  v_sub_f32 v61, v61, v242
  v_sub_f32 v62, v62, v242
  v_sub_f32 v63, v63, v242
  v_sub_f32 v208, 0, v242
  v_sub_f32 v209, 0, v242
  v_sub_f32 v210, 0, v242
  v_sub_f32 v211, 0, v242
  v_sub_f32 v212, 0, v242
  v_sub_f32 v213, 0, v242
  v_sub_f32 v214, 0, v242
  v_sub_f32 v215, 0, v242
  v_sub_f32 v216, 0, v242
  v_sub_f32 v217, 0, v242
  v_sub_f32 v218, 0, v242
  v_sub_f32 v219, 0, v242
  v_sub_f32 v220, 0, v242
  v_sub_f32 v221, 0, v242
  v_sub_f32 v222, 0, v242
  v_sub_f32 v223, 0, v242
  s_mov_b32 s53, 1
  s_nop 3
  s_branch L_attn_ret0
L_attn_fix1:
  s_nop 11
  v_sub_f32 v64, v64, v240
  v_sub_f32 v65, v65, v240
  v_sub_f32 v66, v66, v240
  v_sub_f32 v67, v67, v240
  v_sub_f32 v68, v68, v240
  v_sub_f32 v69, v69, v240
  v_sub_f32 v70, v70, v240
  v_sub_f32 v71, v71, v240
  v_sub_f32 v72, v72, v240
  v_sub_f32 v73, v73, v240
  v_sub_f32 v74, v74, v240
  v_sub_f32 v75, v75, v240
  v_sub_f32 v76, v76, v240
  v_sub_f32 v77, v77, v240
  v_sub_f32 v78, v78, v240
  v_sub_f32 v79, v79, v240
  v_sub_f32 v80, v80, v241
  v_sub_f32 v81, v81, v241
  v_sub_f32 v82, v82, v241
  v_sub_f32 v83, v83, v241
  v_sub_f32 v84, v84, v241
  v_sub_f32 v85, v85, v241
  v_sub_f32 v86, v86, v241
  v_sub_f32 v87, v87, v241
  v_sub_f32 v88, v88, v241
  v_sub_f32 v89, v89, v241
  v_sub_f32 v90, v90, v241
  v_sub_f32 v91, v91, v241
  v_sub_f32 v92, v92, v241
  v_sub_f32 v93, v93, v241
  v_sub_f32 v94, v94, v241
  v_sub_f32 v95, v95, v241
  v_sub_f32 v96, v96, v242
  v_sub_f32 v97, v97, v242
  v_sub_f32 v98, v98, v242
  v_sub_f32 v99, v99, v242
  v_sub_f32 v100, v100, v242
  v_sub_f32 v101, v101, v242
  v_sub_f32 v102, v102, v242
  v_sub_f32 v103, v103, v242
  v_sub_f32 v104, v104, v242
  v_sub_f32 v105, v105, v242
  v_sub_f32 v106, v106, v242
  v_sub_f32 v107, v107, v242
  v_sub_f32 v108, v108, v242
  v_sub_f32 v109, v109, v242
  v_sub_f32 v110, v110, v242
  v_sub_f32 v111, v111, v242
  s_nop 1
  s_branch L_attn_fix1ret
L_attn_rare1:
  s_nop 3
  v_max3_f32 v251, v64, v65, v66
  v_max3_f32 v251, v251, v67, v68
  v_max3_f32 v251, v251, v69, v70
  v_max3_f32 v251, v251, v71, v72
  v_max3_f32 v251, v251, v73, v74
  v_max3_f32 v251, v251, v75, v76
  v_max3_f32 v251, v251, v77, v78
  v_max_f32 v251, v251, v79
  v_mov_b32 v14, v251
  s_nop 1
  v_permlane32_swap_b32 v251, v14
  v_max3_f32 v251, v251, v14, 0
  v_sub_f32 v64, v64, v251
  v_sub_f32 v65, v65, v251
  v_sub_f32 v66, v66, v251
  v_sub_f32 v67, v67, v251
  v_sub_f32 v68, v68, v251
  v_sub_f32 v69, v69, v251
  v_sub_f32 v70, v70, v251
  v_sub_f32 v71, v71, v251
  v_sub_f32 v72, v72, v251
  v_sub_f32 v73, v73, v251
  v_sub_f32 v74, v74, v251
  v_sub_f32 v75, v75, v251
  v_sub_f32 v76, v76, v251
  v_sub_f32 v77, v77, v251
  v_sub_f32 v78, v78, v251
  v_sub_f32 v79, v79, v251
  v_sub_f32 v176, v176, v251
  v_sub_f32 v177, v177, v251
  v_sub_f32 v178, v178, v251
  v_sub_f32 v179, v179, v251
  v_sub_f32 v180, v180, v251
  v_sub_f32 v181, v181, v251
  v_sub_f32 v182, v182, v251
  v_sub_f32 v183, v183, v251
  v_sub_f32 v184, v184, v251
  v_sub_f32 v185, v185, v251
  v_sub_f32 v186, v186, v251
  v_sub_f32 v187, v187, v251
  v_sub_f32 v188, v188, v251
  v_sub_f32 v189, v189, v251
  v_sub_f32 v190, v190, v251
  v_sub_f32 v191, v191, v251
  v_add_f32 v240, v240, v251
  v_sub_f32 v14, 0, v251
  v_exp_f32 v243, v14
  s_nop 0
  v_mul_f32 v246, v246, v243
  v_max3_f32 v251, v80, v81, v82
  v_max3_f32 v251, v251, v83, v84
  v_max3_f32 v251, v251, v85, v86
  v_max3_f32 v251, v251, v87, v88
  v_max3_f32 v251, v251, v89, v90
  v_max3_f32 v251, v251, v91, v92
  v_max3_f32 v251, v251, v93, v94
  v_max_f32 v251, v251, v95
  v_mov_b32 v14, v251
  s_nop 1
  v_permlane32_swap_b32 v251, v14
  v_max3_f32 v251, v251, v14, 0
  v_sub_f32 v80, v80, v251
  v_sub_f32 v81, v81, v251
  v_sub_f32 v82, v82, v251
  v_sub_f32 v83, v83, v251
  v_sub_f32 v84, v84, v251
  v_sub_f32 v85, v85, v251
  v_sub_f32 v86, v86, v251
  v_sub_f32 v87, v87, v251
  v_sub_f32 v88, v88, v251
  v_sub_f32 v89, v89, v251
  v_sub_f32 v90, v90, v251
  v_sub_f32 v91, v91, v251
  v_sub_f32 v92, v92, v251
  v_sub_f32 v93, v93, v251
  v_sub_f32 v94, v94, v251
  v_sub_f32 v95, v95, v251
  v_sub_f32 v192, v192, v251
  v_sub_f32 v193, v193, v251
  v_sub_f32 v194, v194, v251
  v_sub_f32 v195, v195, v251
  v_sub_f32 v196, v196, v251
  v_sub_f32 v197, v197, v251
  v_sub_f32 v198, v198, v251
  v_sub_f32 v199, v199, v251
  v_sub_f32 v200, v200, v251
  v_sub_f32 v201, v201, v251
  v_sub_f32 v202, v202, v251
  v_sub_f32 v203, v203, v251
  v_sub_f32 v204, v204, v251
  v_sub_f32 v205, v205, v251
  v_sub_f32 v206, v206, v251
  v_sub_f32 v207, v207, v251
  v_add_f32 v241, v241, v251
  v_sub_f32 v14, 0, v251
  v_exp_f32 v244, v14
  s_nop 0
  v_mul_f32 v247, v247, v244
  v_max3_f32 v251, v96, v97, v98
  v_max3_f32 v251, v251, v99, v100
  v_max3_f32 v251, v251, v101, v102
  v_max3_f32 v251, v251, v103, v104
  v_max3_f32 v251, v251, v105, v106
  v_max3_f32 v251, v251, v107, v108
  v_max3_f32 v251, v251, v109, v110
  v_max_f32 v251, v251, v111
  v_mov_b32 v14, v251
  s_nop 1
  v_permlane32_swap_b32 v251, v14
  v_max3_f32 v251, v251, v14, 0
  v_sub_f32 v96, v96, v251
  v_sub_f32 v97, v97, v251
  v_sub_f32 v98, v98, v251
  v_sub_f32 v99, v99, v251
  v_sub_f32 v100, v100, v251
  v_sub_f32 v101, v101, v251
  v_sub_f32 v102, v102, v251
  v_sub_f32 v103, v103, v251
  v_sub_f32 v104, v104, v251
  v_sub_f32 v105, v105, v251
  v_sub_f32 v106, v106, v251
  v_sub_f32 v107, v107, v251
  v_sub_f32 v108, v108, v251
  v_sub_f32 v109, v109, v251
  v_sub_f32 v110, v110, v251
  v_sub_f32 v111, v111, v251
  v_sub_f32 v208, v208, v251
  v_sub_f32 v209, v209, v251
  v_sub_f32 v210, v210, v251
  v_sub_f32 v211, v211, v251
  v_sub_f32 v212, v212, v251
  v_sub_f32 v213, v213, v251
  v_sub_f32 v214, v214, v251
  v_sub_f32 v215, v215, v251
  v_sub_f32 v216, v216, v251
  v_sub_f32 v217, v217, v251
  v_sub_f32 v218, v218, v251
  v_sub_f32 v219, v219, v251
  v_sub_f32 v220, v220, v251
  v_sub_f32 v221, v221, v251
  v_sub_f32 v222, v222, v251
  v_sub_f32 v223, v223, v251
  v_add_f32 v242, v242, v251
  v_sub_f32 v14, 0, v251
  v_exp_f32 v245, v14
  s_nop 0
  v_mul_f32 v248, v248, v245
  s_mov_b32 s52, 1
  s_nop 3
  s_branch L_attn_ret1
L_attn_rare2:
  s_nop 3
  v_max3_f32 v251, v16, v17, v18
  v_max3_f32 v251, v251, v19, v20
  v_max3_f32 v251, v251, v21, v22
  v_max3_f32 v251, v251, v23, v24
  v_max3_f32 v251, v251, v25, v26
  v_max3_f32 v251, v251, v27, v28
  v_max3_f32 v251, v251, v29, v30
  v_max_f32 v251, v251, v31
  v_mov_b32 v14, v251
  s_nop 1
  v_permlane32_swap_b32 v251, v14
  v_max3_f32 v251, v251, v14, 0
  v_sub_f32 v16, v16, v251
  v_sub_f32 v17, v17, v251
  v_sub_f32 v18, v18, v251
  v_sub_f32 v19, v19, v251
  v_sub_f32 v20, v20, v251
  v_sub_f32 v21, v21, v251
  v_sub_f32 v22, v22, v251
  v_sub_f32 v23, v23, v251
  v_sub_f32 v24, v24, v251
  v_sub_f32 v25, v25, v251
  v_sub_f32 v26, v26, v251
  v_sub_f32 v27, v27, v251
  v_sub_f32 v28, v28, v251
  v_sub_f32 v29, v29, v251
  v_sub_f32 v30, v30, v251
  v_sub_f32 v31, v31, v251
  v_sub_f32 v176, v176, v251
  v_sub_f32 v177, v177, v251
  v_sub_f32 v178, v178, v251
  v_sub_f32 v179, v179, v251
  v_sub_f32 v180, v180, v251
  v_sub_f32 v181, v181, v251
  v_sub_f32 v182, v182, v251
  v_sub_f32 v183, v183, v251
  v_sub_f32 v184, v184, v251
  v_sub_f32 v185, v185, v251
  v_sub_f32 v186, v186, v251
  v_sub_f32 v187, v187, v251
  v_sub_f32 v188, v188, v251
  v_sub_f32 v189, v189, v251
  v_sub_f32 v190, v190, v251
  v_sub_f32 v191, v191, v251
  v_add_f32 v240, v240, v251
  v_sub_f32 v14, 0, v251
  v_exp_f32 v243, v14
  s_nop 0
  v_mul_f32 v246, v246, v243
  v_max3_f32 v251, v32, v33, v34
  v_max3_f32 v251, v251, v35, v36
  v_max3_f32 v251, v251, v37, v38
  v_max3_f32 v251, v251, v39, v40
  v_max3_f32 v251, v251, v41, v42
  v_max3_f32 v251, v251, v43, v44
  v_max3_f32 v251, v251, v45, v46
  v_max_f32 v251, v251, v47
  v_mov_b32 v14, v251
  s_nop 1
  v_permlane32_swap_b32 v251, v14
  v_max3_f32 v251, v251, v14, 0
  v_sub_f32 v32, v32, v251
  v_sub_f32 v33, v33, v251
  v_sub_f32 v34, v34, v251
  v_sub_f32 v35, v35, v251
  v_sub_f32 v36, v36, v251
  v_sub_f32 v37, v37, v251
  v_sub_f32 v38, v38, v251
  v_sub_f32 v39, v39, v251
  v_sub_f32 v40, v40, v251
  v_sub_f32 v41, v41, v251
  v_sub_f32 v42, v42, v251
  v_sub_f32 v43, v43, v251
  v_sub_f32 v44, v44, v251
  v_sub_f32 v45, v45, v251
  v_sub_f32 v46, v46, v251
  v_sub_f32 v47, v47, v251
  v_sub_f32 v192, v192, v251
  v_sub_f32 v193, v193, v251
  v_sub_f32 v194, v194, v251
  v_sub_f32 v195, v195, v251
  v_sub_f32 v196, v196, v251
  v_sub_f32 v197, v197, v251
  v_sub_f32 v198, v198, v251
  v_sub_f32 v199, v199, v251
  v_sub_f32 v200, v200, v251
  v_sub_f32 v201, v201, v251
  v_sub_f32 v202, v202, v251
  v_sub_f32 v203, v203, v251
  v_sub_f32 v204, v204, v251
  v_sub_f32 v205, v205, v251
  v_sub_f32 v206, v206, v251
  v_sub_f32 v207, v207, v251
  v_add_f32 v241, v241, v251
  v_sub_f32 v14, 0, v251
  v_exp_f32 v244, v14
  s_nop 0
  v_mul_f32 v247, v247, v244
  v_max3_f32 v251, v48, v49, v50
  v_max3_f32 v251, v251, v51, v52
  v_max3_f32 v251, v251, v53, v54
  v_max3_f32 v251, v251, v55, v56
  v_max3_f32 v251, v251, v57, v58
  v_max3_f32 v251, v251, v59, v60
  v_max3_f32 v251, v251, v61, v62
  v_max_f32 v251, v251, v63
  v_mov_b32 v14, v251
  s_nop 1
  v_permlane32_swap_b32 v251, v14
  v_max3_f32 v251, v251, v14, 0
  v_sub_f32 v48, v48, v251
  v_sub_f32 v49, v49, v251
  v_sub_f32 v50, v50, v251
  v_sub_f32 v51, v51, v251
  v_sub_f32 v52, v52, v251
  v_sub_f32 v53, v53, v251
  v_sub_f32 v54, v54, v251
  v_sub_f32 v55, v55, v251
  v_sub_f32 v56, v56, v251
  v_sub_f32 v57, v57, v251
  v_sub_f32 v58, v58, v251
  v_sub_f32 v59, v59, v251
  v_sub_f32 v60, v60, v251
  v_sub_f32 v61, v61, v251
  v_sub_f32 v62, v62, v251
  v_sub_f32 v63, v63, v251
  v_sub_f32 v208, v208, v251
  v_sub_f32 v209, v209, v251
  v_sub_f32 v210, v210, v251
  v_sub_f32 v211, v211, v251
  v_sub_f32 v212, v212, v251
  v_sub_f32 v213, v213, v251
  v_sub_f32 v214, v214, v251
  v_sub_f32 v215, v215, v251
  v_sub_f32 v216, v216, v251
  v_sub_f32 v217, v217, v251
  v_sub_f32 v218, v218, v251
  v_sub_f32 v219, v219, v251
  v_sub_f32 v220, v220, v251
  v_sub_f32 v221, v221, v251
  v_sub_f32 v222, v222, v251
  v_sub_f32 v223, v223, v251
  v_add_f32 v242, v242, v251
  v_sub_f32 v14, 0, v251
  v_exp_f32 v245, v14
  s_nop 0
  v_mul_f32 v248, v248, v245
  s_mov_b32 s52, 1
  s_nop 3
  s_branch L_attn_ret2
L_attn_rare3:
  s_nop 3
  v_max3_f32 v251, v64, v65, v66
  v_max3_f32 v251, v251, v67, v68
  v_max3_f32 v251, v251, v69, v70
  v_max3_f32 v251, v251, v71, v72
  v_max3_f32 v251, v251, v73, v74
  v_max3_f32 v251, v251, v75, v76
  v_max3_f32 v251, v251, v77, v78
  v_max_f32 v251, v251, v79
  v_mov_b32 v14, v251
  s_nop 1
  v_permlane32_swap_b32 v251, v14
  v_max3_f32 v251, v251, v14, 0
  v_sub_f32 v64, v64, v251
  v_sub_f32 v65, v65, v251
  v_sub_f32 v66, v66, v251
  v_sub_f32 v67, v67, v251
  v_sub_f32 v68, v68, v251
  v_sub_f32 v69, v69, v251
  v_sub_f32 v70, v70, v251
  v_sub_f32 v71, v71, v251
  v_sub_f32 v72, v72, v251
  v_sub_f32 v73, v73, v251
  v_sub_f32 v74, v74, v251
  v_sub_f32 v75, v75, v251
  v_sub_f32 v76, v76, v251
  v_sub_f32 v77, v77, v251
  v_sub_f32 v78, v78, v251
  v_sub_f32 v79, v79, v251
  v_sub_f32 v176, v176, v251
  v_sub_f32 v177, v177, v251
  v_sub_f32 v178, v178, v251
  v_sub_f32 v179, v179, v251
  v_sub_f32 v180, v180, v251
  v_sub_f32 v181, v181, v251
  v_sub_f32 v182, v182, v251
  v_sub_f32 v183, v183, v251
  v_sub_f32 v184, v184, v251
  v_sub_f32 v185, v185, v251
  v_sub_f32 v186, v186, v251
  v_sub_f32 v187, v187, v251
  v_sub_f32 v188, v188, v251
  v_sub_f32 v189, v189, v251
  v_sub_f32 v190, v190, v251
  v_sub_f32 v191, v191, v251
  v_add_f32 v240, v240, v251
  v_sub_f32 v14, 0, v251
  v_exp_f32 v243, v14
  s_nop 0
  v_mul_f32 v246, v246, v243
  v_max3_f32 v251, v80, v81, v82
  v_max3_f32 v251, v251, v83, v84
  v_max3_f32 v251, v251, v85, v86
  v_max3_f32 v251, v251, v87, v88
  v_max3_f32 v251, v251, v89, v90
  v_max3_f32 v251, v251, v91, v92
  v_max3_f32 v251, v251, v93, v94
  v_max_f32 v251, v251, v95
  v_mov_b32 v14, v251
  s_nop 1
  v_permlane32_swap_b32 v251, v14
  v_max3_f32 v251, v251, v14, 0
  v_sub_f32 v80, v80, v251
  v_sub_f32 v81, v81, v251
  v_sub_f32 v82, v82, v251
  v_sub_f32 v83, v83, v251
  v_sub_f32 v84, v84, v251
  v_sub_f32 v85, v85, v251
  v_sub_f32 v86, v86, v251
  v_sub_f32 v87, v87, v251
  v_sub_f32 v88, v88, v251
  v_sub_f32 v89, v89, v251
  v_sub_f32 v90, v90, v251
  v_sub_f32 v91, v91, v251
  v_sub_f32 v92, v92, v251
  v_sub_f32 v93, v93, v251
  v_sub_f32 v94, v94, v251
  v_sub_f32 v95, v95, v251
  v_sub_f32 v192, v192, v251
  v_sub_f32 v193, v193, v251
  v_sub_f32 v194, v194, v251
  v_sub_f32 v195, v195, v251
  v_sub_f32 v196, v196, v251
  v_sub_f32 v197, v197, v251
  v_sub_f32 v198, v198, v251
  v_sub_f32 v199, v199, v251
  v_sub_f32 v200, v200, v251
  v_sub_f32 v201, v201, v251
  v_sub_f32 v202, v202, v251
  v_sub_f32 v203, v203, v251
  v_sub_f32 v204, v204, v251
  v_sub_f32 v205, v205, v251
  v_sub_f32 v206, v206, v251
  v_sub_f32 v207, v207, v251
  v_add_f32 v241, v241, v251
  v_sub_f32 v14, 0, v251
  v_exp_f32 v244, v14
  s_nop 0
  v_mul_f32 v247, v247, v244
  v_max3_f32 v251, v96, v97, v98
  v_max3_f32 v251, v251, v99, v100
  v_max3_f32 v251, v251, v101, v102
  v_max3_f32 v251, v251, v103, v104
  v_max3_f32 v251, v251, v105, v106
  v_max3_f32 v251, v251, v107, v108
  v_max3_f32 v251, v251, v109, v110
  v_max_f32 v251, v251, v111
  v_mov_b32 v14, v251
  s_nop 1
  v_permlane32_swap_b32 v251, v14
  v_max3_f32 v251, v251, v14, 0
  v_sub_f32 v96, v96, v251
  v_sub_f32 v97, v97, v251
  v_sub_f32 v98, v98, v251
  v_sub_f32 v99, v99, v251
  v_sub_f32 v100, v100, v251
  v_sub_f32 v101, v101, v251
  v_sub_f32 v102, v102, v251
  v_sub_f32 v103, v103, v251
  v_sub_f32 v104, v104, v251
  v_sub_f32 v105, v105, v251
  v_sub_f32 v106, v106, v251
  v_sub_f32 v107, v107, v251
  v_sub_f32 v108, v108, v251
  v_sub_f32 v109, v109, v251
  v_sub_f32 v110, v110, v251
  v_sub_f32 v111, v111, v251
  v_sub_f32 v208, v208, v251
  v_sub_f32 v209, v209, v251
  v_sub_f32 v210, v210, v251
  v_sub_f32 v211, v211, v251
  v_sub_f32 v212, v212, v251
  v_sub_f32 v213, v213, v251
  v_sub_f32 v214, v214, v251
  v_sub_f32 v215, v215, v251
  v_sub_f32 v216, v216, v251
  v_sub_f32 v217, v217, v251
  v_sub_f32 v218, v218, v251
  v_sub_f32 v219, v219, v251
  v_sub_f32 v220, v220, v251
  v_sub_f32 v221, v221, v251
  v_sub_f32 v222, v222, v251
  v_sub_f32 v223, v223, v251
  v_add_f32 v242, v242, v251
  v_sub_f32 v14, 0, v251
  v_exp_f32 v245, v14
  s_nop 0
  v_mul_f32 v248, v248, v245
  s_mov_b32 s52, 1
  s_nop 3
  s_branch L_attn_ret3
L_attn_rare4:
  s_nop 3
  v_max3_f32 v251, v16, v17, v18
  v_max3_f32 v251, v251, v19, v20
  v_max3_f32 v251, v251, v21, v22
  v_max3_f32 v251, v251, v23, v24
  v_max3_f32 v251, v251, v25, v26
  v_max3_f32 v251, v251, v27, v28
  v_max3_f32 v251, v251, v29, v30
  v_max_f32 v251, v251, v31
  v_mov_b32 v14, v251
  s_nop 1
  v_permlane32_swap_b32 v251, v14
  v_max3_f32 v251, v251, v14, 0
  v_sub_f32 v16, v16, v251
  v_sub_f32 v17, v17, v251
  v_sub_f32 v18, v18, v251
  v_sub_f32 v19, v19, v251
  v_sub_f32 v20, v20, v251
  v_sub_f32 v21, v21, v251
  v_sub_f32 v22, v22, v251
  v_sub_f32 v23, v23, v251
  v_sub_f32 v24, v24, v251
  v_sub_f32 v25, v25, v251
  v_sub_f32 v26, v26, v251
  v_sub_f32 v27, v27, v251
  v_sub_f32 v28, v28, v251
  v_sub_f32 v29, v29, v251
  v_sub_f32 v30, v30, v251
  v_sub_f32 v31, v31, v251
  v_sub_f32 v176, v176, v251
  v_sub_f32 v177, v177, v251
  v_sub_f32 v178, v178, v251
  v_sub_f32 v179, v179, v251
  v_sub_f32 v180, v180, v251
  v_sub_f32 v181, v181, v251
  v_sub_f32 v182, v182, v251
  v_sub_f32 v183, v183, v251
  v_sub_f32 v184, v184, v251
  v_sub_f32 v185, v185, v251
  v_sub_f32 v186, v186, v251
  v_sub_f32 v187, v187, v251
  v_sub_f32 v188, v188, v251
  v_sub_f32 v189, v189, v251
  v_sub_f32 v190, v190, v251
  v_sub_f32 v191, v191, v251
  v_add_f32 v240, v240, v251
  v_sub_f32 v14, 0, v251
  v_exp_f32 v243, v14
  s_nop 0
  v_mul_f32 v246, v246, v243
  v_max3_f32 v251, v32, v33, v34
  v_max3_f32 v251, v251, v35, v36
  v_max3_f32 v251, v251, v37, v38
  v_max3_f32 v251, v251, v39, v40
  v_max3_f32 v251, v251, v41, v42
  v_max3_f32 v251, v251, v43, v44
  v_max3_f32 v251, v251, v45, v46
  v_max_f32 v251, v251, v47
  v_mov_b32 v14, v251
  s_nop 1
  v_permlane32_swap_b32 v251, v14
  v_max3_f32 v251, v251, v14, 0
  v_sub_f32 v32, v32, v251
  v_sub_f32 v33, v33, v251
  v_sub_f32 v34, v34, v251
  v_sub_f32 v35, v35, v251
  v_sub_f32 v36, v36, v251
  v_sub_f32 v37, v37, v251
  v_sub_f32 v38, v38, v251
  v_sub_f32 v39, v39, v251
  v_sub_f32 v40, v40, v251
  v_sub_f32 v41, v41, v251
  v_sub_f32 v42, v42, v251
  v_sub_f32 v43, v43, v251
  v_sub_f32 v44, v44, v251
  v_sub_f32 v45, v45, v251
  v_sub_f32 v46, v46, v251
  v_sub_f32 v47, v47, v251
  v_sub_f32 v192, v192, v251
  v_sub_f32 v193, v193, v251
  v_sub_f32 v194, v194, v251
  v_sub_f32 v195, v195, v251
  v_sub_f32 v196, v196, v251
  v_sub_f32 v197, v197, v251
  v_sub_f32 v198, v198, v251
  v_sub_f32 v199, v199, v251
  v_sub_f32 v200, v200, v251
  v_sub_f32 v201, v201, v251
  v_sub_f32 v202, v202, v251
  v_sub_f32 v203, v203, v251
  v_sub_f32 v204, v204, v251
  v_sub_f32 v205, v205, v251
  v_sub_f32 v206, v206, v251
  v_sub_f32 v207, v207, v251
  v_add_f32 v241, v241, v251
  v_sub_f32 v14, 0, v251
  v_exp_f32 v244, v14
  s_nop 0
  v_mul_f32 v247, v247, v244
  v_max3_f32 v251, v48, v49, v50
  v_max3_f32 v251, v251, v51, v52
  v_max3_f32 v251, v251, v53, v54
  v_max3_f32 v251, v251, v55, v56
  v_max3_f32 v251, v251, v57, v58
  v_max3_f32 v251, v251, v59, v60
  v_max3_f32 v251, v251, v61, v62
  v_max_f32 v251, v251, v63
  v_mov_b32 v14, v251
  s_nop 1
  v_permlane32_swap_b32 v251, v14
  v_max3_f32 v251, v251, v14, 0
  v_sub_f32 v48, v48, v251
  v_sub_f32 v49, v49, v251
  v_sub_f32 v50, v50, v251
  v_sub_f32 v51, v51, v251
  v_sub_f32 v52, v52, v251
  v_sub_f32 v53, v53, v251
  v_sub_f32 v54, v54, v251
  v_sub_f32 v55, v55, v251
  v_sub_f32 v56, v56, v251
  v_sub_f32 v57, v57, v251
  v_sub_f32 v58, v58, v251
  v_sub_f32 v59, v59, v251
  v_sub_f32 v60, v60, v251
  v_sub_f32 v61, v61, v251
  v_sub_f32 v62, v62, v251
  v_sub_f32 v63, v63, v251
  v_sub_f32 v208, v208, v251
  v_sub_f32 v209, v209, v251
  v_sub_f32 v210, v210, v251
  v_sub_f32 v211, v211, v251
  v_sub_f32 v212, v212, v251
  v_sub_f32 v213, v213, v251
  v_sub_f32 v214, v214, v251
  v_sub_f32 v215, v215, v251
  v_sub_f32 v216, v216, v251
  v_sub_f32 v217, v217, v251
  v_sub_f32 v218, v218, v251
  v_sub_f32 v219, v219, v251
  v_sub_f32 v220, v220, v251
  v_sub_f32 v221, v221, v251
  v_sub_f32 v222, v222, v251
  v_sub_f32 v223, v223, v251
  v_add_f32 v242, v242, v251
  v_sub_f32 v14, 0, v251
  v_exp_f32 v245, v14
  s_nop 0
  v_mul_f32 v248, v248, v245
  s_mov_b32 s52, 1
  s_nop 3
  s_branch L_attn_ret4
L_attn_rare5:
  s_nop 3
  v_max3_f32 v251, v64, v65, v66
  v_max3_f32 v251, v251, v67, v68
  v_max3_f32 v251, v251, v69, v70
  v_max3_f32 v251, v251, v71, v72
  v_max3_f32 v251, v251, v73, v74
  v_max3_f32 v251, v251, v75, v76
  v_max3_f32 v251, v251, v77, v78
  v_max_f32 v251, v251, v79
  v_mov_b32 v14, v251
  s_nop 1
  v_permlane32_swap_b32 v251, v14
  v_max3_f32 v251, v251, v14, 0
  v_sub_f32 v64, v64, v251
  v_sub_f32 v65, v65, v251
  v_sub_f32 v66, v66, v251
  v_sub_f32 v67, v67, v251
  v_sub_f32 v68, v68, v251
  v_sub_f32 v69, v69, v251
  v_sub_f32 v70, v70, v251
  v_sub_f32 v71, v71, v251
  v_sub_f32 v72, v72, v251
  v_sub_f32 v73, v73, v251
  v_sub_f32 v74, v74, v251
  v_sub_f32 v75, v75, v251
  v_sub_f32 v76, v76, v251
  v_sub_f32 v77, v77, v251
  v_sub_f32 v78, v78, v251
  v_sub_f32 v79, v79, v251
  v_sub_f32 v176, v176, v251
  v_sub_f32 v177, v177, v251
  v_sub_f32 v178, v178, v251
  v_sub_f32 v179, v179, v251
  v_sub_f32 v180, v180, v251
  v_sub_f32 v181, v181, v251
  v_sub_f32 v182, v182, v251
  v_sub_f32 v183, v183, v251
  v_sub_f32 v184, v184, v251
  v_sub_f32 v185, v185, v251
  v_sub_f32 v186, v186, v251
  v_sub_f32 v187, v187, v251
  v_sub_f32 v188, v188, v251
  v_sub_f32 v189, v189, v251
  v_sub_f32 v190, v190, v251
  v_sub_f32 v191, v191, v251
  v_add_f32 v240, v240, v251
  v_sub_f32 v14, 0, v251
  v_exp_f32 v243, v14
  s_nop 0
  v_mul_f32 v246, v246, v243
  v_max3_f32 v251, v80, v81, v82
  v_max3_f32 v251, v251, v83, v84
  v_max3_f32 v251, v251, v85, v86
  v_max3_f32 v251, v251, v87, v88
  v_max3_f32 v251, v251, v89, v90
  v_max3_f32 v251, v251, v91, v92
  v_max3_f32 v251, v251, v93, v94
  v_max_f32 v251, v251, v95
  v_mov_b32 v14, v251
  s_nop 1
  v_permlane32_swap_b32 v251, v14
  v_max3_f32 v251, v251, v14, 0
  v_sub_f32 v80, v80, v251
  v_sub_f32 v81, v81, v251
  v_sub_f32 v82, v82, v251
  v_sub_f32 v83, v83, v251
  v_sub_f32 v84, v84, v251
  v_sub_f32 v85, v85, v251
  v_sub_f32 v86, v86, v251
  v_sub_f32 v87, v87, v251
  v_sub_f32 v88, v88, v251
  v_sub_f32 v89, v89, v251
  v_sub_f32 v90, v90, v251
  v_sub_f32 v91, v91, v251
  v_sub_f32 v92, v92, v251
  v_sub_f32 v93, v93, v251
  v_sub_f32 v94, v94, v251
  v_sub_f32 v95, v95, v251
  v_sub_f32 v192, v192, v251
  v_sub_f32 v193, v193, v251
  v_sub_f32 v194, v194, v251
  v_sub_f32 v195, v195, v251
  v_sub_f32 v196, v196, v251
  v_sub_f32 v197, v197, v251
  v_sub_f32 v198, v198, v251
  v_sub_f32 v199, v199, v251
  v_sub_f32 v200, v200, v251
  v_sub_f32 v201, v201, v251
  v_sub_f32 v202, v202, v251
  v_sub_f32 v203, v203, v251
  v_sub_f32 v204, v204, v251
  v_sub_f32 v205, v205, v251
  v_sub_f32 v206, v206, v251
  v_sub_f32 v207, v207, v251
  v_add_f32 v241, v241, v251
  v_sub_f32 v14, 0, v251
  v_exp_f32 v244, v14
  s_nop 0
  v_mul_f32 v247, v247, v244
  v_max3_f32 v251, v96, v97, v98
  v_max3_f32 v251, v251, v99, v100
  v_max3_f32 v251, v251, v101, v102
  v_max3_f32 v251, v251, v103, v104
  v_max3_f32 v251, v251, v105, v106
  v_max3_f32 v251, v251, v107, v108
  v_max3_f32 v251, v251, v109, v110
  v_max_f32 v251, v251, v111
  v_mov_b32 v14, v251
  s_nop 1
  v_permlane32_swap_b32 v251, v14
  v_max3_f32 v251, v251, v14, 0
  v_sub_f32 v96, v96, v251
  v_sub_f32 v97, v97, v251
  v_sub_f32 v98, v98, v251
  v_sub_f32 v99, v99, v251
  v_sub_f32 v100, v100, v251
  v_sub_f32 v101, v101, v251
  v_sub_f32 v102, v102, v251
  v_sub_f32 v103, v103, v251
  v_sub_f32 v104, v104, v251
  v_sub_f32 v105, v105, v251
  v_sub_f32 v106, v106, v251
  v_sub_f32 v107, v107, v251
  v_sub_f32 v108, v108, v251
  v_sub_f32 v109, v109, v251
  v_sub_f32 v110, v110, v251
  v_sub_f32 v111, v111, v251
  v_sub_f32 v208, v208, v251
  v_sub_f32 v209, v209, v251
  v_sub_f32 v210, v210, v251
  v_sub_f32 v211, v211, v251
  v_sub_f32 v212, v212, v251
  v_sub_f32 v213, v213, v251
  v_sub_f32 v214, v214, v251
  v_sub_f32 v215, v215, v251
  v_sub_f32 v216, v216, v251
  v_sub_f32 v217, v217, v251
  v_sub_f32 v218, v218, v251
  v_sub_f32 v219, v219, v251
  v_sub_f32 v220, v220, v251
  v_sub_f32 v221, v221, v251
  v_sub_f32 v222, v222, v251
  v_sub_f32 v223, v223, v251
  v_add_f32 v242, v242, v251
  v_sub_f32 v14, 0, v251
  v_exp_f32 v245, v14
  s_nop 0
  v_mul_f32 v248, v248, v245
  s_mov_b32 s52, 1
  s_nop 3
  s_branch L_attn_ret5
L_attn_rare6:
  s_nop 3
  v_max3_f32 v251, v16, v17, v18
  v_max3_f32 v251, v251, v19, v20
  v_max3_f32 v251, v251, v21, v22
  v_max3_f32 v251, v251, v23, v24
  v_max3_f32 v251, v251, v25, v26
  v_max3_f32 v251, v251, v27, v28
  v_max3_f32 v251, v251, v29, v30
  v_max_f32 v251, v251, v31
  v_mov_b32 v14, v251
  s_nop 1
  v_permlane32_swap_b32 v251, v14
  v_max3_f32 v251, v251, v14, 0
  v_sub_f32 v16, v16, v251
  v_sub_f32 v17, v17, v251
  v_sub_f32 v18, v18, v251
  v_sub_f32 v19, v19, v251
  v_sub_f32 v20, v20, v251
  v_sub_f32 v21, v21, v251
  v_sub_f32 v22, v22, v251
  v_sub_f32 v23, v23, v251
  v_sub_f32 v24, v24, v251
  v_sub_f32 v25, v25, v251
  v_sub_f32 v26, v26, v251
  v_sub_f32 v27, v27, v251
  v_sub_f32 v28, v28, v251
  v_sub_f32 v29, v29, v251
  v_sub_f32 v30, v30, v251
  v_sub_f32 v31, v31, v251
  v_sub_f32 v176, v176, v251
  v_sub_f32 v177, v177, v251
  v_sub_f32 v178, v178, v251
  v_sub_f32 v179, v179, v251
  v_sub_f32 v180, v180, v251
  v_sub_f32 v181, v181, v251
  v_sub_f32 v182, v182, v251
  v_sub_f32 v183, v183, v251
  v_sub_f32 v184, v184, v251
  v_sub_f32 v185, v185, v251
  v_sub_f32 v186, v186, v251
  v_sub_f32 v187, v187, v251
  v_sub_f32 v188, v188, v251
  v_sub_f32 v189, v189, v251
  v_sub_f32 v190, v190, v251
  v_sub_f32 v191, v191, v251
  v_add_f32 v240, v240, v251
  v_sub_f32 v14, 0, v251
  v_exp_f32 v243, v14
  s_nop 0
  v_mul_f32 v246, v246, v243
  v_max3_f32 v251, v32, v33, v34
  v_max3_f32 v251, v251, v35, v36
  v_max3_f32 v251, v251, v37, v38
  v_max3_f32 v251, v251, v39, v40
  v_max3_f32 v251, v251, v41, v42
  v_max3_f32 v251, v251, v43, v44
  v_max3_f32 v251, v251, v45, v46
  v_max_f32 v251, v251, v47
  v_mov_b32 v14, v251
  s_nop 1
  v_permlane32_swap_b32 v251, v14
  v_max3_f32 v251, v251, v14, 0
  v_sub_f32 v32, v32, v251
  v_sub_f32 v33, v33, v251
  v_sub_f32 v34, v34, v251
  v_sub_f32 v35, v35, v251
  v_sub_f32 v36, v36, v251
  v_sub_f32 v37, v37, v251
  v_sub_f32 v38, v38, v251
  v_sub_f32 v39, v39, v251
  v_sub_f32 v40, v40, v251
  v_sub_f32 v41, v41, v251
  v_sub_f32 v42, v42, v251
  v_sub_f32 v43, v43, v251
  v_sub_f32 v44, v44, v251
  v_sub_f32 v45, v45, v251
  v_sub_f32 v46, v46, v251
  v_sub_f32 v47, v47, v251
  v_sub_f32 v192, v192, v251
  v_sub_f32 v193, v193, v251
  v_sub_f32 v194, v194, v251
  v_sub_f32 v195, v195, v251
  v_sub_f32 v196, v196, v251
  v_sub_f32 v197, v197, v251
  v_sub_f32 v198, v198, v251
  v_sub_f32 v199, v199, v251
  v_sub_f32 v200, v200, v251
  v_sub_f32 v201, v201, v251
  v_sub_f32 v202, v202, v251
  v_sub_f32 v203, v203, v251
  v_sub_f32 v204, v204, v251
  v_sub_f32 v205, v205, v251
  v_sub_f32 v206, v206, v251
  v_sub_f32 v207, v207, v251
  v_add_f32 v241, v241, v251
  v_sub_f32 v14, 0, v251
  v_exp_f32 v244, v14
  s_nop 0
  v_mul_f32 v247, v247, v244
  v_max3_f32 v251, v48, v49, v50
  v_max3_f32 v251, v251, v51, v52
  v_max3_f32 v251, v251, v53, v54
  v_max3_f32 v251, v251, v55, v56
  v_max3_f32 v251, v251, v57, v58
  v_max3_f32 v251, v251, v59, v60
  v_max3_f32 v251, v251, v61, v62
  v_max_f32 v251, v251, v63
  v_mov_b32 v14, v251
  s_nop 1
  v_permlane32_swap_b32 v251, v14
  v_max3_f32 v251, v251, v14, 0
  v_sub_f32 v48, v48, v251
  v_sub_f32 v49, v49, v251
  v_sub_f32 v50, v50, v251
  v_sub_f32 v51, v51, v251
  v_sub_f32 v52, v52, v251
  v_sub_f32 v53, v53, v251
  v_sub_f32 v54, v54, v251
  v_sub_f32 v55, v55, v251
  v_sub_f32 v56, v56, v251
  v_sub_f32 v57, v57, v251
  v_sub_f32 v58, v58, v251
  v_sub_f32 v59, v59, v251
  v_sub_f32 v60, v60, v251
  v_sub_f32 v61, v61, v251
  v_sub_f32 v62, v62, v251
  v_sub_f32 v63, v63, v251
  v_sub_f32 v208, v208, v251
  v_sub_f32 v209, v209, v251
  v_sub_f32 v210, v210, v251
  v_sub_f32 v211, v211, v251
  v_sub_f32 v212, v212, v251
  v_sub_f32 v213, v213, v251
  v_sub_f32 v214, v214, v251
  v_sub_f32 v215, v215, v251
  v_sub_f32 v216, v216, v251
  v_sub_f32 v217, v217, v251
  v_sub_f32 v218, v218, v251
  v_sub_f32 v219, v219, v251
  v_sub_f32 v220, v220, v251
  v_sub_f32 v221, v221, v251
  v_sub_f32 v222, v222, v251
  v_sub_f32 v223, v223, v251
  v_add_f32 v242, v242, v251
  v_sub_f32 v14, 0, v251
  v_exp_f32 v245, v14
  s_nop 0
  v_mul_f32 v248, v248, v245
  s_mov_b32 s52, 1
  s_nop 3
  s_branch L_attn_ret6
L_attn_rare7:
  s_nop 3
  v_max3_f32 v251, v64, v65, v66
  v_max3_f32 v251, v251, v67, v68
  v_max3_f32 v251, v251, v69, v70
  v_max3_f32 v251, v251, v71, v72
  v_max3_f32 v251, v251, v73, v74
  v_max3_f32 v251, v251, v75, v76
  v_max3_f32 v251, v251, v77, v78
  v_max_f32 v251, v251, v79
  v_mov_b32 v14, v251
  s_nop 1
  v_permlane32_swap_b32 v251, v14
  v_max3_f32 v251, v251, v14, 0
  v_sub_f32 v64, v64, v251
  v_sub_f32 v65, v65, v251
  v_sub_f32 v66, v66, v251
  v_sub_f32 v67, v67, v251
  v_sub_f32 v68, v68, v251
  v_sub_f32 v69, v69, v251
  v_sub_f32 v70, v70, v251
  v_sub_f32 v71, v71, v251
  v_sub_f32 v72, v72, v251
  v_sub_f32 v73, v73, v251
  v_sub_f32 v74, v74, v251
  v_sub_f32 v75, v75, v251
  v_sub_f32 v76, v76, v251
  v_sub_f32 v77, v77, v251
  v_sub_f32 v78, v78, v251
  v_sub_f32 v79, v79, v251
  v_sub_f32 v176, v176, v251
  v_sub_f32 v177, v177, v251
  v_sub_f32 v178, v178, v251
  v_sub_f32 v179, v179, v251
  v_sub_f32 v180, v180, v251
  v_sub_f32 v181, v181, v251
  v_sub_f32 v182, v182, v251
  v_sub_f32 v183, v183, v251
  v_sub_f32 v184, v184, v251
  v_sub_f32 v185, v185, v251
  v_sub_f32 v186, v186, v251
  v_sub_f32 v187, v187, v251
  v_sub_f32 v188, v188, v251
  v_sub_f32 v189, v189, v251
  v_sub_f32 v190, v190, v251
  v_sub_f32 v191, v191, v251
  v_add_f32 v240, v240, v251
  v_sub_f32 v14, 0, v251
  v_exp_f32 v243, v14
  s_nop 0
  v_mul_f32 v246, v246, v243
  v_max3_f32 v251, v80, v81, v82
  v_max3_f32 v251, v251, v83, v84
  v_max3_f32 v251, v251, v85, v86
  v_max3_f32 v251, v251, v87, v88
  v_max3_f32 v251, v251, v89, v90
  v_max3_f32 v251, v251, v91, v92
  v_max3_f32 v251, v251, v93, v94
  v_max_f32 v251, v251, v95
  v_mov_b32 v14, v251
  s_nop 1
  v_permlane32_swap_b32 v251, v14
  v_max3_f32 v251, v251, v14, 0
  v_sub_f32 v80, v80, v251
  v_sub_f32 v81, v81, v251
  v_sub_f32 v82, v82, v251
  v_sub_f32 v83, v83, v251
  v_sub_f32 v84, v84, v251
  v_sub_f32 v85, v85, v251
  v_sub_f32 v86, v86, v251
  v_sub_f32 v87, v87, v251
  v_sub_f32 v88, v88, v251
  v_sub_f32 v89, v89, v251
  v_sub_f32 v90, v90, v251
  v_sub_f32 v91, v91, v251
  v_sub_f32 v92, v92, v251
  v_sub_f32 v93, v93, v251
  v_sub_f32 v94, v94, v251
  v_sub_f32 v95, v95, v251
  v_sub_f32 v192, v192, v251
  v_sub_f32 v193, v193, v251
  v_sub_f32 v194, v194, v251
  v_sub_f32 v195, v195, v251
  v_sub_f32 v196, v196, v251
  v_sub_f32 v197, v197, v251
  v_sub_f32 v198, v198, v251
  v_sub_f32 v199, v199, v251
  v_sub_f32 v200, v200, v251
  v_sub_f32 v201, v201, v251
  v_sub_f32 v202, v202, v251
  v_sub_f32 v203, v203, v251
  v_sub_f32 v204, v204, v251
  v_sub_f32 v205, v205, v251
  v_sub_f32 v206, v206, v251
  v_sub_f32 v207, v207, v251
  v_add_f32 v241, v241, v251
  v_sub_f32 v14, 0, v251
  v_exp_f32 v244, v14
  s_nop 0
  v_mul_f32 v247, v247, v244
  v_max3_f32 v251, v96, v97, v98
  v_max3_f32 v251, v251, v99, v100
  v_max3_f32 v251, v251, v101, v102
  v_max3_f32 v251, v251, v103, v104
  v_max3_f32 v251, v251, v105, v106
  v_max3_f32 v251, v251, v107, v108
  v_max3_f32 v251, v251, v109, v110
  v_max_f32 v251, v251, v111
  v_mov_b32 v14, v251
  s_nop 1
  v_permlane32_swap_b32 v251, v14
  v_max3_f32 v251, v251, v14, 0
  v_sub_f32 v96, v96, v251
  v_sub_f32 v97, v97, v251
  v_sub_f32 v98, v98, v251
  v_sub_f32 v99, v99, v251
  v_sub_f32 v100, v100, v251
  v_sub_f32 v101, v101, v251
  v_sub_f32 v102, v102, v251
  v_sub_f32 v103, v103, v251
  v_sub_f32 v104, v104, v251
  v_sub_f32 v105, v105, v251
  v_sub_f32 v106, v106, v251
  v_sub_f32 v107, v107, v251
  v_sub_f32 v108, v108, v251
  v_sub_f32 v109, v109, v251
  v_sub_f32 v110, v110, v251
  v_sub_f32 v111, v111, v251
  v_sub_f32 v208, v208, v251
  v_sub_f32 v209, v209, v251
  v_sub_f32 v210, v210, v251
  v_sub_f32 v211, v211, v251
  v_sub_f32 v212, v212, v251
  v_sub_f32 v213, v213, v251
  v_sub_f32 v214, v214, v251
  v_sub_f32 v215, v215, v251
  v_sub_f32 v216, v216, v251
  v_sub_f32 v217, v217, v251
  v_sub_f32 v218, v218, v251
  v_sub_f32 v219, v219, v251
  v_sub_f32 v220, v220, v251
  v_sub_f32 v221, v221, v251
  v_sub_f32 v222, v222, v251
  v_sub_f32 v223, v223, v251
  v_add_f32 v242, v242, v251
  v_sub_f32 v14, 0, v251
  v_exp_f32 v245, v14
  s_nop 0
  v_mul_f32 v248, v248, v245
  s_mov_b32 s52, 1
  s_nop 3
  s_branch L_attn_ret7
L_attn_rs1:
  s_nop 15
  v_accvgpr_read_b32 v249, a0
  v_accvgpr_read_b32 v250, a1
  v_accvgpr_read_b32 v251, a2
  v_accvgpr_read_b32 v14, a3
  v_mul_f32 v249, v249, v243
  v_mul_f32 v250, v250, v243
  v_mul_f32 v251, v251, v243
  v_mul_f32 v14, v14, v243
  v_accvgpr_write_b32 a0, v249
  v_accvgpr_write_b32 a1, v250
  v_accvgpr_write_b32 a2, v251
  v_accvgpr_write_b32 a3, v14
  v_accvgpr_read_b32 v249, a4
  v_accvgpr_read_b32 v250, a5
  v_accvgpr_read_b32 v251, a6
  v_accvgpr_read_b32 v14, a7
  v_mul_f32 v249, v249, v243
  v_mul_f32 v250, v250, v243
  v_mul_f32 v251, v251, v243
  v_mul_f32 v14, v14, v243
  v_accvgpr_write_b32 a4, v249
  v_accvgpr_write_b32 a5, v250
  v_accvgpr_write_b32 a6, v251
  v_accvgpr_write_b32 a7, v14
  v_accvgpr_read_b32 v249, a8
  v_accvgpr_read_b32 v250, a9
  v_accvgpr_read_b32 v251, a10
  v_accvgpr_read_b32 v14, a11
  v_mul_f32 v249, v249, v243
  v_mul_f32 v250, v250, v243
  v_mul_f32 v251, v251, v243
  v_mul_f32 v14, v14, v243
  v_accvgpr_write_b32 a8, v249
  v_accvgpr_write_b32 a9, v250
  v_accvgpr_write_b32 a10, v251
  v_accvgpr_write_b32 a11, v14
  v_accvgpr_read_b32 v249, a12
  v_accvgpr_read_b32 v250, a13
  v_accvgpr_read_b32 v251, a14
  v_accvgpr_read_b32 v14, a15
  v_mul_f32 v249, v249, v243
  v_mul_f32 v250, v250, v243
  v_mul_f32 v251, v251, v243
  v_mul_f32 v14, v14, v243
  v_accvgpr_write_b32 a12, v249
  v_accvgpr_write_b32 a13, v250
  v_accvgpr_write_b32 a14, v251
  v_accvgpr_write_b32 a15, v14
  v_accvgpr_read_b32 v249, a16
  v_accvgpr_read_b32 v250, a17
  v_accvgpr_read_b32 v251, a18
  v_accvgpr_read_b32 v14, a19
  v_mul_f32 v249, v249, v243
  v_mul_f32 v250, v250, v243
  v_mul_f32 v251, v251, v243
  v_mul_f32 v14, v14, v243
  v_accvgpr_write_b32 a16, v249
  v_accvgpr_write_b32 a17, v250
  v_accvgpr_write_b32 a18, v251
  v_accvgpr_write_b32 a19, v14
  v_accvgpr_read_b32 v249, a20
  v_accvgpr_read_b32 v250, a21
  v_accvgpr_read_b32 v251, a22
  v_accvgpr_read_b32 v14, a23
  v_mul_f32 v249, v249, v243
  v_mul_f32 v250, v250, v243
  v_mul_f32 v251, v251, v243
  v_mul_f32 v14, v14, v243
  v_accvgpr_write_b32 a20, v249
  v_accvgpr_write_b32 a21, v250
  v_accvgpr_write_b32 a22, v251
  v_accvgpr_write_b32 a23, v14
  v_accvgpr_read_b32 v249, a24
  v_accvgpr_read_b32 v250, a25
  v_accvgpr_read_b32 v251, a26
  v_accvgpr_read_b32 v14, a27
  v_mul_f32 v249, v249, v243
  v_mul_f32 v250, v250, v243
  v_mul_f32 v251, v251, v243
  v_mul_f32 v14, v14, v243
  v_accvgpr_write_b32 a24, v249
  v_accvgpr_write_b32 a25, v250
  v_accvgpr_write_b32 a26, v251
  v_accvgpr_write_b32 a27, v14
  v_accvgpr_read_b32 v249, a28
  v_accvgpr_read_b32 v250, a29
  v_accvgpr_read_b32 v251, a30
  v_accvgpr_read_b32 v14, a31
  v_mul_f32 v249, v249, v243
  v_mul_f32 v250, v250, v243
  v_mul_f32 v251, v251, v243
  v_mul_f32 v14, v14, v243
  v_accvgpr_write_b32 a28, v249
  v_accvgpr_write_b32 a29, v250
  v_accvgpr_write_b32 a30, v251
  v_accvgpr_write_b32 a31, v14
  v_accvgpr_read_b32 v249, a32
  v_accvgpr_read_b32 v250, a33
  v_accvgpr_read_b32 v251, a34
  v_accvgpr_read_b32 v14, a35
  v_mul_f32 v249, v249, v243
  v_mul_f32 v250, v250, v243
  v_mul_f32 v251, v251, v243
  v_mul_f32 v14, v14, v243
  v_accvgpr_write_b32 a32, v249
  v_accvgpr_write_b32 a33, v250
  v_accvgpr_write_b32 a34, v251
  v_accvgpr_write_b32 a35, v14
  v_accvgpr_read_b32 v249, a36
  v_accvgpr_read_b32 v250, a37
  v_accvgpr_read_b32 v251, a38
  v_accvgpr_read_b32 v14, a39
  v_mul_f32 v249, v249, v243
  v_mul_f32 v250, v250, v243
  v_mul_f32 v251, v251, v243
  v_mul_f32 v14, v14, v243
  v_accvgpr_write_b32 a36, v249
  v_accvgpr_write_b32 a37, v250
  v_accvgpr_write_b32 a38, v251
  v_accvgpr_write_b32 a39, v14
  v_accvgpr_read_b32 v249, a40
  v_accvgpr_read_b32 v250, a41
  v_accvgpr_read_b32 v251, a42
  v_accvgpr_read_b32 v14, a43
  v_mul_f32 v249, v249, v243
  v_mul_f32 v250, v250, v243
  v_mul_f32 v251, v251, v243
  v_mul_f32 v14, v14, v243
  v_accvgpr_write_b32 a40, v249
  v_accvgpr_write_b32 a41, v250
  v_accvgpr_write_b32 a42, v251
  v_accvgpr_write_b32 a43, v14
  v_accvgpr_read_b32 v249, a44
  v_accvgpr_read_b32 v250, a45
  v_accvgpr_read_b32 v251, a46
  v_accvgpr_read_b32 v14, a47
  v_mul_f32 v249, v249, v243
  v_mul_f32 v250, v250, v243
  v_mul_f32 v251, v251, v243
  v_mul_f32 v14, v14, v243
  v_accvgpr_write_b32 a44, v249
  v_accvgpr_write_b32 a45, v250
  v_accvgpr_write_b32 a46, v251
  v_accvgpr_write_b32 a47, v14
  v_accvgpr_read_b32 v249, a48
  v_accvgpr_read_b32 v250, a49
  v_accvgpr_read_b32 v251, a50
  v_accvgpr_read_b32 v14, a51
  v_mul_f32 v249, v249, v243
  v_mul_f32 v250, v250, v243
  v_mul_f32 v251, v251, v243
  v_mul_f32 v14, v14, v243
  v_accvgpr_write_b32 a48, v249
  v_accvgpr_write_b32 a49, v250
  v_accvgpr_write_b32 a50, v251
  v_accvgpr_write_b32 a51, v14
  v_accvgpr_read_b32 v249, a52
  v_accvgpr_read_b32 v250, a53
  v_accvgpr_read_b32 v251, a54
  v_accvgpr_read_b32 v14, a55
  v_mul_f32 v249, v249, v243
  v_mul_f32 v250, v250, v243
  v_mul_f32 v251, v251, v243
  v_mul_f32 v14, v14, v243
  v_accvgpr_write_b32 a52, v249
  v_accvgpr_write_b32 a53, v250
  v_accvgpr_write_b32 a54, v251
  v_accvgpr_write_b32 a55, v14
  v_accvgpr_read_b32 v249, a56
  v_accvgpr_read_b32 v250, a57
  v_accvgpr_read_b32 v251, a58
  v_accvgpr_read_b32 v14, a59
  v_mul_f32 v249, v249, v243
  v_mul_f32 v250, v250, v243
  v_mul_f32 v251, v251, v243
  v_mul_f32 v14, v14, v243
  v_accvgpr_write_b32 a56, v249
  v_accvgpr_write_b32 a57, v250
  v_accvgpr_write_b32 a58, v251
  v_accvgpr_write_b32 a59, v14
  v_accvgpr_read_b32 v249, a60
  v_accvgpr_read_b32 v250, a61
  v_accvgpr_read_b32 v251, a62
  v_accvgpr_read_b32 v14, a63
  v_mul_f32 v249, v249, v243
  v_mul_f32 v250, v250, v243
  v_mul_f32 v251, v251, v243
  v_mul_f32 v14, v14, v243
  v_accvgpr_write_b32 a60, v249
  v_accvgpr_write_b32 a61, v250
  v_accvgpr_write_b32 a62, v251
  v_accvgpr_write_b32 a63, v14
  v_accvgpr_read_b32 v249, a64
  v_accvgpr_read_b32 v250, a65
  v_accvgpr_read_b32 v251, a66
  v_accvgpr_read_b32 v14, a67
  v_mul_f32 v249, v249, v244
  v_mul_f32 v250, v250, v244
  v_mul_f32 v251, v251, v244
  v_mul_f32 v14, v14, v244
  v_accvgpr_write_b32 a64, v249
  v_accvgpr_write_b32 a65, v250
  v_accvgpr_write_b32 a66, v251
  v_accvgpr_write_b32 a67, v14
  v_accvgpr_read_b32 v249, a68
  v_accvgpr_read_b32 v250, a69
  v_accvgpr_read_b32 v251, a70
  v_accvgpr_read_b32 v14, a71
  v_mul_f32 v249, v249, v244
  v_mul_f32 v250, v250, v244
  v_mul_f32 v251, v251, v244
  v_mul_f32 v14, v14, v244
  v_accvgpr_write_b32 a68, v249
  v_accvgpr_write_b32 a69, v250
  v_accvgpr_write_b32 a70, v251
  v_accvgpr_write_b32 a71, v14
  v_accvgpr_read_b32 v249, a72
  v_accvgpr_read_b32 v250, a73
  v_accvgpr_read_b32 v251, a74
  v_accvgpr_read_b32 v14, a75
  v_mul_f32 v249, v249, v244
  v_mul_f32 v250, v250, v244
  v_mul_f32 v251, v251, v244
  v_mul_f32 v14, v14, v244
  v_accvgpr_write_b32 a72, v249
  v_accvgpr_write_b32 a73, v250
  v_accvgpr_write_b32 a74, v251
  v_accvgpr_write_b32 a75, v14
  v_accvgpr_read_b32 v249, a76
  v_accvgpr_read_b32 v250, a77
  v_accvgpr_read_b32 v251, a78
  v_accvgpr_read_b32 v14, a79
  v_mul_f32 v249, v249, v244
  v_mul_f32 v250, v250, v244
  v_mul_f32 v251, v251, v244
  v_mul_f32 v14, v14, v244
  v_accvgpr_write_b32 a76, v249
  v_accvgpr_write_b32 a77, v250
  v_accvgpr_write_b32 a78, v251
  v_accvgpr_write_b32 a79, v14
  v_accvgpr_read_b32 v249, a80
  v_accvgpr_read_b32 v250, a81
  v_accvgpr_read_b32 v251, a82
  v_accvgpr_read_b32 v14, a83
  v_mul_f32 v249, v249, v244
  v_mul_f32 v250, v250, v244
  v_mul_f32 v251, v251, v244
  v_mul_f32 v14, v14, v244
  v_accvgpr_write_b32 a80, v249
  v_accvgpr_write_b32 a81, v250
  v_accvgpr_write_b32 a82, v251
  v_accvgpr_write_b32 a83, v14
  v_accvgpr_read_b32 v249, a84
  v_accvgpr_read_b32 v250, a85
  v_accvgpr_read_b32 v251, a86
  v_accvgpr_read_b32 v14, a87
  v_mul_f32 v249, v249, v244
  v_mul_f32 v250, v250, v244
  v_mul_f32 v251, v251, v244
  v_mul_f32 v14, v14, v244
  v_accvgpr_write_b32 a84, v249
  v_accvgpr_write_b32 a85, v250
  v_accvgpr_write_b32 a86, v251
  v_accvgpr_write_b32 a87, v14
  v_accvgpr_read_b32 v249, a88
  v_accvgpr_read_b32 v250, a89
  v_accvgpr_read_b32 v251, a90
  v_accvgpr_read_b32 v14, a91
  v_mul_f32 v249, v249, v244
  v_mul_f32 v250, v250, v244
  v_mul_f32 v251, v251, v244
  v_mul_f32 v14, v14, v244
  v_accvgpr_write_b32 a88, v249
  v_accvgpr_write_b32 a89, v250
  v_accvgpr_write_b32 a90, v251
  v_accvgpr_write_b32 a91, v14
  v_accvgpr_read_b32 v249, a92
  v_accvgpr_read_b32 v250, a93
  v_accvgpr_read_b32 v251, a94
  v_accvgpr_read_b32 v14, a95
  v_mul_f32 v249, v249, v244
  v_mul_f32 v250, v250, v244
  v_mul_f32 v251, v251, v244
  v_mul_f32 v14, v14, v244
  v_accvgpr_write_b32 a92, v249
  v_accvgpr_write_b32 a93, v250
  v_accvgpr_write_b32 a94, v251
  v_accvgpr_write_b32 a95, v14
  v_accvgpr_read_b32 v249, a96
  v_accvgpr_read_b32 v250, a97
  v_accvgpr_read_b32 v251, a98
  v_accvgpr_read_b32 v14, a99
  v_mul_f32 v249, v249, v244
  v_mul_f32 v250, v250, v244
  v_mul_f32 v251, v251, v244
  v_mul_f32 v14, v14, v244
  v_accvgpr_write_b32 a96, v249
  v_accvgpr_write_b32 a97, v250
  v_accvgpr_write_b32 a98, v251
  v_accvgpr_write_b32 a99, v14
  v_accvgpr_read_b32 v249, a100
  v_accvgpr_read_b32 v250, a101
  v_accvgpr_read_b32 v251, a102
  v_accvgpr_read_b32 v14, a103
  v_mul_f32 v249, v249, v244
  v_mul_f32 v250, v250, v244
  v_mul_f32 v251, v251, v244
  v_mul_f32 v14, v14, v244
  v_accvgpr_write_b32 a100, v249
  v_accvgpr_write_b32 a101, v250
  v_accvgpr_write_b32 a102, v251
  v_accvgpr_write_b32 a103, v14
  v_accvgpr_read_b32 v249, a104
  v_accvgpr_read_b32 v250, a105
  v_accvgpr_read_b32 v251, a106
  v_accvgpr_read_b32 v14, a107
  v_mul_f32 v249, v249, v244
  v_mul_f32 v250, v250, v244
  v_mul_f32 v251, v251, v244
  v_mul_f32 v14, v14, v244
  v_accvgpr_write_b32 a104, v249
  v_accvgpr_write_b32 a105, v250
  v_accvgpr_write_b32 a106, v251
  v_accvgpr_write_b32 a107, v14
  v_accvgpr_read_b32 v249, a108
  v_accvgpr_read_b32 v250, a109
  v_accvgpr_read_b32 v251, a110
  v_accvgpr_read_b32 v14, a111
  v_mul_f32 v249, v249, v244
  v_mul_f32 v250, v250, v244
  v_mul_f32 v251, v251, v244
  v_mul_f32 v14, v14, v244
  v_accvgpr_write_b32 a108, v249
  v_accvgpr_write_b32 a109, v250
  v_accvgpr_write_b32 a110, v251
  v_accvgpr_write_b32 a111, v14
  v_accvgpr_read_b32 v249, a112
  v_accvgpr_read_b32 v250, a113
  v_accvgpr_read_b32 v251, a114
  v_accvgpr_read_b32 v14, a115
  v_mul_f32 v249, v249, v244
  v_mul_f32 v250, v250, v244
  v_mul_f32 v251, v251, v244
  v_mul_f32 v14, v14, v244
  v_accvgpr_write_b32 a112, v249
  v_accvgpr_write_b32 a113, v250
  v_accvgpr_write_b32 a114, v251
  v_accvgpr_write_b32 a115, v14
  v_accvgpr_read_b32 v249, a116
  v_accvgpr_read_b32 v250, a117
  v_accvgpr_read_b32 v251, a118
  v_accvgpr_read_b32 v14, a119
  v_mul_f32 v249, v249, v244
  v_mul_f32 v250, v250, v244
  v_mul_f32 v251, v251, v244
  v_mul_f32 v14, v14, v244
  v_accvgpr_write_b32 a116, v249
  v_accvgpr_write_b32 a117, v250
  v_accvgpr_write_b32 a118, v251
  v_accvgpr_write_b32 a119, v14
  v_accvgpr_read_b32 v249, a120
  v_accvgpr_read_b32 v250, a121
  v_accvgpr_read_b32 v251, a122
  v_accvgpr_read_b32 v14, a123
  v_mul_f32 v249, v249, v244
  v_mul_f32 v250, v250, v244
  v_mul_f32 v251, v251, v244
  v_mul_f32 v14, v14, v244
  v_accvgpr_write_b32 a120, v249
  v_accvgpr_write_b32 a121, v250
  v_accvgpr_write_b32 a122, v251
  v_accvgpr_write_b32 a123, v14
  v_accvgpr_read_b32 v249, a124
  v_accvgpr_read_b32 v250, a125
  v_accvgpr_read_b32 v251, a126
  v_accvgpr_read_b32 v14, a127
  v_mul_f32 v249, v249, v244
  v_mul_f32 v250, v250, v244
  v_mul_f32 v251, v251, v244
  v_mul_f32 v14, v14, v244
  v_accvgpr_write_b32 a124, v249
  v_accvgpr_write_b32 a125, v250
  v_accvgpr_write_b32 a126, v251
  v_accvgpr_write_b32 a127, v14
  v_accvgpr_read_b32 v249, a128
  v_accvgpr_read_b32 v250, a129
  v_accvgpr_read_b32 v251, a130
  v_accvgpr_read_b32 v14, a131
  v_mul_f32 v249, v249, v245
  v_mul_f32 v250, v250, v245
  v_mul_f32 v251, v251, v245
  v_mul_f32 v14, v14, v245
  v_accvgpr_write_b32 a128, v249
  v_accvgpr_write_b32 a129, v250
  v_accvgpr_write_b32 a130, v251
  v_accvgpr_write_b32 a131, v14
  v_accvgpr_read_b32 v249, a132
  v_accvgpr_read_b32 v250, a133
  v_accvgpr_read_b32 v251, a134
  v_accvgpr_read_b32 v14, a135
  v_mul_f32 v249, v249, v245
  v_mul_f32 v250, v250, v245
  v_mul_f32 v251, v251, v245
  v_mul_f32 v14, v14, v245
  v_accvgpr_write_b32 a132, v249
  v_accvgpr_write_b32 a133, v250
  v_accvgpr_write_b32 a134, v251
  v_accvgpr_write_b32 a135, v14
  v_accvgpr_read_b32 v249, a136
  v_accvgpr_read_b32 v250, a137
  v_accvgpr_read_b32 v251, a138
  v_accvgpr_read_b32 v14, a139
  v_mul_f32 v249, v249, v245
  v_mul_f32 v250, v250, v245
  v_mul_f32 v251, v251, v245
  v_mul_f32 v14, v14, v245
  v_accvgpr_write_b32 a136, v249
  v_accvgpr_write_b32 a137, v250
  v_accvgpr_write_b32 a138, v251
  v_accvgpr_write_b32 a139, v14
  v_accvgpr_read_b32 v249, a140
  v_accvgpr_read_b32 v250, a141
  v_accvgpr_read_b32 v251, a142
  v_accvgpr_read_b32 v14, a143
  v_mul_f32 v249, v249, v245
  v_mul_f32 v250, v250, v245
  v_mul_f32 v251, v251, v245
  v_mul_f32 v14, v14, v245
  v_accvgpr_write_b32 a140, v249
  v_accvgpr_write_b32 a141, v250
  v_accvgpr_write_b32 a142, v251
  v_accvgpr_write_b32 a143, v14
  v_accvgpr_read_b32 v249, a144
  v_accvgpr_read_b32 v250, a145
  v_accvgpr_read_b32 v251, a146
  v_accvgpr_read_b32 v14, a147
  v_mul_f32 v249, v249, v245
  v_mul_f32 v250, v250, v245
  v_mul_f32 v251, v251, v245
  v_mul_f32 v14, v14, v245
  v_accvgpr_write_b32 a144, v249
  v_accvgpr_write_b32 a145, v250
  v_accvgpr_write_b32 a146, v251
  v_accvgpr_write_b32 a147, v14
  v_accvgpr_read_b32 v249, a148
  v_accvgpr_read_b32 v250, a149
  v_accvgpr_read_b32 v251, a150
  v_accvgpr_read_b32 v14, a151
  v_mul_f32 v249, v249, v245
  v_mul_f32 v250, v250, v245
  v_mul_f32 v251, v251, v245
  v_mul_f32 v14, v14, v245
  v_accvgpr_write_b32 a148, v249
  v_accvgpr_write_b32 a149, v250
  v_accvgpr_write_b32 a150, v251
  v_accvgpr_write_b32 a151, v14
  v_accvgpr_read_b32 v249, a152
  v_accvgpr_read_b32 v250, a153
  v_accvgpr_read_b32 v251, a154
  v_accvgpr_read_b32 v14, a155
  v_mul_f32 v249, v249, v245
  v_mul_f32 v250, v250, v245
  v_mul_f32 v251, v251, v245
  v_mul_f32 v14, v14, v245
  v_accvgpr_write_b32 a152, v249
  v_accvgpr_write_b32 a153, v250
  v_accvgpr_write_b32 a154, v251
  v_accvgpr_write_b32 a155, v14
  v_accvgpr_read_b32 v249, a156
  v_accvgpr_read_b32 v250, a157
  v_accvgpr_read_b32 v251, a158
  v_accvgpr_read_b32 v14, a159
  v_mul_f32 v249, v249, v245
  v_mul_f32 v250, v250, v245
  v_mul_f32 v251, v251, v245
  v_mul_f32 v14, v14, v245
  v_accvgpr_write_b32 a156, v249
  v_accvgpr_write_b32 a157, v250
  v_accvgpr_write_b32 a158, v251
  v_accvgpr_write_b32 a159, v14
  v_accvgpr_read_b32 v249, a160
  v_accvgpr_read_b32 v250, a161
  v_accvgpr_read_b32 v251, a162
  v_accvgpr_read_b32 v14, a163
  v_mul_f32 v249, v249, v245
  v_mul_f32 v250, v250, v245
  v_mul_f32 v251, v251, v245
  v_mul_f32 v14, v14, v245
  v_accvgpr_write_b32 a160, v249
  v_accvgpr_write_b32 a161, v250
  v_accvgpr_write_b32 a162, v251
  v_accvgpr_write_b32 a163, v14
  v_accvgpr_read_b32 v249, a164
  v_accvgpr_read_b32 v250, a165
  v_accvgpr_read_b32 v251, a166
  v_accvgpr_read_b32 v14, a167
  v_mul_f32 v249, v249, v245
  v_mul_f32 v250, v250, v245
  v_mul_f32 v251, v251, v245
  v_mul_f32 v14, v14, v245
  v_accvgpr_write_b32 a164, v249
  v_accvgpr_write_b32 a165, v250
  v_accvgpr_write_b32 a166, v251
  v_accvgpr_write_b32 a167, v14
  v_accvgpr_read_b32 v249, a168
  v_accvgpr_read_b32 v250, a169
  v_accvgpr_read_b32 v251, a170
  v_accvgpr_read_b32 v14, a171
  v_mul_f32 v249, v249, v245
  v_mul_f32 v250, v250, v245
  v_mul_f32 v251, v251, v245
  v_mul_f32 v14, v14, v245
  v_accvgpr_write_b32 a168, v249
  v_accvgpr_write_b32 a169, v250
  v_accvgpr_write_b32 a170, v251
  v_accvgpr_write_b32 a171, v14
  v_accvgpr_read_b32 v249, a172
  v_accvgpr_read_b32 v250, a173
  v_accvgpr_read_b32 v251, a174
  v_accvgpr_read_b32 v14, a175
  v_mul_f32 v249, v249, v245
  v_mul_f32 v250, v250, v245
  v_mul_f32 v251, v251, v245
  v_mul_f32 v14, v14, v245
  v_accvgpr_write_b32 a172, v249
  v_accvgpr_write_b32 a173, v250
  v_accvgpr_write_b32 a174, v251
  v_accvgpr_write_b32 a175, v14
  v_accvgpr_read_b32 v249, a176
  v_accvgpr_read_b32 v250, a177
  v_accvgpr_read_b32 v251, a178
  v_accvgpr_read_b32 v14, a179
  v_mul_f32 v249, v249, v245
  v_mul_f32 v250, v250, v245
  v_mul_f32 v251, v251, v245
  v_mul_f32 v14, v14, v245
  v_accvgpr_write_b32 a176, v249
  v_accvgpr_write_b32 a177, v250
  v_accvgpr_write_b32 a178, v251
  v_accvgpr_write_b32 a179, v14
  v_accvgpr_read_b32 v249, a180
  v_accvgpr_read_b32 v250, a181
  v_accvgpr_read_b32 v251, a182
  v_accvgpr_read_b32 v14, a183
  v_mul_f32 v249, v249, v245
  v_mul_f32 v250, v250, v245
  v_mul_f32 v251, v251, v245
  v_mul_f32 v14, v14, v245
  v_accvgpr_write_b32 a180, v249
  v_accvgpr_write_b32 a181, v250
  v_accvgpr_write_b32 a182, v251
  v_accvgpr_write_b32 a183, v14
  v_accvgpr_read_b32 v249, a184
  v_accvgpr_read_b32 v250, a185
  v_accvgpr_read_b32 v251, a186
  v_accvgpr_read_b32 v14, a187
  v_mul_f32 v249, v249, v245
  v_mul_f32 v250, v250, v245
  v_mul_f32 v251, v251, v245
  v_mul_f32 v14, v14, v245
  v_accvgpr_write_b32 a184, v249
  v_accvgpr_write_b32 a185, v250
  v_accvgpr_write_b32 a186, v251
  v_accvgpr_write_b32 a187, v14
  v_accvgpr_read_b32 v249, a188
  v_accvgpr_read_b32 v250, a189
  v_accvgpr_read_b32 v251, a190
  v_accvgpr_read_b32 v14, a191
  v_mul_f32 v249, v249, v245
  v_mul_f32 v250, v250, v245
  v_mul_f32 v251, v251, v245
  v_mul_f32 v14, v14, v245
  v_accvgpr_write_b32 a188, v249
  v_accvgpr_write_b32 a189, v250
  v_accvgpr_write_b32 a190, v251
  v_accvgpr_write_b32 a191, v14
  s_mov_b32 s52, 0
  s_nop 3
  s_branch L_attn_rsret1
L_attn_rs2:
  s_nop 15
  v_accvgpr_read_b32 v249, a0
  v_accvgpr_read_b32 v250, a1
  v_accvgpr_read_b32 v251, a2
  v_accvgpr_read_b32 v14, a3
  v_mul_f32 v249, v249, v243
  v_mul_f32 v250, v250, v243
  v_mul_f32 v251, v251, v243
  v_mul_f32 v14, v14, v243
  v_accvgpr_write_b32 a0, v249
  v_accvgpr_write_b32 a1, v250
  v_accvgpr_write_b32 a2, v251
  v_accvgpr_write_b32 a3, v14
  v_accvgpr_read_b32 v249, a4
  v_accvgpr_read_b32 v250, a5
  v_accvgpr_read_b32 v251, a6
  v_accvgpr_read_b32 v14, a7
  v_mul_f32 v249, v249, v243
  v_mul_f32 v250, v250, v243
  v_mul_f32 v251, v251, v243
  v_mul_f32 v14, v14, v243
  v_accvgpr_write_b32 a4, v249
  v_accvgpr_write_b32 a5, v250
  v_accvgpr_write_b32 a6, v251
  v_accvgpr_write_b32 a7, v14
  v_accvgpr_read_b32 v249, a8
  v_accvgpr_read_b32 v250, a9
  v_accvgpr_read_b32 v251, a10
  v_accvgpr_read_b32 v14, a11
  v_mul_f32 v249, v249, v243
  v_mul_f32 v250, v250, v243
  v_mul_f32 v251, v251, v243
  v_mul_f32 v14, v14, v243
  v_accvgpr_write_b32 a8, v249
  v_accvgpr_write_b32 a9, v250
  v_accvgpr_write_b32 a10, v251
  v_accvgpr_write_b32 a11, v14
  v_accvgpr_read_b32 v249, a12
  v_accvgpr_read_b32 v250, a13
  v_accvgpr_read_b32 v251, a14
  v_accvgpr_read_b32 v14, a15
  v_mul_f32 v249, v249, v243
  v_mul_f32 v250, v250, v243
  v_mul_f32 v251, v251, v243
  v_mul_f32 v14, v14, v243
  v_accvgpr_write_b32 a12, v249
  v_accvgpr_write_b32 a13, v250
  v_accvgpr_write_b32 a14, v251
  v_accvgpr_write_b32 a15, v14
  v_accvgpr_read_b32 v249, a16
  v_accvgpr_read_b32 v250, a17
  v_accvgpr_read_b32 v251, a18
  v_accvgpr_read_b32 v14, a19
  v_mul_f32 v249, v249, v243
  v_mul_f32 v250, v250, v243
  v_mul_f32 v251, v251, v243
  v_mul_f32 v14, v14, v243
  v_accvgpr_write_b32 a16, v249
  v_accvgpr_write_b32 a17, v250
  v_accvgpr_write_b32 a18, v251
  v_accvgpr_write_b32 a19, v14
  v_accvgpr_read_b32 v249, a20
  v_accvgpr_read_b32 v250, a21
  v_accvgpr_read_b32 v251, a22
  v_accvgpr_read_b32 v14, a23
  v_mul_f32 v249, v249, v243
  v_mul_f32 v250, v250, v243
  v_mul_f32 v251, v251, v243
  v_mul_f32 v14, v14, v243
  v_accvgpr_write_b32 a20, v249
  v_accvgpr_write_b32 a21, v250
  v_accvgpr_write_b32 a22, v251
  v_accvgpr_write_b32 a23, v14
  v_accvgpr_read_b32 v249, a24
  v_accvgpr_read_b32 v250, a25
  v_accvgpr_read_b32 v251, a26
  v_accvgpr_read_b32 v14, a27
  v_mul_f32 v249, v249, v243
  v_mul_f32 v250, v250, v243
  v_mul_f32 v251, v251, v243
  v_mul_f32 v14, v14, v243
  v_accvgpr_write_b32 a24, v249
  v_accvgpr_write_b32 a25, v250
  v_accvgpr_write_b32 a26, v251
  v_accvgpr_write_b32 a27, v14
  v_accvgpr_read_b32 v249, a28
  v_accvgpr_read_b32 v250, a29
  v_accvgpr_read_b32 v251, a30
  v_accvgpr_read_b32 v14, a31
  v_mul_f32 v249, v249, v243
  v_mul_f32 v250, v250, v243
  v_mul_f32 v251, v251, v243
  v_mul_f32 v14, v14, v243
  v_accvgpr_write_b32 a28, v249
  v_accvgpr_write_b32 a29, v250
  v_accvgpr_write_b32 a30, v251
  v_accvgpr_write_b32 a31, v14
  v_accvgpr_read_b32 v249, a32
  v_accvgpr_read_b32 v250, a33
  v_accvgpr_read_b32 v251, a34
  v_accvgpr_read_b32 v14, a35
  v_mul_f32 v249, v249, v243
  v_mul_f32 v250, v250, v243
  v_mul_f32 v251, v251, v243
  v_mul_f32 v14, v14, v243
  v_accvgpr_write_b32 a32, v249
  v_accvgpr_write_b32 a33, v250
  v_accvgpr_write_b32 a34, v251
  v_accvgpr_write_b32 a35, v14
  v_accvgpr_read_b32 v249, a36
  v_accvgpr_read_b32 v250, a37
  v_accvgpr_read_b32 v251, a38
  v_accvgpr_read_b32 v14, a39
  v_mul_f32 v249, v249, v243
  v_mul_f32 v250, v250, v243
  v_mul_f32 v251, v251, v243
  v_mul_f32 v14, v14, v243
  v_accvgpr_write_b32 a36, v249
  v_accvgpr_write_b32 a37, v250
  v_accvgpr_write_b32 a38, v251
  v_accvgpr_write_b32 a39, v14
  v_accvgpr_read_b32 v249, a40
  v_accvgpr_read_b32 v250, a41
  v_accvgpr_read_b32 v251, a42
  v_accvgpr_read_b32 v14, a43
  v_mul_f32 v249, v249, v243
  v_mul_f32 v250, v250, v243
  v_mul_f32 v251, v251, v243
  v_mul_f32 v14, v14, v243
  v_accvgpr_write_b32 a40, v249
  v_accvgpr_write_b32 a41, v250
  v_accvgpr_write_b32 a42, v251
  v_accvgpr_write_b32 a43, v14
  v_accvgpr_read_b32 v249, a44
  v_accvgpr_read_b32 v250, a45
  v_accvgpr_read_b32 v251, a46
  v_accvgpr_read_b32 v14, a47
  v_mul_f32 v249, v249, v243
  v_mul_f32 v250, v250, v243
  v_mul_f32 v251, v251, v243
  v_mul_f32 v14, v14, v243
  v_accvgpr_write_b32 a44, v249
  v_accvgpr_write_b32 a45, v250
  v_accvgpr_write_b32 a46, v251
  v_accvgpr_write_b32 a47, v14
  v_accvgpr_read_b32 v249, a48
  v_accvgpr_read_b32 v250, a49
  v_accvgpr_read_b32 v251, a50
  v_accvgpr_read_b32 v14, a51
  v_mul_f32 v249, v249, v243
  v_mul_f32 v250, v250, v243
  v_mul_f32 v251, v251, v243
  v_mul_f32 v14, v14, v243
  v_accvgpr_write_b32 a48, v249
  v_accvgpr_write_b32 a49, v250
  v_accvgpr_write_b32 a50, v251
  v_accvgpr_write_b32 a51, v14
  v_accvgpr_read_b32 v249, a52
  v_accvgpr_read_b32 v250, a53
  v_accvgpr_read_b32 v251, a54
  v_accvgpr_read_b32 v14, a55
  v_mul_f32 v249, v249, v243
  v_mul_f32 v250, v250, v243
  v_mul_f32 v251, v251, v243
  v_mul_f32 v14, v14, v243
  v_accvgpr_write_b32 a52, v249
  v_accvgpr_write_b32 a53, v250
  v_accvgpr_write_b32 a54, v251
  v_accvgpr_write_b32 a55, v14
  v_accvgpr_read_b32 v249, a56
  v_accvgpr_read_b32 v250, a57
  v_accvgpr_read_b32 v251, a58
  v_accvgpr_read_b32 v14, a59
  v_mul_f32 v249, v249, v243
  v_mul_f32 v250, v250, v243
  v_mul_f32 v251, v251, v243
  v_mul_f32 v14, v14, v243
  v_accvgpr_write_b32 a56, v249
  v_accvgpr_write_b32 a57, v250
  v_accvgpr_write_b32 a58, v251
  v_accvgpr_write_b32 a59, v14
  v_accvgpr_read_b32 v249, a60
  v_accvgpr_read_b32 v250, a61
  v_accvgpr_read_b32 v251, a62
  v_accvgpr_read_b32 v14, a63
  v_mul_f32 v249, v249, v243
  v_mul_f32 v250, v250, v243
  v_mul_f32 v251, v251, v243
  v_mul_f32 v14, v14, v243
  v_accvgpr_write_b32 a60, v249
  v_accvgpr_write_b32 a61, v250
  v_accvgpr_write_b32 a62, v251
  v_accvgpr_write_b32 a63, v14
  v_accvgpr_read_b32 v249, a64
  v_accvgpr_read_b32 v250, a65
  v_accvgpr_read_b32 v251, a66
  v_accvgpr_read_b32 v14, a67
  v_mul_f32 v249, v249, v244
  v_mul_f32 v250, v250, v244
  v_mul_f32 v251, v251, v244
  v_mul_f32 v14, v14, v244
  v_accvgpr_write_b32 a64, v249
  v_accvgpr_write_b32 a65, v250
  v_accvgpr_write_b32 a66, v251
  v_accvgpr_write_b32 a67, v14
  v_accvgpr_read_b32 v249, a68
  v_accvgpr_read_b32 v250, a69
  v_accvgpr_read_b32 v251, a70
  v_accvgpr_read_b32 v14, a71
  v_mul_f32 v249, v249, v244
  v_mul_f32 v250, v250, v244
  v_mul_f32 v251, v251, v244
  v_mul_f32 v14, v14, v244
  v_accvgpr_write_b32 a68, v249
  v_accvgpr_write_b32 a69, v250
  v_accvgpr_write_b32 a70, v251
  v_accvgpr_write_b32 a71, v14
  v_accvgpr_read_b32 v249, a72
  v_accvgpr_read_b32 v250, a73
  v_accvgpr_read_b32 v251, a74
  v_accvgpr_read_b32 v14, a75
  v_mul_f32 v249, v249, v244
  v_mul_f32 v250, v250, v244
  v_mul_f32 v251, v251, v244
  v_mul_f32 v14, v14, v244
  v_accvgpr_write_b32 a72, v249
  v_accvgpr_write_b32 a73, v250
  v_accvgpr_write_b32 a74, v251
  v_accvgpr_write_b32 a75, v14
  v_accvgpr_read_b32 v249, a76
  v_accvgpr_read_b32 v250, a77
  v_accvgpr_read_b32 v251, a78
  v_accvgpr_read_b32 v14, a79
  v_mul_f32 v249, v249, v244
  v_mul_f32 v250, v250, v244
  v_mul_f32 v251, v251, v244
  v_mul_f32 v14, v14, v244
  v_accvgpr_write_b32 a76, v249
  v_accvgpr_write_b32 a77, v250
  v_accvgpr_write_b32 a78, v251
  v_accvgpr_write_b32 a79, v14
  v_accvgpr_read_b32 v249, a80
  v_accvgpr_read_b32 v250, a81
  v_accvgpr_read_b32 v251, a82
  v_accvgpr_read_b32 v14, a83
  v_mul_f32 v249, v249, v244
  v_mul_f32 v250, v250, v244
  v_mul_f32 v251, v251, v244
  v_mul_f32 v14, v14, v244
  v_accvgpr_write_b32 a80, v249
  v_accvgpr_write_b32 a81, v250
  v_accvgpr_write_b32 a82, v251
  v_accvgpr_write_b32 a83, v14
  v_accvgpr_read_b32 v249, a84
  v_accvgpr_read_b32 v250, a85
  v_accvgpr_read_b32 v251, a86
  v_accvgpr_read_b32 v14, a87
  v_mul_f32 v249, v249, v244
  v_mul_f32 v250, v250, v244
  v_mul_f32 v251, v251, v244
  v_mul_f32 v14, v14, v244
  v_accvgpr_write_b32 a84, v249
  v_accvgpr_write_b32 a85, v250
  v_accvgpr_write_b32 a86, v251
  v_accvgpr_write_b32 a87, v14
  v_accvgpr_read_b32 v249, a88
  v_accvgpr_read_b32 v250, a89
  v_accvgpr_read_b32 v251, a90
  v_accvgpr_read_b32 v14, a91
  v_mul_f32 v249, v249, v244
  v_mul_f32 v250, v250, v244
  v_mul_f32 v251, v251, v244
  v_mul_f32 v14, v14, v244
  v_accvgpr_write_b32 a88, v249
  v_accvgpr_write_b32 a89, v250
  v_accvgpr_write_b32 a90, v251
  v_accvgpr_write_b32 a91, v14
  v_accvgpr_read_b32 v249, a92
  v_accvgpr_read_b32 v250, a93
  v_accvgpr_read_b32 v251, a94
  v_accvgpr_read_b32 v14, a95
  v_mul_f32 v249, v249, v244
  v_mul_f32 v250, v250, v244
  v_mul_f32 v251, v251, v244
  v_mul_f32 v14, v14, v244
  v_accvgpr_write_b32 a92, v249
  v_accvgpr_write_b32 a93, v250
  v_accvgpr_write_b32 a94, v251
  v_accvgpr_write_b32 a95, v14
  v_accvgpr_read_b32 v249, a96
  v_accvgpr_read_b32 v250, a97
  v_accvgpr_read_b32 v251, a98
  v_accvgpr_read_b32 v14, a99
  v_mul_f32 v249, v249, v244
  v_mul_f32 v250, v250, v244
  v_mul_f32 v251, v251, v244
  v_mul_f32 v14, v14, v244
  v_accvgpr_write_b32 a96, v249
  v_accvgpr_write_b32 a97, v250
  v_accvgpr_write_b32 a98, v251
  v_accvgpr_write_b32 a99, v14
  v_accvgpr_read_b32 v249, a100
  v_accvgpr_read_b32 v250, a101
  v_accvgpr_read_b32 v251, a102
  v_accvgpr_read_b32 v14, a103
  v_mul_f32 v249, v249, v244
  v_mul_f32 v250, v250, v244
  v_mul_f32 v251, v251, v244
  v_mul_f32 v14, v14, v244
  v_accvgpr_write_b32 a100, v249
  v_accvgpr_write_b32 a101, v250
  v_accvgpr_write_b32 a102, v251
  v_accvgpr_write_b32 a103, v14
  v_accvgpr_read_b32 v249, a104
  v_accvgpr_read_b32 v250, a105
  v_accvgpr_read_b32 v251, a106
  v_accvgpr_read_b32 v14, a107
  v_mul_f32 v249, v249, v244
  v_mul_f32 v250, v250, v244
  v_mul_f32 v251, v251, v244
  v_mul_f32 v14, v14, v244
  v_accvgpr_write_b32 a104, v249
  v_accvgpr_write_b32 a105, v250
  v_accvgpr_write_b32 a106, v251
  v_accvgpr_write_b32 a107, v14
  v_accvgpr_read_b32 v249, a108
  v_accvgpr_read_b32 v250, a109
  v_accvgpr_read_b32 v251, a110
  v_accvgpr_read_b32 v14, a111
  v_mul_f32 v249, v249, v244
  v_mul_f32 v250, v250, v244
  v_mul_f32 v251, v251, v244
  v_mul_f32 v14, v14, v244
  v_accvgpr_write_b32 a108, v249
  v_accvgpr_write_b32 a109, v250
  v_accvgpr_write_b32 a110, v251
  v_accvgpr_write_b32 a111, v14
  v_accvgpr_read_b32 v249, a112
  v_accvgpr_read_b32 v250, a113
  v_accvgpr_read_b32 v251, a114
  v_accvgpr_read_b32 v14, a115
  v_mul_f32 v249, v249, v244
  v_mul_f32 v250, v250, v244
  v_mul_f32 v251, v251, v244
  v_mul_f32 v14, v14, v244
  v_accvgpr_write_b32 a112, v249
  v_accvgpr_write_b32 a113, v250
  v_accvgpr_write_b32 a114, v251
  v_accvgpr_write_b32 a115, v14
  v_accvgpr_read_b32 v249, a116
  v_accvgpr_read_b32 v250, a117
  v_accvgpr_read_b32 v251, a118
  v_accvgpr_read_b32 v14, a119
  v_mul_f32 v249, v249, v244
  v_mul_f32 v250, v250, v244
  v_mul_f32 v251, v251, v244
  v_mul_f32 v14, v14, v244
  v_accvgpr_write_b32 a116, v249
  v_accvgpr_write_b32 a117, v250
  v_accvgpr_write_b32 a118, v251
  v_accvgpr_write_b32 a119, v14
  v_accvgpr_read_b32 v249, a120
  v_accvgpr_read_b32 v250, a121
  v_accvgpr_read_b32 v251, a122
  v_accvgpr_read_b32 v14, a123
  v_mul_f32 v249, v249, v244
  v_mul_f32 v250, v250, v244
  v_mul_f32 v251, v251, v244
  v_mul_f32 v14, v14, v244
  v_accvgpr_write_b32 a120, v249
  v_accvgpr_write_b32 a121, v250
  v_accvgpr_write_b32 a122, v251
  v_accvgpr_write_b32 a123, v14
  v_accvgpr_read_b32 v249, a124
  v_accvgpr_read_b32 v250, a125
  v_accvgpr_read_b32 v251, a126
  v_accvgpr_read_b32 v14, a127
  v_mul_f32 v249, v249, v244
  v_mul_f32 v250, v250, v244
  v_mul_f32 v251, v251, v244
  v_mul_f32 v14, v14, v244
  v_accvgpr_write_b32 a124, v249
  v_accvgpr_write_b32 a125, v250
  v_accvgpr_write_b32 a126, v251
  v_accvgpr_write_b32 a127, v14
  v_accvgpr_read_b32 v249, a128
  v_accvgpr_read_b32 v250, a129
  v_accvgpr_read_b32 v251, a130
  v_accvgpr_read_b32 v14, a131
  v_mul_f32 v249, v249, v245
  v_mul_f32 v250, v250, v245
  v_mul_f32 v251, v251, v245
  v_mul_f32 v14, v14, v245
  v_accvgpr_write_b32 a128, v249
  v_accvgpr_write_b32 a129, v250
  v_accvgpr_write_b32 a130, v251
  v_accvgpr_write_b32 a131, v14
  v_accvgpr_read_b32 v249, a132
  v_accvgpr_read_b32 v250, a133
  v_accvgpr_read_b32 v251, a134
  v_accvgpr_read_b32 v14, a135
  v_mul_f32 v249, v249, v245
  v_mul_f32 v250, v250, v245
  v_mul_f32 v251, v251, v245
  v_mul_f32 v14, v14, v245
  v_accvgpr_write_b32 a132, v249
  v_accvgpr_write_b32 a133, v250
  v_accvgpr_write_b32 a134, v251
  v_accvgpr_write_b32 a135, v14
  v_accvgpr_read_b32 v249, a136
  v_accvgpr_read_b32 v250, a137
  v_accvgpr_read_b32 v251, a138
  v_accvgpr_read_b32 v14, a139
  v_mul_f32 v249, v249, v245
  v_mul_f32 v250, v250, v245
  v_mul_f32 v251, v251, v245
  v_mul_f32 v14, v14, v245
  v_accvgpr_write_b32 a136, v249
  v_accvgpr_write_b32 a137, v250
  v_accvgpr_write_b32 a138, v251
  v_accvgpr_write_b32 a139, v14
  v_accvgpr_read_b32 v249, a140
  v_accvgpr_read_b32 v250, a141
  v_accvgpr_read_b32 v251, a142
  v_accvgpr_read_b32 v14, a143
  v_mul_f32 v249, v249, v245
  v_mul_f32 v250, v250, v245
  v_mul_f32 v251, v251, v245
  v_mul_f32 v14, v14, v245
  v_accvgpr_write_b32 a140, v249
  v_accvgpr_write_b32 a141, v250
  v_accvgpr_write_b32 a142, v251
  v_accvgpr_write_b32 a143, v14
  v_accvgpr_read_b32 v249, a144
  v_accvgpr_read_b32 v250, a145
  v_accvgpr_read_b32 v251, a146
  v_accvgpr_read_b32 v14, a147
  v_mul_f32 v249, v249, v245
  v_mul_f32 v250, v250, v245
  v_mul_f32 v251, v251, v245
  v_mul_f32 v14, v14, v245
  v_accvgpr_write_b32 a144, v249
  v_accvgpr_write_b32 a145, v250
  v_accvgpr_write_b32 a146, v251
  v_accvgpr_write_b32 a147, v14
  v_accvgpr_read_b32 v249, a148
  v_accvgpr_read_b32 v250, a149
  v_accvgpr_read_b32 v251, a150
  v_accvgpr_read_b32 v14, a151
  v_mul_f32 v249, v249, v245
  v_mul_f32 v250, v250, v245
  v_mul_f32 v251, v251, v245
  v_mul_f32 v14, v14, v245
  v_accvgpr_write_b32 a148, v249
  v_accvgpr_write_b32 a149, v250
  v_accvgpr_write_b32 a150, v251
  v_accvgpr_write_b32 a151, v14
  v_accvgpr_read_b32 v249, a152
  v_accvgpr_read_b32 v250, a153
  v_accvgpr_read_b32 v251, a154
  v_accvgpr_read_b32 v14, a155
  v_mul_f32 v249, v249, v245
  v_mul_f32 v250, v250, v245
  v_mul_f32 v251, v251, v245
  v_mul_f32 v14, v14, v245
  v_accvgpr_write_b32 a152, v249
  v_accvgpr_write_b32 a153, v250
  v_accvgpr_write_b32 a154, v251
  v_accvgpr_write_b32 a155, v14
  v_accvgpr_read_b32 v249, a156
  v_accvgpr_read_b32 v250, a157
  v_accvgpr_read_b32 v251, a158
  v_accvgpr_read_b32 v14, a159
  v_mul_f32 v249, v249, v245
  v_mul_f32 v250, v250, v245
  v_mul_f32 v251, v251, v245
  v_mul_f32 v14, v14, v245
  v_accvgpr_write_b32 a156, v249
  v_accvgpr_write_b32 a157, v250
  v_accvgpr_write_b32 a158, v251
  v_accvgpr_write_b32 a159, v14
  v_accvgpr_read_b32 v249, a160
  v_accvgpr_read_b32 v250, a161
  v_accvgpr_read_b32 v251, a162
  v_accvgpr_read_b32 v14, a163
  v_mul_f32 v249, v249, v245
  v_mul_f32 v250, v250, v245
  v_mul_f32 v251, v251, v245
  v_mul_f32 v14, v14, v245
  v_accvgpr_write_b32 a160, v249
  v_accvgpr_write_b32 a161, v250
  v_accvgpr_write_b32 a162, v251
  v_accvgpr_write_b32 a163, v14
  v_accvgpr_read_b32 v249, a164
  v_accvgpr_read_b32 v250, a165
  v_accvgpr_read_b32 v251, a166
  v_accvgpr_read_b32 v14, a167
  v_mul_f32 v249, v249, v245
  v_mul_f32 v250, v250, v245
  v_mul_f32 v251, v251, v245
  v_mul_f32 v14, v14, v245
  v_accvgpr_write_b32 a164, v249
  v_accvgpr_write_b32 a165, v250
  v_accvgpr_write_b32 a166, v251
  v_accvgpr_write_b32 a167, v14
  v_accvgpr_read_b32 v249, a168
  v_accvgpr_read_b32 v250, a169
  v_accvgpr_read_b32 v251, a170
  v_accvgpr_read_b32 v14, a171
  v_mul_f32 v249, v249, v245
  v_mul_f32 v250, v250, v245
  v_mul_f32 v251, v251, v245
  v_mul_f32 v14, v14, v245
  v_accvgpr_write_b32 a168, v249
  v_accvgpr_write_b32 a169, v250
  v_accvgpr_write_b32 a170, v251
  v_accvgpr_write_b32 a171, v14
  v_accvgpr_read_b32 v249, a172
  v_accvgpr_read_b32 v250, a173
  v_accvgpr_read_b32 v251, a174
  v_accvgpr_read_b32 v14, a175
  v_mul_f32 v249, v249, v245
  v_mul_f32 v250, v250, v245
  v_mul_f32 v251, v251, v245
  v_mul_f32 v14, v14, v245
  v_accvgpr_write_b32 a172, v249
  v_accvgpr_write_b32 a173, v250
  v_accvgpr_write_b32 a174, v251
  v_accvgpr_write_b32 a175, v14
  v_accvgpr_read_b32 v249, a176
  v_accvgpr_read_b32 v250, a177
  v_accvgpr_read_b32 v251, a178
  v_accvgpr_read_b32 v14, a179
  v_mul_f32 v249, v249, v245
  v_mul_f32 v250, v250, v245
  v_mul_f32 v251, v251, v245
  v_mul_f32 v14, v14, v245
  v_accvgpr_write_b32 a176, v249
  v_accvgpr_write_b32 a177, v250
  v_accvgpr_write_b32 a178, v251
  v_accvgpr_write_b32 a179, v14
  v_accvgpr_read_b32 v249, a180
  v_accvgpr_read_b32 v250, a181
  v_accvgpr_read_b32 v251, a182
  v_accvgpr_read_b32 v14, a183
  v_mul_f32 v249, v249, v245
  v_mul_f32 v250, v250, v245
  v_mul_f32 v251, v251, v245
  v_mul_f32 v14, v14, v245
  v_accvgpr_write_b32 a180, v249
  v_accvgpr_write_b32 a181, v250
  v_accvgpr_write_b32 a182, v251
  v_accvgpr_write_b32 a183, v14
  v_accvgpr_read_b32 v249, a184
  v_accvgpr_read_b32 v250, a185
  v_accvgpr_read_b32 v251, a186
  v_accvgpr_read_b32 v14, a187
  v_mul_f32 v249, v249, v245
  v_mul_f32 v250, v250, v245
  v_mul_f32 v251, v251, v245
  v_mul_f32 v14, v14, v245
  v_accvgpr_write_b32 a184, v249
  v_accvgpr_write_b32 a185, v250
  v_accvgpr_write_b32 a186, v251
  v_accvgpr_write_b32 a187, v14
  v_accvgpr_read_b32 v249, a188
  v_accvgpr_read_b32 v250, a189
  v_accvgpr_read_b32 v251, a190
  v_accvgpr_read_b32 v14, a191
  v_mul_f32 v249, v249, v245
  v_mul_f32 v250, v250, v245
  v_mul_f32 v251, v251, v245
  v_mul_f32 v14, v14, v245
  v_accvgpr_write_b32 a188, v249
  v_accvgpr_write_b32 a189, v250
  v_accvgpr_write_b32 a190, v251
  v_accvgpr_write_b32 a191, v14
  s_mov_b32 s52, 0
  s_nop 3
  s_branch L_attn_rsret2
L_attn_rs3:
  s_nop 15
  v_accvgpr_read_b32 v249, a0
  v_accvgpr_read_b32 v250, a1
  v_accvgpr_read_b32 v251, a2
  v_accvgpr_read_b32 v14, a3
  v_mul_f32 v249, v249, v243
  v_mul_f32 v250, v250, v243
  v_mul_f32 v251, v251, v243
  v_mul_f32 v14, v14, v243
  v_accvgpr_write_b32 a0, v249
  v_accvgpr_write_b32 a1, v250
  v_accvgpr_write_b32 a2, v251
  v_accvgpr_write_b32 a3, v14
  v_accvgpr_read_b32 v249, a4
  v_accvgpr_read_b32 v250, a5
  v_accvgpr_read_b32 v251, a6
  v_accvgpr_read_b32 v14, a7
  v_mul_f32 v249, v249, v243
  v_mul_f32 v250, v250, v243
  v_mul_f32 v251, v251, v243
  v_mul_f32 v14, v14, v243
  v_accvgpr_write_b32 a4, v249
  v_accvgpr_write_b32 a5, v250
  v_accvgpr_write_b32 a6, v251
  v_accvgpr_write_b32 a7, v14
  v_accvgpr_read_b32 v249, a8
  v_accvgpr_read_b32 v250, a9
  v_accvgpr_read_b32 v251, a10
  v_accvgpr_read_b32 v14, a11
  v_mul_f32 v249, v249, v243
  v_mul_f32 v250, v250, v243
  v_mul_f32 v251, v251, v243
  v_mul_f32 v14, v14, v243
  v_accvgpr_write_b32 a8, v249
  v_accvgpr_write_b32 a9, v250
  v_accvgpr_write_b32 a10, v251
  v_accvgpr_write_b32 a11, v14
  v_accvgpr_read_b32 v249, a12
  v_accvgpr_read_b32 v250, a13
  v_accvgpr_read_b32 v251, a14
  v_accvgpr_read_b32 v14, a15
  v_mul_f32 v249, v249, v243
  v_mul_f32 v250, v250, v243
  v_mul_f32 v251, v251, v243
  v_mul_f32 v14, v14, v243
  v_accvgpr_write_b32 a12, v249
  v_accvgpr_write_b32 a13, v250
  v_accvgpr_write_b32 a14, v251
  v_accvgpr_write_b32 a15, v14
  v_accvgpr_read_b32 v249, a16
  v_accvgpr_read_b32 v250, a17
  v_accvgpr_read_b32 v251, a18
  v_accvgpr_read_b32 v14, a19
  v_mul_f32 v249, v249, v243
  v_mul_f32 v250, v250, v243
  v_mul_f32 v251, v251, v243
  v_mul_f32 v14, v14, v243
  v_accvgpr_write_b32 a16, v249
  v_accvgpr_write_b32 a17, v250
  v_accvgpr_write_b32 a18, v251
  v_accvgpr_write_b32 a19, v14
  v_accvgpr_read_b32 v249, a20
  v_accvgpr_read_b32 v250, a21
  v_accvgpr_read_b32 v251, a22
  v_accvgpr_read_b32 v14, a23
  v_mul_f32 v249, v249, v243
  v_mul_f32 v250, v250, v243
  v_mul_f32 v251, v251, v243
  v_mul_f32 v14, v14, v243
  v_accvgpr_write_b32 a20, v249
  v_accvgpr_write_b32 a21, v250
  v_accvgpr_write_b32 a22, v251
  v_accvgpr_write_b32 a23, v14
  v_accvgpr_read_b32 v249, a24
  v_accvgpr_read_b32 v250, a25
  v_accvgpr_read_b32 v251, a26
  v_accvgpr_read_b32 v14, a27
  v_mul_f32 v249, v249, v243
  v_mul_f32 v250, v250, v243
  v_mul_f32 v251, v251, v243
  v_mul_f32 v14, v14, v243
  v_accvgpr_write_b32 a24, v249
  v_accvgpr_write_b32 a25, v250
  v_accvgpr_write_b32 a26, v251
  v_accvgpr_write_b32 a27, v14
  v_accvgpr_read_b32 v249, a28
  v_accvgpr_read_b32 v250, a29
  v_accvgpr_read_b32 v251, a30
  v_accvgpr_read_b32 v14, a31
  v_mul_f32 v249, v249, v243
  v_mul_f32 v250, v250, v243
  v_mul_f32 v251, v251, v243
  v_mul_f32 v14, v14, v243
  v_accvgpr_write_b32 a28, v249
  v_accvgpr_write_b32 a29, v250
  v_accvgpr_write_b32 a30, v251
  v_accvgpr_write_b32 a31, v14
  v_accvgpr_read_b32 v249, a32
  v_accvgpr_read_b32 v250, a33
  v_accvgpr_read_b32 v251, a34
  v_accvgpr_read_b32 v14, a35
  v_mul_f32 v249, v249, v243
  v_mul_f32 v250, v250, v243
  v_mul_f32 v251, v251, v243
  v_mul_f32 v14, v14, v243
  v_accvgpr_write_b32 a32, v249
  v_accvgpr_write_b32 a33, v250
  v_accvgpr_write_b32 a34, v251
  v_accvgpr_write_b32 a35, v14
  v_accvgpr_read_b32 v249, a36
  v_accvgpr_read_b32 v250, a37
  v_accvgpr_read_b32 v251, a38
  v_accvgpr_read_b32 v14, a39
  v_mul_f32 v249, v249, v243
  v_mul_f32 v250, v250, v243
  v_mul_f32 v251, v251, v243
  v_mul_f32 v14, v14, v243
  v_accvgpr_write_b32 a36, v249
  v_accvgpr_write_b32 a37, v250
  v_accvgpr_write_b32 a38, v251
  v_accvgpr_write_b32 a39, v14
  v_accvgpr_read_b32 v249, a40
  v_accvgpr_read_b32 v250, a41
  v_accvgpr_read_b32 v251, a42
  v_accvgpr_read_b32 v14, a43
  v_mul_f32 v249, v249, v243
  v_mul_f32 v250, v250, v243
  v_mul_f32 v251, v251, v243
  v_mul_f32 v14, v14, v243
  v_accvgpr_write_b32 a40, v249
  v_accvgpr_write_b32 a41, v250
  v_accvgpr_write_b32 a42, v251
  v_accvgpr_write_b32 a43, v14
  v_accvgpr_read_b32 v249, a44
  v_accvgpr_read_b32 v250, a45
  v_accvgpr_read_b32 v251, a46
  v_accvgpr_read_b32 v14, a47
  v_mul_f32 v249, v249, v243
  v_mul_f32 v250, v250, v243
  v_mul_f32 v251, v251, v243
  v_mul_f32 v14, v14, v243
  v_accvgpr_write_b32 a44, v249
  v_accvgpr_write_b32 a45, v250
  v_accvgpr_write_b32 a46, v251
  v_accvgpr_write_b32 a47, v14
  v_accvgpr_read_b32 v249, a48
  v_accvgpr_read_b32 v250, a49
  v_accvgpr_read_b32 v251, a50
  v_accvgpr_read_b32 v14, a51
  v_mul_f32 v249, v249, v243
  v_mul_f32 v250, v250, v243
  v_mul_f32 v251, v251, v243
  v_mul_f32 v14, v14, v243
  v_accvgpr_write_b32 a48, v249
  v_accvgpr_write_b32 a49, v250
  v_accvgpr_write_b32 a50, v251
  v_accvgpr_write_b32 a51, v14
  v_accvgpr_read_b32 v249, a52
  v_accvgpr_read_b32 v250, a53
  v_accvgpr_read_b32 v251, a54
  v_accvgpr_read_b32 v14, a55
  v_mul_f32 v249, v249, v243
  v_mul_f32 v250, v250, v243
  v_mul_f32 v251, v251, v243
  v_mul_f32 v14, v14, v243
  v_accvgpr_write_b32 a52, v249
  v_accvgpr_write_b32 a53, v250
  v_accvgpr_write_b32 a54, v251
  v_accvgpr_write_b32 a55, v14
  v_accvgpr_read_b32 v249, a56
  v_accvgpr_read_b32 v250, a57
  v_accvgpr_read_b32 v251, a58
  v_accvgpr_read_b32 v14, a59
  v_mul_f32 v249, v249, v243
  v_mul_f32 v250, v250, v243
  v_mul_f32 v251, v251, v243
  v_mul_f32 v14, v14, v243
  v_accvgpr_write_b32 a56, v249
  v_accvgpr_write_b32 a57, v250
  v_accvgpr_write_b32 a58, v251
  v_accvgpr_write_b32 a59, v14
  v_accvgpr_read_b32 v249, a60
  v_accvgpr_read_b32 v250, a61
  v_accvgpr_read_b32 v251, a62
  v_accvgpr_read_b32 v14, a63
  v_mul_f32 v249, v249, v243
  v_mul_f32 v250, v250, v243
  v_mul_f32 v251, v251, v243
  v_mul_f32 v14, v14, v243
  v_accvgpr_write_b32 a60, v249
  v_accvgpr_write_b32 a61, v250
  v_accvgpr_write_b32 a62, v251
  v_accvgpr_write_b32 a63, v14
  v_accvgpr_read_b32 v249, a64
  v_accvgpr_read_b32 v250, a65
  v_accvgpr_read_b32 v251, a66
  v_accvgpr_read_b32 v14, a67
  v_mul_f32 v249, v249, v244
  v_mul_f32 v250, v250, v244
  v_mul_f32 v251, v251, v244
  v_mul_f32 v14, v14, v244
  v_accvgpr_write_b32 a64, v249
  v_accvgpr_write_b32 a65, v250
  v_accvgpr_write_b32 a66, v251
  v_accvgpr_write_b32 a67, v14
  v_accvgpr_read_b32 v249, a68
  v_accvgpr_read_b32 v250, a69
  v_accvgpr_read_b32 v251, a70
  v_accvgpr_read_b32 v14, a71
  v_mul_f32 v249, v249, v244
  v_mul_f32 v250, v250, v244
  v_mul_f32 v251, v251, v244
  v_mul_f32 v14, v14, v244
  v_accvgpr_write_b32 a68, v249
  v_accvgpr_write_b32 a69, v250
  v_accvgpr_write_b32 a70, v251
  v_accvgpr_write_b32 a71, v14
  v_accvgpr_read_b32 v249, a72
  v_accvgpr_read_b32 v250, a73
  v_accvgpr_read_b32 v251, a74
  v_accvgpr_read_b32 v14, a75
  v_mul_f32 v249, v249, v244
  v_mul_f32 v250, v250, v244
  v_mul_f32 v251, v251, v244
  v_mul_f32 v14, v14, v244
  v_accvgpr_write_b32 a72, v249
  v_accvgpr_write_b32 a73, v250
  v_accvgpr_write_b32 a74, v251
  v_accvgpr_write_b32 a75, v14
  v_accvgpr_read_b32 v249, a76
  v_accvgpr_read_b32 v250, a77
  v_accvgpr_read_b32 v251, a78
  v_accvgpr_read_b32 v14, a79
  v_mul_f32 v249, v249, v244
  v_mul_f32 v250, v250, v244
  v_mul_f32 v251, v251, v244
  v_mul_f32 v14, v14, v244
  v_accvgpr_write_b32 a76, v249
  v_accvgpr_write_b32 a77, v250
  v_accvgpr_write_b32 a78, v251
  v_accvgpr_write_b32 a79, v14
  v_accvgpr_read_b32 v249, a80
  v_accvgpr_read_b32 v250, a81
  v_accvgpr_read_b32 v251, a82
  v_accvgpr_read_b32 v14, a83
  v_mul_f32 v249, v249, v244
  v_mul_f32 v250, v250, v244
  v_mul_f32 v251, v251, v244
  v_mul_f32 v14, v14, v244
  v_accvgpr_write_b32 a80, v249
  v_accvgpr_write_b32 a81, v250
  v_accvgpr_write_b32 a82, v251
  v_accvgpr_write_b32 a83, v14
  v_accvgpr_read_b32 v249, a84
  v_accvgpr_read_b32 v250, a85
  v_accvgpr_read_b32 v251, a86
  v_accvgpr_read_b32 v14, a87
  v_mul_f32 v249, v249, v244
  v_mul_f32 v250, v250, v244
  v_mul_f32 v251, v251, v244
  v_mul_f32 v14, v14, v244
  v_accvgpr_write_b32 a84, v249
  v_accvgpr_write_b32 a85, v250
  v_accvgpr_write_b32 a86, v251
  v_accvgpr_write_b32 a87, v14
  v_accvgpr_read_b32 v249, a88
  v_accvgpr_read_b32 v250, a89
  v_accvgpr_read_b32 v251, a90
  v_accvgpr_read_b32 v14, a91
  v_mul_f32 v249, v249, v244
  v_mul_f32 v250, v250, v244
  v_mul_f32 v251, v251, v244
  v_mul_f32 v14, v14, v244
  v_accvgpr_write_b32 a88, v249
  v_accvgpr_write_b32 a89, v250
  v_accvgpr_write_b32 a90, v251
  v_accvgpr_write_b32 a91, v14
  v_accvgpr_read_b32 v249, a92
  v_accvgpr_read_b32 v250, a93
  v_accvgpr_read_b32 v251, a94
  v_accvgpr_read_b32 v14, a95
  v_mul_f32 v249, v249, v244
  v_mul_f32 v250, v250, v244
  v_mul_f32 v251, v251, v244
  v_mul_f32 v14, v14, v244
  v_accvgpr_write_b32 a92, v249
  v_accvgpr_write_b32 a93, v250
  v_accvgpr_write_b32 a94, v251
  v_accvgpr_write_b32 a95, v14
  v_accvgpr_read_b32 v249, a96
  v_accvgpr_read_b32 v250, a97
  v_accvgpr_read_b32 v251, a98
  v_accvgpr_read_b32 v14, a99
  v_mul_f32 v249, v249, v244
  v_mul_f32 v250, v250, v244
  v_mul_f32 v251, v251, v244
  v_mul_f32 v14, v14, v244
  v_accvgpr_write_b32 a96, v249
  v_accvgpr_write_b32 a97, v250
  v_accvgpr_write_b32 a98, v251
  v_accvgpr_write_b32 a99, v14
  v_accvgpr_read_b32 v249, a100
  v_accvgpr_read_b32 v250, a101
  v_accvgpr_read_b32 v251, a102
  v_accvgpr_read_b32 v14, a103
  v_mul_f32 v249, v249, v244
  v_mul_f32 v250, v250, v244
  v_mul_f32 v251, v251, v244
  v_mul_f32 v14, v14, v244
  v_accvgpr_write_b32 a100, v249
  v_accvgpr_write_b32 a101, v250
  v_accvgpr_write_b32 a102, v251
  v_accvgpr_write_b32 a103, v14
  v_accvgpr_read_b32 v249, a104
  v_accvgpr_read_b32 v250, a105
  v_accvgpr_read_b32 v251, a106
  v_accvgpr_read_b32 v14, a107
  v_mul_f32 v249, v249, v244
  v_mul_f32 v250, v250, v244
  v_mul_f32 v251, v251, v244
  v_mul_f32 v14, v14, v244
  v_accvgpr_write_b32 a104, v249
  v_accvgpr_write_b32 a105, v250
  v_accvgpr_write_b32 a106, v251
  v_accvgpr_write_b32 a107, v14
  v_accvgpr_read_b32 v249, a108
  v_accvgpr_read_b32 v250, a109
  v_accvgpr_read_b32 v251, a110
  v_accvgpr_read_b32 v14, a111
  v_mul_f32 v249, v249, v244
  v_mul_f32 v250, v250, v244
  v_mul_f32 v251, v251, v244
  v_mul_f32 v14, v14, v244
  v_accvgpr_write_b32 a108, v249
  v_accvgpr_write_b32 a109, v250
  v_accvgpr_write_b32 a110, v251
  v_accvgpr_write_b32 a111, v14
  v_accvgpr_read_b32 v249, a112
  v_accvgpr_read_b32 v250, a113
  v_accvgpr_read_b32 v251, a114
  v_accvgpr_read_b32 v14, a115
  v_mul_f32 v249, v249, v244
  v_mul_f32 v250, v250, v244
  v_mul_f32 v251, v251, v244
  v_mul_f32 v14, v14, v244
  v_accvgpr_write_b32 a112, v249
  v_accvgpr_write_b32 a113, v250
  v_accvgpr_write_b32 a114, v251
  v_accvgpr_write_b32 a115, v14
  v_accvgpr_read_b32 v249, a116
  v_accvgpr_read_b32 v250, a117
  v_accvgpr_read_b32 v251, a118
  v_accvgpr_read_b32 v14, a119
  v_mul_f32 v249, v249, v244
  v_mul_f32 v250, v250, v244
  v_mul_f32 v251, v251, v244
  v_mul_f32 v14, v14, v244
  v_accvgpr_write_b32 a116, v249
  v_accvgpr_write_b32 a117, v250
  v_accvgpr_write_b32 a118, v251
  v_accvgpr_write_b32 a119, v14
  v_accvgpr_read_b32 v249, a120
  v_accvgpr_read_b32 v250, a121
  v_accvgpr_read_b32 v251, a122
  v_accvgpr_read_b32 v14, a123
  v_mul_f32 v249, v249, v244
  v_mul_f32 v250, v250, v244
  v_mul_f32 v251, v251, v244
  v_mul_f32 v14, v14, v244
  v_accvgpr_write_b32 a120, v249
  v_accvgpr_write_b32 a121, v250
  v_accvgpr_write_b32 a122, v251
  v_accvgpr_write_b32 a123, v14
  v_accvgpr_read_b32 v249, a124
  v_accvgpr_read_b32 v250, a125
  v_accvgpr_read_b32 v251, a126
  v_accvgpr_read_b32 v14, a127
  v_mul_f32 v249, v249, v244
  v_mul_f32 v250, v250, v244
  v_mul_f32 v251, v251, v244
  v_mul_f32 v14, v14, v244
  v_accvgpr_write_b32 a124, v249
  v_accvgpr_write_b32 a125, v250
  v_accvgpr_write_b32 a126, v251
  v_accvgpr_write_b32 a127, v14
  v_accvgpr_read_b32 v249, a128
  v_accvgpr_read_b32 v250, a129
  v_accvgpr_read_b32 v251, a130
  v_accvgpr_read_b32 v14, a131
  v_mul_f32 v249, v249, v245
  v_mul_f32 v250, v250, v245
  v_mul_f32 v251, v251, v245
  v_mul_f32 v14, v14, v245
  v_accvgpr_write_b32 a128, v249
  v_accvgpr_write_b32 a129, v250
  v_accvgpr_write_b32 a130, v251
  v_accvgpr_write_b32 a131, v14
  v_accvgpr_read_b32 v249, a132
  v_accvgpr_read_b32 v250, a133
  v_accvgpr_read_b32 v251, a134
  v_accvgpr_read_b32 v14, a135
  v_mul_f32 v249, v249, v245
  v_mul_f32 v250, v250, v245
  v_mul_f32 v251, v251, v245
  v_mul_f32 v14, v14, v245
  v_accvgpr_write_b32 a132, v249
  v_accvgpr_write_b32 a133, v250
  v_accvgpr_write_b32 a134, v251
  v_accvgpr_write_b32 a135, v14
  v_accvgpr_read_b32 v249, a136
  v_accvgpr_read_b32 v250, a137
  v_accvgpr_read_b32 v251, a138
  v_accvgpr_read_b32 v14, a139
  v_mul_f32 v249, v249, v245
  v_mul_f32 v250, v250, v245
  v_mul_f32 v251, v251, v245
  v_mul_f32 v14, v14, v245
  v_accvgpr_write_b32 a136, v249
  v_accvgpr_write_b32 a137, v250
  v_accvgpr_write_b32 a138, v251
  v_accvgpr_write_b32 a139, v14
  v_accvgpr_read_b32 v249, a140
  v_accvgpr_read_b32 v250, a141
  v_accvgpr_read_b32 v251, a142
  v_accvgpr_read_b32 v14, a143
  v_mul_f32 v249, v249, v245
  v_mul_f32 v250, v250, v245
  v_mul_f32 v251, v251, v245
  v_mul_f32 v14, v14, v245
  v_accvgpr_write_b32 a140, v249
  v_accvgpr_write_b32 a141, v250
  v_accvgpr_write_b32 a142, v251
  v_accvgpr_write_b32 a143, v14
  v_accvgpr_read_b32 v249, a144
  v_accvgpr_read_b32 v250, a145
  v_accvgpr_read_b32 v251, a146
  v_accvgpr_read_b32 v14, a147
  v_mul_f32 v249, v249, v245
  v_mul_f32 v250, v250, v245
  v_mul_f32 v251, v251, v245
  v_mul_f32 v14, v14, v245
  v_accvgpr_write_b32 a144, v249
  v_accvgpr_write_b32 a145, v250
  v_accvgpr_write_b32 a146, v251
  v_accvgpr_write_b32 a147, v14
  v_accvgpr_read_b32 v249, a148
  v_accvgpr_read_b32 v250, a149
  v_accvgpr_read_b32 v251, a150
  v_accvgpr_read_b32 v14, a151
  v_mul_f32 v249, v249, v245
  v_mul_f32 v250, v250, v245
  v_mul_f32 v251, v251, v245
  v_mul_f32 v14, v14, v245
  v_accvgpr_write_b32 a148, v249
  v_accvgpr_write_b32 a149, v250
  v_accvgpr_write_b32 a150, v251
  v_accvgpr_write_b32 a151, v14
  v_accvgpr_read_b32 v249, a152
  v_accvgpr_read_b32 v250, a153
  v_accvgpr_read_b32 v251, a154
  v_accvgpr_read_b32 v14, a155
  v_mul_f32 v249, v249, v245
  v_mul_f32 v250, v250, v245
  v_mul_f32 v251, v251, v245
  v_mul_f32 v14, v14, v245
  v_accvgpr_write_b32 a152, v249
  v_accvgpr_write_b32 a153, v250
  v_accvgpr_write_b32 a154, v251
  v_accvgpr_write_b32 a155, v14
  v_accvgpr_read_b32 v249, a156
  v_accvgpr_read_b32 v250, a157
  v_accvgpr_read_b32 v251, a158
  v_accvgpr_read_b32 v14, a159
  v_mul_f32 v249, v249, v245
  v_mul_f32 v250, v250, v245
  v_mul_f32 v251, v251, v245
  v_mul_f32 v14, v14, v245
  v_accvgpr_write_b32 a156, v249
  v_accvgpr_write_b32 a157, v250
  v_accvgpr_write_b32 a158, v251
  v_accvgpr_write_b32 a159, v14
  v_accvgpr_read_b32 v249, a160
  v_accvgpr_read_b32 v250, a161
  v_accvgpr_read_b32 v251, a162
  v_accvgpr_read_b32 v14, a163
  v_mul_f32 v249, v249, v245
  v_mul_f32 v250, v250, v245
  v_mul_f32 v251, v251, v245
  v_mul_f32 v14, v14, v245
  v_accvgpr_write_b32 a160, v249
  v_accvgpr_write_b32 a161, v250
  v_accvgpr_write_b32 a162, v251
  v_accvgpr_write_b32 a163, v14
  v_accvgpr_read_b32 v249, a164
  v_accvgpr_read_b32 v250, a165
  v_accvgpr_read_b32 v251, a166
  v_accvgpr_read_b32 v14, a167
  v_mul_f32 v249, v249, v245
  v_mul_f32 v250, v250, v245
  v_mul_f32 v251, v251, v245
  v_mul_f32 v14, v14, v245
  v_accvgpr_write_b32 a164, v249
  v_accvgpr_write_b32 a165, v250
  v_accvgpr_write_b32 a166, v251
  v_accvgpr_write_b32 a167, v14
  v_accvgpr_read_b32 v249, a168
  v_accvgpr_read_b32 v250, a169
  v_accvgpr_read_b32 v251, a170
  v_accvgpr_read_b32 v14, a171
  v_mul_f32 v249, v249, v245
  v_mul_f32 v250, v250, v245
  v_mul_f32 v251, v251, v245
  v_mul_f32 v14, v14, v245
  v_accvgpr_write_b32 a168, v249
  v_accvgpr_write_b32 a169, v250
  v_accvgpr_write_b32 a170, v251
  v_accvgpr_write_b32 a171, v14
  v_accvgpr_read_b32 v249, a172
  v_accvgpr_read_b32 v250, a173
  v_accvgpr_read_b32 v251, a174
  v_accvgpr_read_b32 v14, a175
  v_mul_f32 v249, v249, v245
  v_mul_f32 v250, v250, v245
  v_mul_f32 v251, v251, v245
  v_mul_f32 v14, v14, v245
  v_accvgpr_write_b32 a172, v249
  v_accvgpr_write_b32 a173, v250
  v_accvgpr_write_b32 a174, v251
  v_accvgpr_write_b32 a175, v14
  v_accvgpr_read_b32 v249, a176
  v_accvgpr_read_b32 v250, a177
  v_accvgpr_read_b32 v251, a178
  v_accvgpr_read_b32 v14, a179
  v_mul_f32 v249, v249, v245
  v_mul_f32 v250, v250, v245
  v_mul_f32 v251, v251, v245
  v_mul_f32 v14, v14, v245
  v_accvgpr_write_b32 a176, v249
  v_accvgpr_write_b32 a177, v250
  v_accvgpr_write_b32 a178, v251
  v_accvgpr_write_b32 a179, v14
  v_accvgpr_read_b32 v249, a180
  v_accvgpr_read_b32 v250, a181
  v_accvgpr_read_b32 v251, a182
  v_accvgpr_read_b32 v14, a183
  v_mul_f32 v249, v249, v245
  v_mul_f32 v250, v250, v245
  v_mul_f32 v251, v251, v245
  v_mul_f32 v14, v14, v245
  v_accvgpr_write_b32 a180, v249
  v_accvgpr_write_b32 a181, v250
  v_accvgpr_write_b32 a182, v251
  v_accvgpr_write_b32 a183, v14
  v_accvgpr_read_b32 v249, a184
  v_accvgpr_read_b32 v250, a185
  v_accvgpr_read_b32 v251, a186
  v_accvgpr_read_b32 v14, a187
  v_mul_f32 v249, v249, v245
  v_mul_f32 v250, v250, v245
  v_mul_f32 v251, v251, v245
  v_mul_f32 v14, v14, v245
  v_accvgpr_write_b32 a184, v249
  v_accvgpr_write_b32 a185, v250
  v_accvgpr_write_b32 a186, v251
  v_accvgpr_write_b32 a187, v14
  v_accvgpr_read_b32 v249, a188
  v_accvgpr_read_b32 v250, a189
  v_accvgpr_read_b32 v251, a190
  v_accvgpr_read_b32 v14, a191
  v_mul_f32 v249, v249, v245
  v_mul_f32 v250, v250, v245
  v_mul_f32 v251, v251, v245
  v_mul_f32 v14, v14, v245
  v_accvgpr_write_b32 a188, v249
  v_accvgpr_write_b32 a189, v250
  v_accvgpr_write_b32 a190, v251
  v_accvgpr_write_b32 a191, v14
  s_mov_b32 s52, 0
  s_nop 3
  s_branch L_attn_rsret3
L_attn_rs4:
  s_nop 15
  v_accvgpr_read_b32 v249, a0
  v_accvgpr_read_b32 v250, a1
  v_accvgpr_read_b32 v251, a2
  v_accvgpr_read_b32 v14, a3
  v_mul_f32 v249, v249, v243
  v_mul_f32 v250, v250, v243
  v_mul_f32 v251, v251, v243
  v_mul_f32 v14, v14, v243
  v_accvgpr_write_b32 a0, v249
  v_accvgpr_write_b32 a1, v250
  v_accvgpr_write_b32 a2, v251
  v_accvgpr_write_b32 a3, v14
  v_accvgpr_read_b32 v249, a4
  v_accvgpr_read_b32 v250, a5
  v_accvgpr_read_b32 v251, a6
  v_accvgpr_read_b32 v14, a7
  v_mul_f32 v249, v249, v243
  v_mul_f32 v250, v250, v243
  v_mul_f32 v251, v251, v243
  v_mul_f32 v14, v14, v243
  v_accvgpr_write_b32 a4, v249
  v_accvgpr_write_b32 a5, v250
  v_accvgpr_write_b32 a6, v251
  v_accvgpr_write_b32 a7, v14
  v_accvgpr_read_b32 v249, a8
  v_accvgpr_read_b32 v250, a9
  v_accvgpr_read_b32 v251, a10
  v_accvgpr_read_b32 v14, a11
  v_mul_f32 v249, v249, v243
  v_mul_f32 v250, v250, v243
  v_mul_f32 v251, v251, v243
  v_mul_f32 v14, v14, v243
  v_accvgpr_write_b32 a8, v249
  v_accvgpr_write_b32 a9, v250
  v_accvgpr_write_b32 a10, v251
  v_accvgpr_write_b32 a11, v14
  v_accvgpr_read_b32 v249, a12
  v_accvgpr_read_b32 v250, a13
  v_accvgpr_read_b32 v251, a14
  v_accvgpr_read_b32 v14, a15
  v_mul_f32 v249, v249, v243
  v_mul_f32 v250, v250, v243
  v_mul_f32 v251, v251, v243
  v_mul_f32 v14, v14, v243
  v_accvgpr_write_b32 a12, v249
  v_accvgpr_write_b32 a13, v250
  v_accvgpr_write_b32 a14, v251
  v_accvgpr_write_b32 a15, v14
  v_accvgpr_read_b32 v249, a16
  v_accvgpr_read_b32 v250, a17
  v_accvgpr_read_b32 v251, a18
  v_accvgpr_read_b32 v14, a19
  v_mul_f32 v249, v249, v243
  v_mul_f32 v250, v250, v243
  v_mul_f32 v251, v251, v243
  v_mul_f32 v14, v14, v243
  v_accvgpr_write_b32 a16, v249
  v_accvgpr_write_b32 a17, v250
  v_accvgpr_write_b32 a18, v251
  v_accvgpr_write_b32 a19, v14
  v_accvgpr_read_b32 v249, a20
  v_accvgpr_read_b32 v250, a21
  v_accvgpr_read_b32 v251, a22
  v_accvgpr_read_b32 v14, a23
  v_mul_f32 v249, v249, v243
  v_mul_f32 v250, v250, v243
  v_mul_f32 v251, v251, v243
  v_mul_f32 v14, v14, v243
  v_accvgpr_write_b32 a20, v249
  v_accvgpr_write_b32 a21, v250
  v_accvgpr_write_b32 a22, v251
  v_accvgpr_write_b32 a23, v14
  v_accvgpr_read_b32 v249, a24
  v_accvgpr_read_b32 v250, a25
  v_accvgpr_read_b32 v251, a26
  v_accvgpr_read_b32 v14, a27
  v_mul_f32 v249, v249, v243
  v_mul_f32 v250, v250, v243
  v_mul_f32 v251, v251, v243
  v_mul_f32 v14, v14, v243
  v_accvgpr_write_b32 a24, v249
  v_accvgpr_write_b32 a25, v250
  v_accvgpr_write_b32 a26, v251
  v_accvgpr_write_b32 a27, v14
  v_accvgpr_read_b32 v249, a28
  v_accvgpr_read_b32 v250, a29
  v_accvgpr_read_b32 v251, a30
  v_accvgpr_read_b32 v14, a31
  v_mul_f32 v249, v249, v243
  v_mul_f32 v250, v250, v243
  v_mul_f32 v251, v251, v243
  v_mul_f32 v14, v14, v243
  v_accvgpr_write_b32 a28, v249
  v_accvgpr_write_b32 a29, v250
  v_accvgpr_write_b32 a30, v251
  v_accvgpr_write_b32 a31, v14
  v_accvgpr_read_b32 v249, a32
  v_accvgpr_read_b32 v250, a33
  v_accvgpr_read_b32 v251, a34
  v_accvgpr_read_b32 v14, a35
  v_mul_f32 v249, v249, v243
  v_mul_f32 v250, v250, v243
  v_mul_f32 v251, v251, v243
  v_mul_f32 v14, v14, v243
  v_accvgpr_write_b32 a32, v249
  v_accvgpr_write_b32 a33, v250
  v_accvgpr_write_b32 a34, v251
  v_accvgpr_write_b32 a35, v14
  v_accvgpr_read_b32 v249, a36
  v_accvgpr_read_b32 v250, a37
  v_accvgpr_read_b32 v251, a38
  v_accvgpr_read_b32 v14, a39
  v_mul_f32 v249, v249, v243
  v_mul_f32 v250, v250, v243
  v_mul_f32 v251, v251, v243
  v_mul_f32 v14, v14, v243
  v_accvgpr_write_b32 a36, v249
  v_accvgpr_write_b32 a37, v250
  v_accvgpr_write_b32 a38, v251
  v_accvgpr_write_b32 a39, v14
  v_accvgpr_read_b32 v249, a40
  v_accvgpr_read_b32 v250, a41
  v_accvgpr_read_b32 v251, a42
  v_accvgpr_read_b32 v14, a43
  v_mul_f32 v249, v249, v243
  v_mul_f32 v250, v250, v243
  v_mul_f32 v251, v251, v243
  v_mul_f32 v14, v14, v243
  v_accvgpr_write_b32 a40, v249
  v_accvgpr_write_b32 a41, v250
  v_accvgpr_write_b32 a42, v251
  v_accvgpr_write_b32 a43, v14
  v_accvgpr_read_b32 v249, a44
  v_accvgpr_read_b32 v250, a45
  v_accvgpr_read_b32 v251, a46
  v_accvgpr_read_b32 v14, a47
  v_mul_f32 v249, v249, v243
  v_mul_f32 v250, v250, v243
  v_mul_f32 v251, v251, v243
  v_mul_f32 v14, v14, v243
  v_accvgpr_write_b32 a44, v249
  v_accvgpr_write_b32 a45, v250
  v_accvgpr_write_b32 a46, v251
  v_accvgpr_write_b32 a47, v14
  v_accvgpr_read_b32 v249, a48
  v_accvgpr_read_b32 v250, a49
  v_accvgpr_read_b32 v251, a50
  v_accvgpr_read_b32 v14, a51
  v_mul_f32 v249, v249, v243
  v_mul_f32 v250, v250, v243
  v_mul_f32 v251, v251, v243
  v_mul_f32 v14, v14, v243
  v_accvgpr_write_b32 a48, v249
  v_accvgpr_write_b32 a49, v250
  v_accvgpr_write_b32 a50, v251
  v_accvgpr_write_b32 a51, v14
  v_accvgpr_read_b32 v249, a52
  v_accvgpr_read_b32 v250, a53
  v_accvgpr_read_b32 v251, a54
  v_accvgpr_read_b32 v14, a55
  v_mul_f32 v249, v249, v243
  v_mul_f32 v250, v250, v243
  v_mul_f32 v251, v251, v243
  v_mul_f32 v14, v14, v243
  v_accvgpr_write_b32 a52, v249
  v_accvgpr_write_b32 a53, v250
  v_accvgpr_write_b32 a54, v251
  v_accvgpr_write_b32 a55, v14
  v_accvgpr_read_b32 v249, a56
  v_accvgpr_read_b32 v250, a57
  v_accvgpr_read_b32 v251, a58
  v_accvgpr_read_b32 v14, a59
  v_mul_f32 v249, v249, v243
  v_mul_f32 v250, v250, v243
  v_mul_f32 v251, v251, v243
  v_mul_f32 v14, v14, v243
  v_accvgpr_write_b32 a56, v249
  v_accvgpr_write_b32 a57, v250
  v_accvgpr_write_b32 a58, v251
  v_accvgpr_write_b32 a59, v14
  v_accvgpr_read_b32 v249, a60
  v_accvgpr_read_b32 v250, a61
  v_accvgpr_read_b32 v251, a62
  v_accvgpr_read_b32 v14, a63
  v_mul_f32 v249, v249, v243
  v_mul_f32 v250, v250, v243
  v_mul_f32 v251, v251, v243
  v_mul_f32 v14, v14, v243
  v_accvgpr_write_b32 a60, v249
  v_accvgpr_write_b32 a61, v250
  v_accvgpr_write_b32 a62, v251
  v_accvgpr_write_b32 a63, v14
  v_accvgpr_read_b32 v249, a64
  v_accvgpr_read_b32 v250, a65
  v_accvgpr_read_b32 v251, a66
  v_accvgpr_read_b32 v14, a67
  v_mul_f32 v249, v249, v244
  v_mul_f32 v250, v250, v244
  v_mul_f32 v251, v251, v244
  v_mul_f32 v14, v14, v244
  v_accvgpr_write_b32 a64, v249
  v_accvgpr_write_b32 a65, v250
  v_accvgpr_write_b32 a66, v251
  v_accvgpr_write_b32 a67, v14
  v_accvgpr_read_b32 v249, a68
  v_accvgpr_read_b32 v250, a69
  v_accvgpr_read_b32 v251, a70
  v_accvgpr_read_b32 v14, a71
  v_mul_f32 v249, v249, v244
  v_mul_f32 v250, v250, v244
  v_mul_f32 v251, v251, v244
  v_mul_f32 v14, v14, v244
  v_accvgpr_write_b32 a68, v249
  v_accvgpr_write_b32 a69, v250
  v_accvgpr_write_b32 a70, v251
  v_accvgpr_write_b32 a71, v14
  v_accvgpr_read_b32 v249, a72
  v_accvgpr_read_b32 v250, a73
  v_accvgpr_read_b32 v251, a74
  v_accvgpr_read_b32 v14, a75
  v_mul_f32 v249, v249, v244
  v_mul_f32 v250, v250, v244
  v_mul_f32 v251, v251, v244
  v_mul_f32 v14, v14, v244
  v_accvgpr_write_b32 a72, v249
  v_accvgpr_write_b32 a73, v250
  v_accvgpr_write_b32 a74, v251
  v_accvgpr_write_b32 a75, v14
  v_accvgpr_read_b32 v249, a76
  v_accvgpr_read_b32 v250, a77
  v_accvgpr_read_b32 v251, a78
  v_accvgpr_read_b32 v14, a79
  v_mul_f32 v249, v249, v244
  v_mul_f32 v250, v250, v244
  v_mul_f32 v251, v251, v244
  v_mul_f32 v14, v14, v244
  v_accvgpr_write_b32 a76, v249
  v_accvgpr_write_b32 a77, v250
  v_accvgpr_write_b32 a78, v251
  v_accvgpr_write_b32 a79, v14
  v_accvgpr_read_b32 v249, a80
  v_accvgpr_read_b32 v250, a81
  v_accvgpr_read_b32 v251, a82
  v_accvgpr_read_b32 v14, a83
  v_mul_f32 v249, v249, v244
  v_mul_f32 v250, v250, v244
  v_mul_f32 v251, v251, v244
  v_mul_f32 v14, v14, v244
  v_accvgpr_write_b32 a80, v249
  v_accvgpr_write_b32 a81, v250
  v_accvgpr_write_b32 a82, v251
  v_accvgpr_write_b32 a83, v14
  v_accvgpr_read_b32 v249, a84
  v_accvgpr_read_b32 v250, a85
  v_accvgpr_read_b32 v251, a86
  v_accvgpr_read_b32 v14, a87
  v_mul_f32 v249, v249, v244
  v_mul_f32 v250, v250, v244
  v_mul_f32 v251, v251, v244
  v_mul_f32 v14, v14, v244
  v_accvgpr_write_b32 a84, v249
  v_accvgpr_write_b32 a85, v250
  v_accvgpr_write_b32 a86, v251
  v_accvgpr_write_b32 a87, v14
  v_accvgpr_read_b32 v249, a88
  v_accvgpr_read_b32 v250, a89
  v_accvgpr_read_b32 v251, a90
  v_accvgpr_read_b32 v14, a91
  v_mul_f32 v249, v249, v244
  v_mul_f32 v250, v250, v244
  v_mul_f32 v251, v251, v244
  v_mul_f32 v14, v14, v244
  v_accvgpr_write_b32 a88, v249
  v_accvgpr_write_b32 a89, v250
  v_accvgpr_write_b32 a90, v251
  v_accvgpr_write_b32 a91, v14
  v_accvgpr_read_b32 v249, a92
  v_accvgpr_read_b32 v250, a93
  v_accvgpr_read_b32 v251, a94
  v_accvgpr_read_b32 v14, a95
  v_mul_f32 v249, v249, v244
  v_mul_f32 v250, v250, v244
  v_mul_f32 v251, v251, v244
  v_mul_f32 v14, v14, v244
  v_accvgpr_write_b32 a92, v249
  v_accvgpr_write_b32 a93, v250
  v_accvgpr_write_b32 a94, v251
  v_accvgpr_write_b32 a95, v14
  v_accvgpr_read_b32 v249, a96
  v_accvgpr_read_b32 v250, a97
  v_accvgpr_read_b32 v251, a98
  v_accvgpr_read_b32 v14, a99
  v_mul_f32 v249, v249, v244
  v_mul_f32 v250, v250, v244
  v_mul_f32 v251, v251, v244
  v_mul_f32 v14, v14, v244
  v_accvgpr_write_b32 a96, v249
  v_accvgpr_write_b32 a97, v250
  v_accvgpr_write_b32 a98, v251
  v_accvgpr_write_b32 a99, v14
  v_accvgpr_read_b32 v249, a100
  v_accvgpr_read_b32 v250, a101
  v_accvgpr_read_b32 v251, a102
  v_accvgpr_read_b32 v14, a103
  v_mul_f32 v249, v249, v244
  v_mul_f32 v250, v250, v244
  v_mul_f32 v251, v251, v244
  v_mul_f32 v14, v14, v244
  v_accvgpr_write_b32 a100, v249
  v_accvgpr_write_b32 a101, v250
  v_accvgpr_write_b32 a102, v251
  v_accvgpr_write_b32 a103, v14
  v_accvgpr_read_b32 v249, a104
  v_accvgpr_read_b32 v250, a105
  v_accvgpr_read_b32 v251, a106
  v_accvgpr_read_b32 v14, a107
  v_mul_f32 v249, v249, v244
  v_mul_f32 v250, v250, v244
  v_mul_f32 v251, v251, v244
  v_mul_f32 v14, v14, v244
  v_accvgpr_write_b32 a104, v249
  v_accvgpr_write_b32 a105, v250
  v_accvgpr_write_b32 a106, v251
  v_accvgpr_write_b32 a107, v14
  v_accvgpr_read_b32 v249, a108
  v_accvgpr_read_b32 v250, a109
  v_accvgpr_read_b32 v251, a110
  v_accvgpr_read_b32 v14, a111
  v_mul_f32 v249, v249, v244
  v_mul_f32 v250, v250, v244
  v_mul_f32 v251, v251, v244
  v_mul_f32 v14, v14, v244
  v_accvgpr_write_b32 a108, v249
  v_accvgpr_write_b32 a109, v250
  v_accvgpr_write_b32 a110, v251
  v_accvgpr_write_b32 a111, v14
  v_accvgpr_read_b32 v249, a112
  v_accvgpr_read_b32 v250, a113
  v_accvgpr_read_b32 v251, a114
  v_accvgpr_read_b32 v14, a115
  v_mul_f32 v249, v249, v244
  v_mul_f32 v250, v250, v244
  v_mul_f32 v251, v251, v244
  v_mul_f32 v14, v14, v244
  v_accvgpr_write_b32 a112, v249
  v_accvgpr_write_b32 a113, v250
  v_accvgpr_write_b32 a114, v251
  v_accvgpr_write_b32 a115, v14
  v_accvgpr_read_b32 v249, a116
  v_accvgpr_read_b32 v250, a117
  v_accvgpr_read_b32 v251, a118
  v_accvgpr_read_b32 v14, a119
  v_mul_f32 v249, v249, v244
  v_mul_f32 v250, v250, v244
  v_mul_f32 v251, v251, v244
  v_mul_f32 v14, v14, v244
  v_accvgpr_write_b32 a116, v249
  v_accvgpr_write_b32 a117, v250
  v_accvgpr_write_b32 a118, v251
  v_accvgpr_write_b32 a119, v14
  v_accvgpr_read_b32 v249, a120
  v_accvgpr_read_b32 v250, a121
  v_accvgpr_read_b32 v251, a122
  v_accvgpr_read_b32 v14, a123
  v_mul_f32 v249, v249, v244
  v_mul_f32 v250, v250, v244
  v_mul_f32 v251, v251, v244
  v_mul_f32 v14, v14, v244
  v_accvgpr_write_b32 a120, v249
  v_accvgpr_write_b32 a121, v250
  v_accvgpr_write_b32 a122, v251
  v_accvgpr_write_b32 a123, v14
  v_accvgpr_read_b32 v249, a124
  v_accvgpr_read_b32 v250, a125
  v_accvgpr_read_b32 v251, a126
  v_accvgpr_read_b32 v14, a127
  v_mul_f32 v249, v249, v244
  v_mul_f32 v250, v250, v244
  v_mul_f32 v251, v251, v244
  v_mul_f32 v14, v14, v244
  v_accvgpr_write_b32 a124, v249
  v_accvgpr_write_b32 a125, v250
  v_accvgpr_write_b32 a126, v251
  v_accvgpr_write_b32 a127, v14
  v_accvgpr_read_b32 v249, a128
  v_accvgpr_read_b32 v250, a129
  v_accvgpr_read_b32 v251, a130
  v_accvgpr_read_b32 v14, a131
  v_mul_f32 v249, v249, v245
  v_mul_f32 v250, v250, v245
  v_mul_f32 v251, v251, v245
  v_mul_f32 v14, v14, v245
  v_accvgpr_write_b32 a128, v249
  v_accvgpr_write_b32 a129, v250
  v_accvgpr_write_b32 a130, v251
  v_accvgpr_write_b32 a131, v14
  v_accvgpr_read_b32 v249, a132
  v_accvgpr_read_b32 v250, a133
  v_accvgpr_read_b32 v251, a134
  v_accvgpr_read_b32 v14, a135
  v_mul_f32 v249, v249, v245
  v_mul_f32 v250, v250, v245
  v_mul_f32 v251, v251, v245
  v_mul_f32 v14, v14, v245
  v_accvgpr_write_b32 a132, v249
  v_accvgpr_write_b32 a133, v250
  v_accvgpr_write_b32 a134, v251
  v_accvgpr_write_b32 a135, v14
  v_accvgpr_read_b32 v249, a136
  v_accvgpr_read_b32 v250, a137
  v_accvgpr_read_b32 v251, a138
  v_accvgpr_read_b32 v14, a139
  v_mul_f32 v249, v249, v245
  v_mul_f32 v250, v250, v245
  v_mul_f32 v251, v251, v245
  v_mul_f32 v14, v14, v245
  v_accvgpr_write_b32 a136, v249
  v_accvgpr_write_b32 a137, v250
  v_accvgpr_write_b32 a138, v251
  v_accvgpr_write_b32 a139, v14
  v_accvgpr_read_b32 v249, a140
  v_accvgpr_read_b32 v250, a141
  v_accvgpr_read_b32 v251, a142
  v_accvgpr_read_b32 v14, a143
  v_mul_f32 v249, v249, v245
  v_mul_f32 v250, v250, v245
  v_mul_f32 v251, v251, v245
  v_mul_f32 v14, v14, v245
  v_accvgpr_write_b32 a140, v249
  v_accvgpr_write_b32 a141, v250
  v_accvgpr_write_b32 a142, v251
  v_accvgpr_write_b32 a143, v14
  v_accvgpr_read_b32 v249, a144
  v_accvgpr_read_b32 v250, a145
  v_accvgpr_read_b32 v251, a146
  v_accvgpr_read_b32 v14, a147
  v_mul_f32 v249, v249, v245
  v_mul_f32 v250, v250, v245
  v_mul_f32 v251, v251, v245
  v_mul_f32 v14, v14, v245
  v_accvgpr_write_b32 a144, v249
  v_accvgpr_write_b32 a145, v250
  v_accvgpr_write_b32 a146, v251
  v_accvgpr_write_b32 a147, v14
  v_accvgpr_read_b32 v249, a148
  v_accvgpr_read_b32 v250, a149
  v_accvgpr_read_b32 v251, a150
  v_accvgpr_read_b32 v14, a151
  v_mul_f32 v249, v249, v245
  v_mul_f32 v250, v250, v245
  v_mul_f32 v251, v251, v245
  v_mul_f32 v14, v14, v245
  v_accvgpr_write_b32 a148, v249
  v_accvgpr_write_b32 a149, v250
  v_accvgpr_write_b32 a150, v251
  v_accvgpr_write_b32 a151, v14
  v_accvgpr_read_b32 v249, a152
  v_accvgpr_read_b32 v250, a153
  v_accvgpr_read_b32 v251, a154
  v_accvgpr_read_b32 v14, a155
  v_mul_f32 v249, v249, v245
  v_mul_f32 v250, v250, v245
  v_mul_f32 v251, v251, v245
  v_mul_f32 v14, v14, v245
  v_accvgpr_write_b32 a152, v249
  v_accvgpr_write_b32 a153, v250
  v_accvgpr_write_b32 a154, v251
  v_accvgpr_write_b32 a155, v14
  v_accvgpr_read_b32 v249, a156
  v_accvgpr_read_b32 v250, a157
  v_accvgpr_read_b32 v251, a158
  v_accvgpr_read_b32 v14, a159
  v_mul_f32 v249, v249, v245
  v_mul_f32 v250, v250, v245
  v_mul_f32 v251, v251, v245
  v_mul_f32 v14, v14, v245
  v_accvgpr_write_b32 a156, v249
  v_accvgpr_write_b32 a157, v250
  v_accvgpr_write_b32 a158, v251
  v_accvgpr_write_b32 a159, v14
  v_accvgpr_read_b32 v249, a160
  v_accvgpr_read_b32 v250, a161
  v_accvgpr_read_b32 v251, a162
  v_accvgpr_read_b32 v14, a163
  v_mul_f32 v249, v249, v245
  v_mul_f32 v250, v250, v245
  v_mul_f32 v251, v251, v245
  v_mul_f32 v14, v14, v245
  v_accvgpr_write_b32 a160, v249
  v_accvgpr_write_b32 a161, v250
  v_accvgpr_write_b32 a162, v251
  v_accvgpr_write_b32 a163, v14
  v_accvgpr_read_b32 v249, a164
  v_accvgpr_read_b32 v250, a165
  v_accvgpr_read_b32 v251, a166
  v_accvgpr_read_b32 v14, a167
  v_mul_f32 v249, v249, v245
  v_mul_f32 v250, v250, v245
  v_mul_f32 v251, v251, v245
  v_mul_f32 v14, v14, v245
  v_accvgpr_write_b32 a164, v249
  v_accvgpr_write_b32 a165, v250
  v_accvgpr_write_b32 a166, v251
  v_accvgpr_write_b32 a167, v14
  v_accvgpr_read_b32 v249, a168
  v_accvgpr_read_b32 v250, a169
  v_accvgpr_read_b32 v251, a170
  v_accvgpr_read_b32 v14, a171
  v_mul_f32 v249, v249, v245
  v_mul_f32 v250, v250, v245
  v_mul_f32 v251, v251, v245
  v_mul_f32 v14, v14, v245
  v_accvgpr_write_b32 a168, v249
  v_accvgpr_write_b32 a169, v250
  v_accvgpr_write_b32 a170, v251
  v_accvgpr_write_b32 a171, v14
  v_accvgpr_read_b32 v249, a172
  v_accvgpr_read_b32 v250, a173
  v_accvgpr_read_b32 v251, a174
  v_accvgpr_read_b32 v14, a175
  v_mul_f32 v249, v249, v245
  v_mul_f32 v250, v250, v245
  v_mul_f32 v251, v251, v245
  v_mul_f32 v14, v14, v245
  v_accvgpr_write_b32 a172, v249
  v_accvgpr_write_b32 a173, v250
  v_accvgpr_write_b32 a174, v251
  v_accvgpr_write_b32 a175, v14
  v_accvgpr_read_b32 v249, a176
  v_accvgpr_read_b32 v250, a177
  v_accvgpr_read_b32 v251, a178
  v_accvgpr_read_b32 v14, a179
  v_mul_f32 v249, v249, v245
  v_mul_f32 v250, v250, v245
  v_mul_f32 v251, v251, v245
  v_mul_f32 v14, v14, v245
  v_accvgpr_write_b32 a176, v249
  v_accvgpr_write_b32 a177, v250
  v_accvgpr_write_b32 a178, v251
  v_accvgpr_write_b32 a179, v14
  v_accvgpr_read_b32 v249, a180
  v_accvgpr_read_b32 v250, a181
  v_accvgpr_read_b32 v251, a182
  v_accvgpr_read_b32 v14, a183
  v_mul_f32 v249, v249, v245
  v_mul_f32 v250, v250, v245
  v_mul_f32 v251, v251, v245
  v_mul_f32 v14, v14, v245
  v_accvgpr_write_b32 a180, v249
  v_accvgpr_write_b32 a181, v250
  v_accvgpr_write_b32 a182, v251
  v_accvgpr_write_b32 a183, v14
  v_accvgpr_read_b32 v249, a184
  v_accvgpr_read_b32 v250, a185
  v_accvgpr_read_b32 v251, a186
  v_accvgpr_read_b32 v14, a187
  v_mul_f32 v249, v249, v245
  v_mul_f32 v250, v250, v245
  v_mul_f32 v251, v251, v245
  v_mul_f32 v14, v14, v245
  v_accvgpr_write_b32 a184, v249
  v_accvgpr_write_b32 a185, v250
  v_accvgpr_write_b32 a186, v251
  v_accvgpr_write_b32 a187, v14
  v_accvgpr_read_b32 v249, a188
  v_accvgpr_read_b32 v250, a189
  v_accvgpr_read_b32 v251, a190
  v_accvgpr_read_b32 v14, a191
  v_mul_f32 v249, v249, v245
  v_mul_f32 v250, v250, v245
  v_mul_f32 v251, v251, v245
  v_mul_f32 v14, v14, v245
  v_accvgpr_write_b32 a188, v249
  v_accvgpr_write_b32 a189, v250
  v_accvgpr_write_b32 a190, v251
  v_accvgpr_write_b32 a191, v14
  s_mov_b32 s52, 0
  s_nop 3
  s_branch L_attn_rsret4
L_attn_rs5:
  s_nop 15
  v_accvgpr_read_b32 v249, a0
  v_accvgpr_read_b32 v250, a1
  v_accvgpr_read_b32 v251, a2
  v_accvgpr_read_b32 v14, a3
  v_mul_f32 v249, v249, v243
  v_mul_f32 v250, v250, v243
  v_mul_f32 v251, v251, v243
  v_mul_f32 v14, v14, v243
  v_accvgpr_write_b32 a0, v249
  v_accvgpr_write_b32 a1, v250
  v_accvgpr_write_b32 a2, v251
  v_accvgpr_write_b32 a3, v14
  v_accvgpr_read_b32 v249, a4
  v_accvgpr_read_b32 v250, a5
  v_accvgpr_read_b32 v251, a6
  v_accvgpr_read_b32 v14, a7
  v_mul_f32 v249, v249, v243
  v_mul_f32 v250, v250, v243
  v_mul_f32 v251, v251, v243
  v_mul_f32 v14, v14, v243
  v_accvgpr_write_b32 a4, v249
  v_accvgpr_write_b32 a5, v250
  v_accvgpr_write_b32 a6, v251
  v_accvgpr_write_b32 a7, v14
  v_accvgpr_read_b32 v249, a8
  v_accvgpr_read_b32 v250, a9
  v_accvgpr_read_b32 v251, a10
  v_accvgpr_read_b32 v14, a11
  v_mul_f32 v249, v249, v243
  v_mul_f32 v250, v250, v243
  v_mul_f32 v251, v251, v243
  v_mul_f32 v14, v14, v243
  v_accvgpr_write_b32 a8, v249
  v_accvgpr_write_b32 a9, v250
  v_accvgpr_write_b32 a10, v251
  v_accvgpr_write_b32 a11, v14
  v_accvgpr_read_b32 v249, a12
  v_accvgpr_read_b32 v250, a13
  v_accvgpr_read_b32 v251, a14
  v_accvgpr_read_b32 v14, a15
  v_mul_f32 v249, v249, v243
  v_mul_f32 v250, v250, v243
  v_mul_f32 v251, v251, v243
  v_mul_f32 v14, v14, v243
  v_accvgpr_write_b32 a12, v249
  v_accvgpr_write_b32 a13, v250
  v_accvgpr_write_b32 a14, v251
  v_accvgpr_write_b32 a15, v14
  v_accvgpr_read_b32 v249, a16
  v_accvgpr_read_b32 v250, a17
  v_accvgpr_read_b32 v251, a18
  v_accvgpr_read_b32 v14, a19
  v_mul_f32 v249, v249, v243
  v_mul_f32 v250, v250, v243
  v_mul_f32 v251, v251, v243
  v_mul_f32 v14, v14, v243
  v_accvgpr_write_b32 a16, v249
  v_accvgpr_write_b32 a17, v250
  v_accvgpr_write_b32 a18, v251
  v_accvgpr_write_b32 a19, v14
  v_accvgpr_read_b32 v249, a20
  v_accvgpr_read_b32 v250, a21
  v_accvgpr_read_b32 v251, a22
  v_accvgpr_read_b32 v14, a23
  v_mul_f32 v249, v249, v243
  v_mul_f32 v250, v250, v243
  v_mul_f32 v251, v251, v243
  v_mul_f32 v14, v14, v243
  v_accvgpr_write_b32 a20, v249
  v_accvgpr_write_b32 a21, v250
  v_accvgpr_write_b32 a22, v251
  v_accvgpr_write_b32 a23, v14
  v_accvgpr_read_b32 v249, a24
  v_accvgpr_read_b32 v250, a25
  v_accvgpr_read_b32 v251, a26
  v_accvgpr_read_b32 v14, a27
  v_mul_f32 v249, v249, v243
  v_mul_f32 v250, v250, v243
  v_mul_f32 v251, v251, v243
  v_mul_f32 v14, v14, v243
  v_accvgpr_write_b32 a24, v249
  v_accvgpr_write_b32 a25, v250
  v_accvgpr_write_b32 a26, v251
  v_accvgpr_write_b32 a27, v14
  v_accvgpr_read_b32 v249, a28
  v_accvgpr_read_b32 v250, a29
  v_accvgpr_read_b32 v251, a30
  v_accvgpr_read_b32 v14, a31
  v_mul_f32 v249, v249, v243
  v_mul_f32 v250, v250, v243
  v_mul_f32 v251, v251, v243
  v_mul_f32 v14, v14, v243
  v_accvgpr_write_b32 a28, v249
  v_accvgpr_write_b32 a29, v250
  v_accvgpr_write_b32 a30, v251
  v_accvgpr_write_b32 a31, v14
  v_accvgpr_read_b32 v249, a32
  v_accvgpr_read_b32 v250, a33
  v_accvgpr_read_b32 v251, a34
  v_accvgpr_read_b32 v14, a35
  v_mul_f32 v249, v249, v243
  v_mul_f32 v250, v250, v243
  v_mul_f32 v251, v251, v243
  v_mul_f32 v14, v14, v243
  v_accvgpr_write_b32 a32, v249
  v_accvgpr_write_b32 a33, v250
  v_accvgpr_write_b32 a34, v251
  v_accvgpr_write_b32 a35, v14
  v_accvgpr_read_b32 v249, a36
  v_accvgpr_read_b32 v250, a37
  v_accvgpr_read_b32 v251, a38
  v_accvgpr_read_b32 v14, a39
  v_mul_f32 v249, v249, v243
  v_mul_f32 v250, v250, v243
  v_mul_f32 v251, v251, v243
  v_mul_f32 v14, v14, v243
  v_accvgpr_write_b32 a36, v249
  v_accvgpr_write_b32 a37, v250
  v_accvgpr_write_b32 a38, v251
  v_accvgpr_write_b32 a39, v14
  v_accvgpr_read_b32 v249, a40
  v_accvgpr_read_b32 v250, a41
  v_accvgpr_read_b32 v251, a42
  v_accvgpr_read_b32 v14, a43
  v_mul_f32 v249, v249, v243
  v_mul_f32 v250, v250, v243
  v_mul_f32 v251, v251, v243
  v_mul_f32 v14, v14, v243
  v_accvgpr_write_b32 a40, v249
  v_accvgpr_write_b32 a41, v250
  v_accvgpr_write_b32 a42, v251
  v_accvgpr_write_b32 a43, v14
  v_accvgpr_read_b32 v249, a44
  v_accvgpr_read_b32 v250, a45
  v_accvgpr_read_b32 v251, a46
  v_accvgpr_read_b32 v14, a47
  v_mul_f32 v249, v249, v243
  v_mul_f32 v250, v250, v243
  v_mul_f32 v251, v251, v243
  v_mul_f32 v14, v14, v243
  v_accvgpr_write_b32 a44, v249
  v_accvgpr_write_b32 a45, v250
  v_accvgpr_write_b32 a46, v251
  v_accvgpr_write_b32 a47, v14
  v_accvgpr_read_b32 v249, a48
  v_accvgpr_read_b32 v250, a49
  v_accvgpr_read_b32 v251, a50
  v_accvgpr_read_b32 v14, a51
  v_mul_f32 v249, v249, v243
  v_mul_f32 v250, v250, v243
  v_mul_f32 v251, v251, v243
  v_mul_f32 v14, v14, v243
  v_accvgpr_write_b32 a48, v249
  v_accvgpr_write_b32 a49, v250
  v_accvgpr_write_b32 a50, v251
  v_accvgpr_write_b32 a51, v14
  v_accvgpr_read_b32 v249, a52
  v_accvgpr_read_b32 v250, a53
  v_accvgpr_read_b32 v251, a54
  v_accvgpr_read_b32 v14, a55
  v_mul_f32 v249, v249, v243
  v_mul_f32 v250, v250, v243
  v_mul_f32 v251, v251, v243
  v_mul_f32 v14, v14, v243
  v_accvgpr_write_b32 a52, v249
  v_accvgpr_write_b32 a53, v250
  v_accvgpr_write_b32 a54, v251
  v_accvgpr_write_b32 a55, v14
  v_accvgpr_read_b32 v249, a56
  v_accvgpr_read_b32 v250, a57
  v_accvgpr_read_b32 v251, a58
  v_accvgpr_read_b32 v14, a59
  v_mul_f32 v249, v249, v243
  v_mul_f32 v250, v250, v243
  v_mul_f32 v251, v251, v243
  v_mul_f32 v14, v14, v243
  v_accvgpr_write_b32 a56, v249
  v_accvgpr_write_b32 a57, v250
  v_accvgpr_write_b32 a58, v251
  v_accvgpr_write_b32 a59, v14
  v_accvgpr_read_b32 v249, a60
  v_accvgpr_read_b32 v250, a61
  v_accvgpr_read_b32 v251, a62
  v_accvgpr_read_b32 v14, a63
  v_mul_f32 v249, v249, v243
  v_mul_f32 v250, v250, v243
  v_mul_f32 v251, v251, v243
  v_mul_f32 v14, v14, v243
  v_accvgpr_write_b32 a60, v249
  v_accvgpr_write_b32 a61, v250
  v_accvgpr_write_b32 a62, v251
  v_accvgpr_write_b32 a63, v14
  v_accvgpr_read_b32 v249, a64
  v_accvgpr_read_b32 v250, a65
  v_accvgpr_read_b32 v251, a66
  v_accvgpr_read_b32 v14, a67
  v_mul_f32 v249, v249, v244
  v_mul_f32 v250, v250, v244
  v_mul_f32 v251, v251, v244
  v_mul_f32 v14, v14, v244
  v_accvgpr_write_b32 a64, v249
  v_accvgpr_write_b32 a65, v250
  v_accvgpr_write_b32 a66, v251
  v_accvgpr_write_b32 a67, v14
  v_accvgpr_read_b32 v249, a68
  v_accvgpr_read_b32 v250, a69
  v_accvgpr_read_b32 v251, a70
  v_accvgpr_read_b32 v14, a71
  v_mul_f32 v249, v249, v244
  v_mul_f32 v250, v250, v244
  v_mul_f32 v251, v251, v244
  v_mul_f32 v14, v14, v244
  v_accvgpr_write_b32 a68, v249
  v_accvgpr_write_b32 a69, v250
  v_accvgpr_write_b32 a70, v251
  v_accvgpr_write_b32 a71, v14
  v_accvgpr_read_b32 v249, a72
  v_accvgpr_read_b32 v250, a73
  v_accvgpr_read_b32 v251, a74
  v_accvgpr_read_b32 v14, a75
  v_mul_f32 v249, v249, v244
  v_mul_f32 v250, v250, v244
  v_mul_f32 v251, v251, v244
  v_mul_f32 v14, v14, v244
  v_accvgpr_write_b32 a72, v249
  v_accvgpr_write_b32 a73, v250
  v_accvgpr_write_b32 a74, v251
  v_accvgpr_write_b32 a75, v14
  v_accvgpr_read_b32 v249, a76
  v_accvgpr_read_b32 v250, a77
  v_accvgpr_read_b32 v251, a78
  v_accvgpr_read_b32 v14, a79
  v_mul_f32 v249, v249, v244
  v_mul_f32 v250, v250, v244
  v_mul_f32 v251, v251, v244
  v_mul_f32 v14, v14, v244
  v_accvgpr_write_b32 a76, v249
  v_accvgpr_write_b32 a77, v250
  v_accvgpr_write_b32 a78, v251
  v_accvgpr_write_b32 a79, v14
  v_accvgpr_read_b32 v249, a80
  v_accvgpr_read_b32 v250, a81
  v_accvgpr_read_b32 v251, a82
  v_accvgpr_read_b32 v14, a83
  v_mul_f32 v249, v249, v244
  v_mul_f32 v250, v250, v244
  v_mul_f32 v251, v251, v244
  v_mul_f32 v14, v14, v244
  v_accvgpr_write_b32 a80, v249
  v_accvgpr_write_b32 a81, v250
  v_accvgpr_write_b32 a82, v251
  v_accvgpr_write_b32 a83, v14
  v_accvgpr_read_b32 v249, a84
  v_accvgpr_read_b32 v250, a85
  v_accvgpr_read_b32 v251, a86
  v_accvgpr_read_b32 v14, a87
  v_mul_f32 v249, v249, v244
  v_mul_f32 v250, v250, v244
  v_mul_f32 v251, v251, v244
  v_mul_f32 v14, v14, v244
  v_accvgpr_write_b32 a84, v249
  v_accvgpr_write_b32 a85, v250
  v_accvgpr_write_b32 a86, v251
  v_accvgpr_write_b32 a87, v14
  v_accvgpr_read_b32 v249, a88
  v_accvgpr_read_b32 v250, a89
  v_accvgpr_read_b32 v251, a90
  v_accvgpr_read_b32 v14, a91
  v_mul_f32 v249, v249, v244
  v_mul_f32 v250, v250, v244
  v_mul_f32 v251, v251, v244
  v_mul_f32 v14, v14, v244
  v_accvgpr_write_b32 a88, v249
  v_accvgpr_write_b32 a89, v250
  v_accvgpr_write_b32 a90, v251
  v_accvgpr_write_b32 a91, v14
  v_accvgpr_read_b32 v249, a92
  v_accvgpr_read_b32 v250, a93
  v_accvgpr_read_b32 v251, a94
  v_accvgpr_read_b32 v14, a95
  v_mul_f32 v249, v249, v244
  v_mul_f32 v250, v250, v244
  v_mul_f32 v251, v251, v244
  v_mul_f32 v14, v14, v244
  v_accvgpr_write_b32 a92, v249
  v_accvgpr_write_b32 a93, v250
  v_accvgpr_write_b32 a94, v251
  v_accvgpr_write_b32 a95, v14
  v_accvgpr_read_b32 v249, a96
  v_accvgpr_read_b32 v250, a97
  v_accvgpr_read_b32 v251, a98
  v_accvgpr_read_b32 v14, a99
  v_mul_f32 v249, v249, v244
  v_mul_f32 v250, v250, v244
  v_mul_f32 v251, v251, v244
  v_mul_f32 v14, v14, v244
  v_accvgpr_write_b32 a96, v249
  v_accvgpr_write_b32 a97, v250
  v_accvgpr_write_b32 a98, v251
  v_accvgpr_write_b32 a99, v14
  v_accvgpr_read_b32 v249, a100
  v_accvgpr_read_b32 v250, a101
  v_accvgpr_read_b32 v251, a102
  v_accvgpr_read_b32 v14, a103
  v_mul_f32 v249, v249, v244
  v_mul_f32 v250, v250, v244
  v_mul_f32 v251, v251, v244
  v_mul_f32 v14, v14, v244
  v_accvgpr_write_b32 a100, v249
  v_accvgpr_write_b32 a101, v250
  v_accvgpr_write_b32 a102, v251
  v_accvgpr_write_b32 a103, v14
  v_accvgpr_read_b32 v249, a104
  v_accvgpr_read_b32 v250, a105
  v_accvgpr_read_b32 v251, a106
  v_accvgpr_read_b32 v14, a107
  v_mul_f32 v249, v249, v244
  v_mul_f32 v250, v250, v244
  v_mul_f32 v251, v251, v244
  v_mul_f32 v14, v14, v244
  v_accvgpr_write_b32 a104, v249
  v_accvgpr_write_b32 a105, v250
  v_accvgpr_write_b32 a106, v251
  v_accvgpr_write_b32 a107, v14
  v_accvgpr_read_b32 v249, a108
  v_accvgpr_read_b32 v250, a109
  v_accvgpr_read_b32 v251, a110
  v_accvgpr_read_b32 v14, a111
  v_mul_f32 v249, v249, v244
  v_mul_f32 v250, v250, v244
  v_mul_f32 v251, v251, v244
  v_mul_f32 v14, v14, v244
  v_accvgpr_write_b32 a108, v249
  v_accvgpr_write_b32 a109, v250
  v_accvgpr_write_b32 a110, v251
  v_accvgpr_write_b32 a111, v14
  v_accvgpr_read_b32 v249, a112
  v_accvgpr_read_b32 v250, a113
  v_accvgpr_read_b32 v251, a114
  v_accvgpr_read_b32 v14, a115
  v_mul_f32 v249, v249, v244
  v_mul_f32 v250, v250, v244
  v_mul_f32 v251, v251, v244
  v_mul_f32 v14, v14, v244
  v_accvgpr_write_b32 a112, v249
  v_accvgpr_write_b32 a113, v250
  v_accvgpr_write_b32 a114, v251
  v_accvgpr_write_b32 a115, v14
  v_accvgpr_read_b32 v249, a116
  v_accvgpr_read_b32 v250, a117
  v_accvgpr_read_b32 v251, a118
  v_accvgpr_read_b32 v14, a119
  v_mul_f32 v249, v249, v244
  v_mul_f32 v250, v250, v244
  v_mul_f32 v251, v251, v244
  v_mul_f32 v14, v14, v244
  v_accvgpr_write_b32 a116, v249
  v_accvgpr_write_b32 a117, v250
  v_accvgpr_write_b32 a118, v251
  v_accvgpr_write_b32 a119, v14
  v_accvgpr_read_b32 v249, a120
  v_accvgpr_read_b32 v250, a121
  v_accvgpr_read_b32 v251, a122
  v_accvgpr_read_b32 v14, a123
  v_mul_f32 v249, v249, v244
  v_mul_f32 v250, v250, v244
  v_mul_f32 v251, v251, v244
  v_mul_f32 v14, v14, v244
  v_accvgpr_write_b32 a120, v249
  v_accvgpr_write_b32 a121, v250
  v_accvgpr_write_b32 a122, v251
  v_accvgpr_write_b32 a123, v14
  v_accvgpr_read_b32 v249, a124
  v_accvgpr_read_b32 v250, a125
  v_accvgpr_read_b32 v251, a126
  v_accvgpr_read_b32 v14, a127
  v_mul_f32 v249, v249, v244
  v_mul_f32 v250, v250, v244
  v_mul_f32 v251, v251, v244
  v_mul_f32 v14, v14, v244
  v_accvgpr_write_b32 a124, v249
  v_accvgpr_write_b32 a125, v250
  v_accvgpr_write_b32 a126, v251
  v_accvgpr_write_b32 a127, v14
  v_accvgpr_read_b32 v249, a128
  v_accvgpr_read_b32 v250, a129
  v_accvgpr_read_b32 v251, a130
  v_accvgpr_read_b32 v14, a131
  v_mul_f32 v249, v249, v245
  v_mul_f32 v250, v250, v245
  v_mul_f32 v251, v251, v245
  v_mul_f32 v14, v14, v245
  v_accvgpr_write_b32 a128, v249
  v_accvgpr_write_b32 a129, v250
  v_accvgpr_write_b32 a130, v251
  v_accvgpr_write_b32 a131, v14
  v_accvgpr_read_b32 v249, a132
  v_accvgpr_read_b32 v250, a133
  v_accvgpr_read_b32 v251, a134
  v_accvgpr_read_b32 v14, a135
  v_mul_f32 v249, v249, v245
  v_mul_f32 v250, v250, v245
  v_mul_f32 v251, v251, v245
  v_mul_f32 v14, v14, v245
  v_accvgpr_write_b32 a132, v249
  v_accvgpr_write_b32 a133, v250
  v_accvgpr_write_b32 a134, v251
  v_accvgpr_write_b32 a135, v14
  v_accvgpr_read_b32 v249, a136
  v_accvgpr_read_b32 v250, a137
  v_accvgpr_read_b32 v251, a138
  v_accvgpr_read_b32 v14, a139
  v_mul_f32 v249, v249, v245
  v_mul_f32 v250, v250, v245
  v_mul_f32 v251, v251, v245
  v_mul_f32 v14, v14, v245
  v_accvgpr_write_b32 a136, v249
  v_accvgpr_write_b32 a137, v250
  v_accvgpr_write_b32 a138, v251
  v_accvgpr_write_b32 a139, v14
  v_accvgpr_read_b32 v249, a140
  v_accvgpr_read_b32 v250, a141
  v_accvgpr_read_b32 v251, a142
  v_accvgpr_read_b32 v14, a143
  v_mul_f32 v249, v249, v245
  v_mul_f32 v250, v250, v245
  v_mul_f32 v251, v251, v245
  v_mul_f32 v14, v14, v245
  v_accvgpr_write_b32 a140, v249
  v_accvgpr_write_b32 a141, v250
  v_accvgpr_write_b32 a142, v251
  v_accvgpr_write_b32 a143, v14
  v_accvgpr_read_b32 v249, a144
  v_accvgpr_read_b32 v250, a145
  v_accvgpr_read_b32 v251, a146
  v_accvgpr_read_b32 v14, a147
  v_mul_f32 v249, v249, v245
  v_mul_f32 v250, v250, v245
  v_mul_f32 v251, v251, v245
  v_mul_f32 v14, v14, v245
  v_accvgpr_write_b32 a144, v249
  v_accvgpr_write_b32 a145, v250
  v_accvgpr_write_b32 a146, v251
  v_accvgpr_write_b32 a147, v14
  v_accvgpr_read_b32 v249, a148
  v_accvgpr_read_b32 v250, a149
  v_accvgpr_read_b32 v251, a150
  v_accvgpr_read_b32 v14, a151
  v_mul_f32 v249, v249, v245
  v_mul_f32 v250, v250, v245
  v_mul_f32 v251, v251, v245
  v_mul_f32 v14, v14, v245
  v_accvgpr_write_b32 a148, v249
  v_accvgpr_write_b32 a149, v250
  v_accvgpr_write_b32 a150, v251
  v_accvgpr_write_b32 a151, v14
  v_accvgpr_read_b32 v249, a152
  v_accvgpr_read_b32 v250, a153
  v_accvgpr_read_b32 v251, a154
  v_accvgpr_read_b32 v14, a155
  v_mul_f32 v249, v249, v245
  v_mul_f32 v250, v250, v245
  v_mul_f32 v251, v251, v245
  v_mul_f32 v14, v14, v245
  v_accvgpr_write_b32 a152, v249
  v_accvgpr_write_b32 a153, v250
  v_accvgpr_write_b32 a154, v251
  v_accvgpr_write_b32 a155, v14
  v_accvgpr_read_b32 v249, a156
  v_accvgpr_read_b32 v250, a157
  v_accvgpr_read_b32 v251, a158
  v_accvgpr_read_b32 v14, a159
  v_mul_f32 v249, v249, v245
  v_mul_f32 v250, v250, v245
  v_mul_f32 v251, v251, v245
  v_mul_f32 v14, v14, v245
  v_accvgpr_write_b32 a156, v249
  v_accvgpr_write_b32 a157, v250
  v_accvgpr_write_b32 a158, v251
  v_accvgpr_write_b32 a159, v14
  v_accvgpr_read_b32 v249, a160
  v_accvgpr_read_b32 v250, a161
  v_accvgpr_read_b32 v251, a162
  v_accvgpr_read_b32 v14, a163
  v_mul_f32 v249, v249, v245
  v_mul_f32 v250, v250, v245
  v_mul_f32 v251, v251, v245
  v_mul_f32 v14, v14, v245
  v_accvgpr_write_b32 a160, v249
  v_accvgpr_write_b32 a161, v250
  v_accvgpr_write_b32 a162, v251
  v_accvgpr_write_b32 a163, v14
  v_accvgpr_read_b32 v249, a164
  v_accvgpr_read_b32 v250, a165
  v_accvgpr_read_b32 v251, a166
  v_accvgpr_read_b32 v14, a167
  v_mul_f32 v249, v249, v245
  v_mul_f32 v250, v250, v245
  v_mul_f32 v251, v251, v245
  v_mul_f32 v14, v14, v245
  v_accvgpr_write_b32 a164, v249
  v_accvgpr_write_b32 a165, v250
  v_accvgpr_write_b32 a166, v251
  v_accvgpr_write_b32 a167, v14
  v_accvgpr_read_b32 v249, a168
  v_accvgpr_read_b32 v250, a169
  v_accvgpr_read_b32 v251, a170
  v_accvgpr_read_b32 v14, a171
  v_mul_f32 v249, v249, v245
  v_mul_f32 v250, v250, v245
  v_mul_f32 v251, v251, v245
  v_mul_f32 v14, v14, v245
  v_accvgpr_write_b32 a168, v249
  v_accvgpr_write_b32 a169, v250
  v_accvgpr_write_b32 a170, v251
  v_accvgpr_write_b32 a171, v14
  v_accvgpr_read_b32 v249, a172
  v_accvgpr_read_b32 v250, a173
  v_accvgpr_read_b32 v251, a174
  v_accvgpr_read_b32 v14, a175
  v_mul_f32 v249, v249, v245
  v_mul_f32 v250, v250, v245
  v_mul_f32 v251, v251, v245
  v_mul_f32 v14, v14, v245
  v_accvgpr_write_b32 a172, v249
  v_accvgpr_write_b32 a173, v250
  v_accvgpr_write_b32 a174, v251
  v_accvgpr_write_b32 a175, v14
  v_accvgpr_read_b32 v249, a176
  v_accvgpr_read_b32 v250, a177
  v_accvgpr_read_b32 v251, a178
  v_accvgpr_read_b32 v14, a179
  v_mul_f32 v249, v249, v245
  v_mul_f32 v250, v250, v245
  v_mul_f32 v251, v251, v245
  v_mul_f32 v14, v14, v245
  v_accvgpr_write_b32 a176, v249
  v_accvgpr_write_b32 a177, v250
  v_accvgpr_write_b32 a178, v251
  v_accvgpr_write_b32 a179, v14
  v_accvgpr_read_b32 v249, a180
  v_accvgpr_read_b32 v250, a181
  v_accvgpr_read_b32 v251, a182
  v_accvgpr_read_b32 v14, a183
  v_mul_f32 v249, v249, v245
  v_mul_f32 v250, v250, v245
  v_mul_f32 v251, v251, v245
  v_mul_f32 v14, v14, v245
  v_accvgpr_write_b32 a180, v249
  v_accvgpr_write_b32 a181, v250
  v_accvgpr_write_b32 a182, v251
  v_accvgpr_write_b32 a183, v14
  v_accvgpr_read_b32 v249, a184
  v_accvgpr_read_b32 v250, a185
  v_accvgpr_read_b32 v251, a186
  v_accvgpr_read_b32 v14, a187
  v_mul_f32 v249, v249, v245
  v_mul_f32 v250, v250, v245
  v_mul_f32 v251, v251, v245
  v_mul_f32 v14, v14, v245
  v_accvgpr_write_b32 a184, v249
  v_accvgpr_write_b32 a185, v250
  v_accvgpr_write_b32 a186, v251
  v_accvgpr_write_b32 a187, v14
  v_accvgpr_read_b32 v249, a188
  v_accvgpr_read_b32 v250, a189
  v_accvgpr_read_b32 v251, a190
  v_accvgpr_read_b32 v14, a191
  v_mul_f32 v249, v249, v245
  v_mul_f32 v250, v250, v245
  v_mul_f32 v251, v251, v245
  v_mul_f32 v14, v14, v245
  v_accvgpr_write_b32 a188, v249
  v_accvgpr_write_b32 a189, v250
  v_accvgpr_write_b32 a190, v251
  v_accvgpr_write_b32 a191, v14
  s_mov_b32 s52, 0
  s_nop 3
  s_branch L_attn_rsret5
L_attn_rs6:
  s_nop 15
  v_accvgpr_read_b32 v249, a0
  v_accvgpr_read_b32 v250, a1
  v_accvgpr_read_b32 v251, a2
  v_accvgpr_read_b32 v14, a3
  v_mul_f32 v249, v249, v243
  v_mul_f32 v250, v250, v243
  v_mul_f32 v251, v251, v243
  v_mul_f32 v14, v14, v243
  v_accvgpr_write_b32 a0, v249
  v_accvgpr_write_b32 a1, v250
  v_accvgpr_write_b32 a2, v251
  v_accvgpr_write_b32 a3, v14
  v_accvgpr_read_b32 v249, a4
  v_accvgpr_read_b32 v250, a5
  v_accvgpr_read_b32 v251, a6
  v_accvgpr_read_b32 v14, a7
  v_mul_f32 v249, v249, v243
  v_mul_f32 v250, v250, v243
  v_mul_f32 v251, v251, v243
  v_mul_f32 v14, v14, v243
  v_accvgpr_write_b32 a4, v249
  v_accvgpr_write_b32 a5, v250
  v_accvgpr_write_b32 a6, v251
  v_accvgpr_write_b32 a7, v14
  v_accvgpr_read_b32 v249, a8
  v_accvgpr_read_b32 v250, a9
  v_accvgpr_read_b32 v251, a10
  v_accvgpr_read_b32 v14, a11
  v_mul_f32 v249, v249, v243
  v_mul_f32 v250, v250, v243
  v_mul_f32 v251, v251, v243
  v_mul_f32 v14, v14, v243
  v_accvgpr_write_b32 a8, v249
  v_accvgpr_write_b32 a9, v250
  v_accvgpr_write_b32 a10, v251
  v_accvgpr_write_b32 a11, v14
  v_accvgpr_read_b32 v249, a12
  v_accvgpr_read_b32 v250, a13
  v_accvgpr_read_b32 v251, a14
  v_accvgpr_read_b32 v14, a15
  v_mul_f32 v249, v249, v243
  v_mul_f32 v250, v250, v243
  v_mul_f32 v251, v251, v243
  v_mul_f32 v14, v14, v243
  v_accvgpr_write_b32 a12, v249
  v_accvgpr_write_b32 a13, v250
  v_accvgpr_write_b32 a14, v251
  v_accvgpr_write_b32 a15, v14
  v_accvgpr_read_b32 v249, a16
  v_accvgpr_read_b32 v250, a17
  v_accvgpr_read_b32 v251, a18
  v_accvgpr_read_b32 v14, a19
  v_mul_f32 v249, v249, v243
  v_mul_f32 v250, v250, v243
  v_mul_f32 v251, v251, v243
  v_mul_f32 v14, v14, v243
  v_accvgpr_write_b32 a16, v249
  v_accvgpr_write_b32 a17, v250
  v_accvgpr_write_b32 a18, v251
  v_accvgpr_write_b32 a19, v14
  v_accvgpr_read_b32 v249, a20
  v_accvgpr_read_b32 v250, a21
  v_accvgpr_read_b32 v251, a22
  v_accvgpr_read_b32 v14, a23
  v_mul_f32 v249, v249, v243
  v_mul_f32 v250, v250, v243
  v_mul_f32 v251, v251, v243
  v_mul_f32 v14, v14, v243
  v_accvgpr_write_b32 a20, v249
  v_accvgpr_write_b32 a21, v250
  v_accvgpr_write_b32 a22, v251
  v_accvgpr_write_b32 a23, v14
  v_accvgpr_read_b32 v249, a24
  v_accvgpr_read_b32 v250, a25
  v_accvgpr_read_b32 v251, a26
  v_accvgpr_read_b32 v14, a27
  v_mul_f32 v249, v249, v243
  v_mul_f32 v250, v250, v243
  v_mul_f32 v251, v251, v243
  v_mul_f32 v14, v14, v243
  v_accvgpr_write_b32 a24, v249
  v_accvgpr_write_b32 a25, v250
  v_accvgpr_write_b32 a26, v251
  v_accvgpr_write_b32 a27, v14
  v_accvgpr_read_b32 v249, a28
  v_accvgpr_read_b32 v250, a29
  v_accvgpr_read_b32 v251, a30
  v_accvgpr_read_b32 v14, a31
  v_mul_f32 v249, v249, v243
  v_mul_f32 v250, v250, v243
  v_mul_f32 v251, v251, v243
  v_mul_f32 v14, v14, v243
  v_accvgpr_write_b32 a28, v249
  v_accvgpr_write_b32 a29, v250
  v_accvgpr_write_b32 a30, v251
  v_accvgpr_write_b32 a31, v14
  v_accvgpr_read_b32 v249, a32
  v_accvgpr_read_b32 v250, a33
  v_accvgpr_read_b32 v251, a34
  v_accvgpr_read_b32 v14, a35
  v_mul_f32 v249, v249, v243
  v_mul_f32 v250, v250, v243
  v_mul_f32 v251, v251, v243
  v_mul_f32 v14, v14, v243
  v_accvgpr_write_b32 a32, v249
  v_accvgpr_write_b32 a33, v250
  v_accvgpr_write_b32 a34, v251
  v_accvgpr_write_b32 a35, v14
  v_accvgpr_read_b32 v249, a36
  v_accvgpr_read_b32 v250, a37
  v_accvgpr_read_b32 v251, a38
  v_accvgpr_read_b32 v14, a39
  v_mul_f32 v249, v249, v243
  v_mul_f32 v250, v250, v243
  v_mul_f32 v251, v251, v243
  v_mul_f32 v14, v14, v243
  v_accvgpr_write_b32 a36, v249
  v_accvgpr_write_b32 a37, v250
  v_accvgpr_write_b32 a38, v251
  v_accvgpr_write_b32 a39, v14
  v_accvgpr_read_b32 v249, a40
  v_accvgpr_read_b32 v250, a41
  v_accvgpr_read_b32 v251, a42
  v_accvgpr_read_b32 v14, a43
  v_mul_f32 v249, v249, v243
  v_mul_f32 v250, v250, v243
  v_mul_f32 v251, v251, v243
  v_mul_f32 v14, v14, v243
  v_accvgpr_write_b32 a40, v249
  v_accvgpr_write_b32 a41, v250
  v_accvgpr_write_b32 a42, v251
  v_accvgpr_write_b32 a43, v14
  v_accvgpr_read_b32 v249, a44
  v_accvgpr_read_b32 v250, a45
  v_accvgpr_read_b32 v251, a46
  v_accvgpr_read_b32 v14, a47
  v_mul_f32 v249, v249, v243
  v_mul_f32 v250, v250, v243
  v_mul_f32 v251, v251, v243
  v_mul_f32 v14, v14, v243
  v_accvgpr_write_b32 a44, v249
  v_accvgpr_write_b32 a45, v250
  v_accvgpr_write_b32 a46, v251
  v_accvgpr_write_b32 a47, v14
  v_accvgpr_read_b32 v249, a48
  v_accvgpr_read_b32 v250, a49
  v_accvgpr_read_b32 v251, a50
  v_accvgpr_read_b32 v14, a51
  v_mul_f32 v249, v249, v243
  v_mul_f32 v250, v250, v243
  v_mul_f32 v251, v251, v243
  v_mul_f32 v14, v14, v243
  v_accvgpr_write_b32 a48, v249
  v_accvgpr_write_b32 a49, v250
  v_accvgpr_write_b32 a50, v251
  v_accvgpr_write_b32 a51, v14
  v_accvgpr_read_b32 v249, a52
  v_accvgpr_read_b32 v250, a53
  v_accvgpr_read_b32 v251, a54
  v_accvgpr_read_b32 v14, a55
  v_mul_f32 v249, v249, v243
  v_mul_f32 v250, v250, v243
  v_mul_f32 v251, v251, v243
  v_mul_f32 v14, v14, v243
  v_accvgpr_write_b32 a52, v249
  v_accvgpr_write_b32 a53, v250
  v_accvgpr_write_b32 a54, v251
  v_accvgpr_write_b32 a55, v14
  v_accvgpr_read_b32 v249, a56
  v_accvgpr_read_b32 v250, a57
  v_accvgpr_read_b32 v251, a58
  v_accvgpr_read_b32 v14, a59
  v_mul_f32 v249, v249, v243
  v_mul_f32 v250, v250, v243
  v_mul_f32 v251, v251, v243
  v_mul_f32 v14, v14, v243
  v_accvgpr_write_b32 a56, v249
  v_accvgpr_write_b32 a57, v250
  v_accvgpr_write_b32 a58, v251
  v_accvgpr_write_b32 a59, v14
  v_accvgpr_read_b32 v249, a60
  v_accvgpr_read_b32 v250, a61
  v_accvgpr_read_b32 v251, a62
  v_accvgpr_read_b32 v14, a63
  v_mul_f32 v249, v249, v243
  v_mul_f32 v250, v250, v243
  v_mul_f32 v251, v251, v243
  v_mul_f32 v14, v14, v243
  v_accvgpr_write_b32 a60, v249
  v_accvgpr_write_b32 a61, v250
  v_accvgpr_write_b32 a62, v251
  v_accvgpr_write_b32 a63, v14
  v_accvgpr_read_b32 v249, a64
  v_accvgpr_read_b32 v250, a65
  v_accvgpr_read_b32 v251, a66
  v_accvgpr_read_b32 v14, a67
  v_mul_f32 v249, v249, v244
  v_mul_f32 v250, v250, v244
  v_mul_f32 v251, v251, v244
  v_mul_f32 v14, v14, v244
  v_accvgpr_write_b32 a64, v249
  v_accvgpr_write_b32 a65, v250
  v_accvgpr_write_b32 a66, v251
  v_accvgpr_write_b32 a67, v14
  v_accvgpr_read_b32 v249, a68
  v_accvgpr_read_b32 v250, a69
  v_accvgpr_read_b32 v251, a70
  v_accvgpr_read_b32 v14, a71
  v_mul_f32 v249, v249, v244
  v_mul_f32 v250, v250, v244
  v_mul_f32 v251, v251, v244
  v_mul_f32 v14, v14, v244
  v_accvgpr_write_b32 a68, v249
  v_accvgpr_write_b32 a69, v250
  v_accvgpr_write_b32 a70, v251
  v_accvgpr_write_b32 a71, v14
  v_accvgpr_read_b32 v249, a72
  v_accvgpr_read_b32 v250, a73
  v_accvgpr_read_b32 v251, a74
  v_accvgpr_read_b32 v14, a75
  v_mul_f32 v249, v249, v244
  v_mul_f32 v250, v250, v244
  v_mul_f32 v251, v251, v244
  v_mul_f32 v14, v14, v244
  v_accvgpr_write_b32 a72, v249
  v_accvgpr_write_b32 a73, v250
  v_accvgpr_write_b32 a74, v251
  v_accvgpr_write_b32 a75, v14
  v_accvgpr_read_b32 v249, a76
  v_accvgpr_read_b32 v250, a77
  v_accvgpr_read_b32 v251, a78
  v_accvgpr_read_b32 v14, a79
  v_mul_f32 v249, v249, v244
  v_mul_f32 v250, v250, v244
  v_mul_f32 v251, v251, v244
  v_mul_f32 v14, v14, v244
  v_accvgpr_write_b32 a76, v249
  v_accvgpr_write_b32 a77, v250
  v_accvgpr_write_b32 a78, v251
  v_accvgpr_write_b32 a79, v14
  v_accvgpr_read_b32 v249, a80
  v_accvgpr_read_b32 v250, a81
  v_accvgpr_read_b32 v251, a82
  v_accvgpr_read_b32 v14, a83
  v_mul_f32 v249, v249, v244
  v_mul_f32 v250, v250, v244
  v_mul_f32 v251, v251, v244
  v_mul_f32 v14, v14, v244
  v_accvgpr_write_b32 a80, v249
  v_accvgpr_write_b32 a81, v250
  v_accvgpr_write_b32 a82, v251
  v_accvgpr_write_b32 a83, v14
  v_accvgpr_read_b32 v249, a84
  v_accvgpr_read_b32 v250, a85
  v_accvgpr_read_b32 v251, a86
  v_accvgpr_read_b32 v14, a87
  v_mul_f32 v249, v249, v244
  v_mul_f32 v250, v250, v244
  v_mul_f32 v251, v251, v244
  v_mul_f32 v14, v14, v244
  v_accvgpr_write_b32 a84, v249
  v_accvgpr_write_b32 a85, v250
  v_accvgpr_write_b32 a86, v251
  v_accvgpr_write_b32 a87, v14
  v_accvgpr_read_b32 v249, a88
  v_accvgpr_read_b32 v250, a89
  v_accvgpr_read_b32 v251, a90
  v_accvgpr_read_b32 v14, a91
  v_mul_f32 v249, v249, v244
  v_mul_f32 v250, v250, v244
  v_mul_f32 v251, v251, v244
  v_mul_f32 v14, v14, v244
  v_accvgpr_write_b32 a88, v249
  v_accvgpr_write_b32 a89, v250
  v_accvgpr_write_b32 a90, v251
  v_accvgpr_write_b32 a91, v14
  v_accvgpr_read_b32 v249, a92
  v_accvgpr_read_b32 v250, a93
  v_accvgpr_read_b32 v251, a94
  v_accvgpr_read_b32 v14, a95
  v_mul_f32 v249, v249, v244
  v_mul_f32 v250, v250, v244
  v_mul_f32 v251, v251, v244
  v_mul_f32 v14, v14, v244
  v_accvgpr_write_b32 a92, v249
  v_accvgpr_write_b32 a93, v250
  v_accvgpr_write_b32 a94, v251
  v_accvgpr_write_b32 a95, v14
  v_accvgpr_read_b32 v249, a96
  v_accvgpr_read_b32 v250, a97
  v_accvgpr_read_b32 v251, a98
  v_accvgpr_read_b32 v14, a99
  v_mul_f32 v249, v249, v244
  v_mul_f32 v250, v250, v244
  v_mul_f32 v251, v251, v244
  v_mul_f32 v14, v14, v244
  v_accvgpr_write_b32 a96, v249
  v_accvgpr_write_b32 a97, v250
  v_accvgpr_write_b32 a98, v251
  v_accvgpr_write_b32 a99, v14
  v_accvgpr_read_b32 v249, a100
  v_accvgpr_read_b32 v250, a101
  v_accvgpr_read_b32 v251, a102
  v_accvgpr_read_b32 v14, a103
  v_mul_f32 v249, v249, v244
  v_mul_f32 v250, v250, v244
  v_mul_f32 v251, v251, v244
  v_mul_f32 v14, v14, v244
  v_accvgpr_write_b32 a100, v249
  v_accvgpr_write_b32 a101, v250
  v_accvgpr_write_b32 a102, v251
  v_accvgpr_write_b32 a103, v14
  v_accvgpr_read_b32 v249, a104
  v_accvgpr_read_b32 v250, a105
  v_accvgpr_read_b32 v251, a106
  v_accvgpr_read_b32 v14, a107
  v_mul_f32 v249, v249, v244
  v_mul_f32 v250, v250, v244
  v_mul_f32 v251, v251, v244
  v_mul_f32 v14, v14, v244
  v_accvgpr_write_b32 a104, v249
  v_accvgpr_write_b32 a105, v250
  v_accvgpr_write_b32 a106, v251
  v_accvgpr_write_b32 a107, v14
  v_accvgpr_read_b32 v249, a108
  v_accvgpr_read_b32 v250, a109
  v_accvgpr_read_b32 v251, a110
  v_accvgpr_read_b32 v14, a111
  v_mul_f32 v249, v249, v244
  v_mul_f32 v250, v250, v244
  v_mul_f32 v251, v251, v244
  v_mul_f32 v14, v14, v244
  v_accvgpr_write_b32 a108, v249
  v_accvgpr_write_b32 a109, v250
  v_accvgpr_write_b32 a110, v251
  v_accvgpr_write_b32 a111, v14
  v_accvgpr_read_b32 v249, a112
  v_accvgpr_read_b32 v250, a113
  v_accvgpr_read_b32 v251, a114
  v_accvgpr_read_b32 v14, a115
  v_mul_f32 v249, v249, v244
  v_mul_f32 v250, v250, v244
  v_mul_f32 v251, v251, v244
  v_mul_f32 v14, v14, v244
  v_accvgpr_write_b32 a112, v249
  v_accvgpr_write_b32 a113, v250
  v_accvgpr_write_b32 a114, v251
  v_accvgpr_write_b32 a115, v14
  v_accvgpr_read_b32 v249, a116
  v_accvgpr_read_b32 v250, a117
  v_accvgpr_read_b32 v251, a118
  v_accvgpr_read_b32 v14, a119
  v_mul_f32 v249, v249, v244
  v_mul_f32 v250, v250, v244
  v_mul_f32 v251, v251, v244
  v_mul_f32 v14, v14, v244
  v_accvgpr_write_b32 a116, v249
  v_accvgpr_write_b32 a117, v250
  v_accvgpr_write_b32 a118, v251
  v_accvgpr_write_b32 a119, v14
  v_accvgpr_read_b32 v249, a120
  v_accvgpr_read_b32 v250, a121
  v_accvgpr_read_b32 v251, a122
  v_accvgpr_read_b32 v14, a123
  v_mul_f32 v249, v249, v244
  v_mul_f32 v250, v250, v244
  v_mul_f32 v251, v251, v244
  v_mul_f32 v14, v14, v244
  v_accvgpr_write_b32 a120, v249
  v_accvgpr_write_b32 a121, v250
  v_accvgpr_write_b32 a122, v251
  v_accvgpr_write_b32 a123, v14
  v_accvgpr_read_b32 v249, a124
  v_accvgpr_read_b32 v250, a125
  v_accvgpr_read_b32 v251, a126
  v_accvgpr_read_b32 v14, a127
  v_mul_f32 v249, v249, v244
  v_mul_f32 v250, v250, v244
  v_mul_f32 v251, v251, v244
  v_mul_f32 v14, v14, v244
  v_accvgpr_write_b32 a124, v249
  v_accvgpr_write_b32 a125, v250
  v_accvgpr_write_b32 a126, v251
  v_accvgpr_write_b32 a127, v14
  v_accvgpr_read_b32 v249, a128
  v_accvgpr_read_b32 v250, a129
  v_accvgpr_read_b32 v251, a130
  v_accvgpr_read_b32 v14, a131
  v_mul_f32 v249, v249, v245
  v_mul_f32 v250, v250, v245
  v_mul_f32 v251, v251, v245
  v_mul_f32 v14, v14, v245
  v_accvgpr_write_b32 a128, v249
  v_accvgpr_write_b32 a129, v250
  v_accvgpr_write_b32 a130, v251
  v_accvgpr_write_b32 a131, v14
  v_accvgpr_read_b32 v249, a132
  v_accvgpr_read_b32 v250, a133
  v_accvgpr_read_b32 v251, a134
  v_accvgpr_read_b32 v14, a135
  v_mul_f32 v249, v249, v245
  v_mul_f32 v250, v250, v245
  v_mul_f32 v251, v251, v245
  v_mul_f32 v14, v14, v245
  v_accvgpr_write_b32 a132, v249
  v_accvgpr_write_b32 a133, v250
  v_accvgpr_write_b32 a134, v251
  v_accvgpr_write_b32 a135, v14
  v_accvgpr_read_b32 v249, a136
  v_accvgpr_read_b32 v250, a137
  v_accvgpr_read_b32 v251, a138
  v_accvgpr_read_b32 v14, a139
  v_mul_f32 v249, v249, v245
  v_mul_f32 v250, v250, v245
  v_mul_f32 v251, v251, v245
  v_mul_f32 v14, v14, v245
  v_accvgpr_write_b32 a136, v249
  v_accvgpr_write_b32 a137, v250
  v_accvgpr_write_b32 a138, v251
  v_accvgpr_write_b32 a139, v14
  v_accvgpr_read_b32 v249, a140
  v_accvgpr_read_b32 v250, a141
  v_accvgpr_read_b32 v251, a142
  v_accvgpr_read_b32 v14, a143
  v_mul_f32 v249, v249, v245
  v_mul_f32 v250, v250, v245
  v_mul_f32 v251, v251, v245
  v_mul_f32 v14, v14, v245
  v_accvgpr_write_b32 a140, v249
  v_accvgpr_write_b32 a141, v250
  v_accvgpr_write_b32 a142, v251
  v_accvgpr_write_b32 a143, v14
  v_accvgpr_read_b32 v249, a144
  v_accvgpr_read_b32 v250, a145
  v_accvgpr_read_b32 v251, a146
  v_accvgpr_read_b32 v14, a147
  v_mul_f32 v249, v249, v245
  v_mul_f32 v250, v250, v245
  v_mul_f32 v251, v251, v245
  v_mul_f32 v14, v14, v245
  v_accvgpr_write_b32 a144, v249
  v_accvgpr_write_b32 a145, v250
  v_accvgpr_write_b32 a146, v251
  v_accvgpr_write_b32 a147, v14
  v_accvgpr_read_b32 v249, a148
  v_accvgpr_read_b32 v250, a149
  v_accvgpr_read_b32 v251, a150
  v_accvgpr_read_b32 v14, a151
  v_mul_f32 v249, v249, v245
  v_mul_f32 v250, v250, v245
  v_mul_f32 v251, v251, v245
  v_mul_f32 v14, v14, v245
  v_accvgpr_write_b32 a148, v249
  v_accvgpr_write_b32 a149, v250
  v_accvgpr_write_b32 a150, v251
  v_accvgpr_write_b32 a151, v14
  v_accvgpr_read_b32 v249, a152
  v_accvgpr_read_b32 v250, a153
  v_accvgpr_read_b32 v251, a154
  v_accvgpr_read_b32 v14, a155
  v_mul_f32 v249, v249, v245
  v_mul_f32 v250, v250, v245
  v_mul_f32 v251, v251, v245
  v_mul_f32 v14, v14, v245
  v_accvgpr_write_b32 a152, v249
  v_accvgpr_write_b32 a153, v250
  v_accvgpr_write_b32 a154, v251
  v_accvgpr_write_b32 a155, v14
  v_accvgpr_read_b32 v249, a156
  v_accvgpr_read_b32 v250, a157
  v_accvgpr_read_b32 v251, a158
  v_accvgpr_read_b32 v14, a159
  v_mul_f32 v249, v249, v245
  v_mul_f32 v250, v250, v245
  v_mul_f32 v251, v251, v245
  v_mul_f32 v14, v14, v245
  v_accvgpr_write_b32 a156, v249
  v_accvgpr_write_b32 a157, v250
  v_accvgpr_write_b32 a158, v251
  v_accvgpr_write_b32 a159, v14
  v_accvgpr_read_b32 v249, a160
  v_accvgpr_read_b32 v250, a161
  v_accvgpr_read_b32 v251, a162
  v_accvgpr_read_b32 v14, a163
  v_mul_f32 v249, v249, v245
  v_mul_f32 v250, v250, v245
  v_mul_f32 v251, v251, v245
  v_mul_f32 v14, v14, v245
  v_accvgpr_write_b32 a160, v249
  v_accvgpr_write_b32 a161, v250
  v_accvgpr_write_b32 a162, v251
  v_accvgpr_write_b32 a163, v14
  v_accvgpr_read_b32 v249, a164
  v_accvgpr_read_b32 v250, a165
  v_accvgpr_read_b32 v251, a166
  v_accvgpr_read_b32 v14, a167
  v_mul_f32 v249, v249, v245
  v_mul_f32 v250, v250, v245
  v_mul_f32 v251, v251, v245
  v_mul_f32 v14, v14, v245
  v_accvgpr_write_b32 a164, v249
  v_accvgpr_write_b32 a165, v250
  v_accvgpr_write_b32 a166, v251
  v_accvgpr_write_b32 a167, v14
  v_accvgpr_read_b32 v249, a168
  v_accvgpr_read_b32 v250, a169
  v_accvgpr_read_b32 v251, a170
  v_accvgpr_read_b32 v14, a171
  v_mul_f32 v249, v249, v245
  v_mul_f32 v250, v250, v245
  v_mul_f32 v251, v251, v245
  v_mul_f32 v14, v14, v245
  v_accvgpr_write_b32 a168, v249
  v_accvgpr_write_b32 a169, v250
  v_accvgpr_write_b32 a170, v251
  v_accvgpr_write_b32 a171, v14
  v_accvgpr_read_b32 v249, a172
  v_accvgpr_read_b32 v250, a173
  v_accvgpr_read_b32 v251, a174
  v_accvgpr_read_b32 v14, a175
  v_mul_f32 v249, v249, v245
  v_mul_f32 v250, v250, v245
  v_mul_f32 v251, v251, v245
  v_mul_f32 v14, v14, v245
  v_accvgpr_write_b32 a172, v249
  v_accvgpr_write_b32 a173, v250
  v_accvgpr_write_b32 a174, v251
  v_accvgpr_write_b32 a175, v14
  v_accvgpr_read_b32 v249, a176
  v_accvgpr_read_b32 v250, a177
  v_accvgpr_read_b32 v251, a178
  v_accvgpr_read_b32 v14, a179
  v_mul_f32 v249, v249, v245
  v_mul_f32 v250, v250, v245
  v_mul_f32 v251, v251, v245
  v_mul_f32 v14, v14, v245
  v_accvgpr_write_b32 a176, v249
  v_accvgpr_write_b32 a177, v250
  v_accvgpr_write_b32 a178, v251
  v_accvgpr_write_b32 a179, v14
  v_accvgpr_read_b32 v249, a180
  v_accvgpr_read_b32 v250, a181
  v_accvgpr_read_b32 v251, a182
  v_accvgpr_read_b32 v14, a183
  v_mul_f32 v249, v249, v245
  v_mul_f32 v250, v250, v245
  v_mul_f32 v251, v251, v245
  v_mul_f32 v14, v14, v245
  v_accvgpr_write_b32 a180, v249
  v_accvgpr_write_b32 a181, v250
  v_accvgpr_write_b32 a182, v251
  v_accvgpr_write_b32 a183, v14
  v_accvgpr_read_b32 v249, a184
  v_accvgpr_read_b32 v250, a185
  v_accvgpr_read_b32 v251, a186
  v_accvgpr_read_b32 v14, a187
  v_mul_f32 v249, v249, v245
  v_mul_f32 v250, v250, v245
  v_mul_f32 v251, v251, v245
  v_mul_f32 v14, v14, v245
  v_accvgpr_write_b32 a184, v249
  v_accvgpr_write_b32 a185, v250
  v_accvgpr_write_b32 a186, v251
  v_accvgpr_write_b32 a187, v14
  v_accvgpr_read_b32 v249, a188
  v_accvgpr_read_b32 v250, a189
  v_accvgpr_read_b32 v251, a190
  v_accvgpr_read_b32 v14, a191
  v_mul_f32 v249, v249, v245
  v_mul_f32 v250, v250, v245
  v_mul_f32 v251, v251, v245
  v_mul_f32 v14, v14, v245
  v_accvgpr_write_b32 a188, v249
  v_accvgpr_write_b32 a189, v250
  v_accvgpr_write_b32 a190, v251
  v_accvgpr_write_b32 a191, v14
  s_mov_b32 s52, 0
  s_nop 3
  s_branch L_attn_rsret6
L_attn_rs7:
  s_nop 15
  v_accvgpr_read_b32 v249, a0
  v_accvgpr_read_b32 v250, a1
  v_accvgpr_read_b32 v251, a2
  v_accvgpr_read_b32 v14, a3
  v_mul_f32 v249, v249, v243
  v_mul_f32 v250, v250, v243
  v_mul_f32 v251, v251, v243
  v_mul_f32 v14, v14, v243
  v_accvgpr_write_b32 a0, v249
  v_accvgpr_write_b32 a1, v250
  v_accvgpr_write_b32 a2, v251
  v_accvgpr_write_b32 a3, v14
  v_accvgpr_read_b32 v249, a4
  v_accvgpr_read_b32 v250, a5
  v_accvgpr_read_b32 v251, a6
  v_accvgpr_read_b32 v14, a7
  v_mul_f32 v249, v249, v243
  v_mul_f32 v250, v250, v243
  v_mul_f32 v251, v251, v243
  v_mul_f32 v14, v14, v243
  v_accvgpr_write_b32 a4, v249
  v_accvgpr_write_b32 a5, v250
  v_accvgpr_write_b32 a6, v251
  v_accvgpr_write_b32 a7, v14
  v_accvgpr_read_b32 v249, a8
  v_accvgpr_read_b32 v250, a9
  v_accvgpr_read_b32 v251, a10
  v_accvgpr_read_b32 v14, a11
  v_mul_f32 v249, v249, v243
  v_mul_f32 v250, v250, v243
  v_mul_f32 v251, v251, v243
  v_mul_f32 v14, v14, v243
  v_accvgpr_write_b32 a8, v249
  v_accvgpr_write_b32 a9, v250
  v_accvgpr_write_b32 a10, v251
  v_accvgpr_write_b32 a11, v14
  v_accvgpr_read_b32 v249, a12
  v_accvgpr_read_b32 v250, a13
  v_accvgpr_read_b32 v251, a14
  v_accvgpr_read_b32 v14, a15
  v_mul_f32 v249, v249, v243
  v_mul_f32 v250, v250, v243
  v_mul_f32 v251, v251, v243
  v_mul_f32 v14, v14, v243
  v_accvgpr_write_b32 a12, v249
  v_accvgpr_write_b32 a13, v250
  v_accvgpr_write_b32 a14, v251
  v_accvgpr_write_b32 a15, v14
  v_accvgpr_read_b32 v249, a16
  v_accvgpr_read_b32 v250, a17
  v_accvgpr_read_b32 v251, a18
  v_accvgpr_read_b32 v14, a19
  v_mul_f32 v249, v249, v243
  v_mul_f32 v250, v250, v243
  v_mul_f32 v251, v251, v243
  v_mul_f32 v14, v14, v243
  v_accvgpr_write_b32 a16, v249
  v_accvgpr_write_b32 a17, v250
  v_accvgpr_write_b32 a18, v251
  v_accvgpr_write_b32 a19, v14
  v_accvgpr_read_b32 v249, a20
  v_accvgpr_read_b32 v250, a21
  v_accvgpr_read_b32 v251, a22
  v_accvgpr_read_b32 v14, a23
  v_mul_f32 v249, v249, v243
  v_mul_f32 v250, v250, v243
  v_mul_f32 v251, v251, v243
  v_mul_f32 v14, v14, v243
  v_accvgpr_write_b32 a20, v249
  v_accvgpr_write_b32 a21, v250
  v_accvgpr_write_b32 a22, v251
  v_accvgpr_write_b32 a23, v14
  v_accvgpr_read_b32 v249, a24
  v_accvgpr_read_b32 v250, a25
  v_accvgpr_read_b32 v251, a26
  v_accvgpr_read_b32 v14, a27
  v_mul_f32 v249, v249, v243
  v_mul_f32 v250, v250, v243
  v_mul_f32 v251, v251, v243
  v_mul_f32 v14, v14, v243
  v_accvgpr_write_b32 a24, v249
  v_accvgpr_write_b32 a25, v250
  v_accvgpr_write_b32 a26, v251
  v_accvgpr_write_b32 a27, v14
  v_accvgpr_read_b32 v249, a28
  v_accvgpr_read_b32 v250, a29
  v_accvgpr_read_b32 v251, a30
  v_accvgpr_read_b32 v14, a31
  v_mul_f32 v249, v249, v243
  v_mul_f32 v250, v250, v243
  v_mul_f32 v251, v251, v243
  v_mul_f32 v14, v14, v243
  v_accvgpr_write_b32 a28, v249
  v_accvgpr_write_b32 a29, v250
  v_accvgpr_write_b32 a30, v251
  v_accvgpr_write_b32 a31, v14
  v_accvgpr_read_b32 v249, a32
  v_accvgpr_read_b32 v250, a33
  v_accvgpr_read_b32 v251, a34
  v_accvgpr_read_b32 v14, a35
  v_mul_f32 v249, v249, v243
  v_mul_f32 v250, v250, v243
  v_mul_f32 v251, v251, v243
  v_mul_f32 v14, v14, v243
  v_accvgpr_write_b32 a32, v249
  v_accvgpr_write_b32 a33, v250
  v_accvgpr_write_b32 a34, v251
  v_accvgpr_write_b32 a35, v14
  v_accvgpr_read_b32 v249, a36
  v_accvgpr_read_b32 v250, a37
  v_accvgpr_read_b32 v251, a38
  v_accvgpr_read_b32 v14, a39
  v_mul_f32 v249, v249, v243
  v_mul_f32 v250, v250, v243
  v_mul_f32 v251, v251, v243
  v_mul_f32 v14, v14, v243
  v_accvgpr_write_b32 a36, v249
  v_accvgpr_write_b32 a37, v250
  v_accvgpr_write_b32 a38, v251
  v_accvgpr_write_b32 a39, v14
  v_accvgpr_read_b32 v249, a40
  v_accvgpr_read_b32 v250, a41
  v_accvgpr_read_b32 v251, a42
  v_accvgpr_read_b32 v14, a43
  v_mul_f32 v249, v249, v243
  v_mul_f32 v250, v250, v243
  v_mul_f32 v251, v251, v243
  v_mul_f32 v14, v14, v243
  v_accvgpr_write_b32 a40, v249
  v_accvgpr_write_b32 a41, v250
  v_accvgpr_write_b32 a42, v251
  v_accvgpr_write_b32 a43, v14
  v_accvgpr_read_b32 v249, a44
  v_accvgpr_read_b32 v250, a45
  v_accvgpr_read_b32 v251, a46
  v_accvgpr_read_b32 v14, a47
  v_mul_f32 v249, v249, v243
  v_mul_f32 v250, v250, v243
  v_mul_f32 v251, v251, v243
  v_mul_f32 v14, v14, v243
  v_accvgpr_write_b32 a44, v249
  v_accvgpr_write_b32 a45, v250
  v_accvgpr_write_b32 a46, v251
  v_accvgpr_write_b32 a47, v14
  v_accvgpr_read_b32 v249, a48
  v_accvgpr_read_b32 v250, a49
  v_accvgpr_read_b32 v251, a50
  v_accvgpr_read_b32 v14, a51
  v_mul_f32 v249, v249, v243
  v_mul_f32 v250, v250, v243
  v_mul_f32 v251, v251, v243
  v_mul_f32 v14, v14, v243
  v_accvgpr_write_b32 a48, v249
  v_accvgpr_write_b32 a49, v250
  v_accvgpr_write_b32 a50, v251
  v_accvgpr_write_b32 a51, v14
  v_accvgpr_read_b32 v249, a52
  v_accvgpr_read_b32 v250, a53
  v_accvgpr_read_b32 v251, a54
  v_accvgpr_read_b32 v14, a55
  v_mul_f32 v249, v249, v243
  v_mul_f32 v250, v250, v243
  v_mul_f32 v251, v251, v243
  v_mul_f32 v14, v14, v243
  v_accvgpr_write_b32 a52, v249
  v_accvgpr_write_b32 a53, v250
  v_accvgpr_write_b32 a54, v251
  v_accvgpr_write_b32 a55, v14
  v_accvgpr_read_b32 v249, a56
  v_accvgpr_read_b32 v250, a57
  v_accvgpr_read_b32 v251, a58
  v_accvgpr_read_b32 v14, a59
  v_mul_f32 v249, v249, v243
  v_mul_f32 v250, v250, v243
  v_mul_f32 v251, v251, v243
  v_mul_f32 v14, v14, v243
  v_accvgpr_write_b32 a56, v249
  v_accvgpr_write_b32 a57, v250
  v_accvgpr_write_b32 a58, v251
  v_accvgpr_write_b32 a59, v14
  v_accvgpr_read_b32 v249, a60
  v_accvgpr_read_b32 v250, a61
  v_accvgpr_read_b32 v251, a62
  v_accvgpr_read_b32 v14, a63
  v_mul_f32 v249, v249, v243
  v_mul_f32 v250, v250, v243
  v_mul_f32 v251, v251, v243
  v_mul_f32 v14, v14, v243
  v_accvgpr_write_b32 a60, v249
  v_accvgpr_write_b32 a61, v250
  v_accvgpr_write_b32 a62, v251
  v_accvgpr_write_b32 a63, v14
  v_accvgpr_read_b32 v249, a64
  v_accvgpr_read_b32 v250, a65
  v_accvgpr_read_b32 v251, a66
  v_accvgpr_read_b32 v14, a67
  v_mul_f32 v249, v249, v244
  v_mul_f32 v250, v250, v244
  v_mul_f32 v251, v251, v244
  v_mul_f32 v14, v14, v244
  v_accvgpr_write_b32 a64, v249
  v_accvgpr_write_b32 a65, v250
  v_accvgpr_write_b32 a66, v251
  v_accvgpr_write_b32 a67, v14
  v_accvgpr_read_b32 v249, a68
  v_accvgpr_read_b32 v250, a69
  v_accvgpr_read_b32 v251, a70
  v_accvgpr_read_b32 v14, a71
  v_mul_f32 v249, v249, v244
  v_mul_f32 v250, v250, v244
  v_mul_f32 v251, v251, v244
  v_mul_f32 v14, v14, v244
  v_accvgpr_write_b32 a68, v249
  v_accvgpr_write_b32 a69, v250
  v_accvgpr_write_b32 a70, v251
  v_accvgpr_write_b32 a71, v14
  v_accvgpr_read_b32 v249, a72
  v_accvgpr_read_b32 v250, a73
  v_accvgpr_read_b32 v251, a74
  v_accvgpr_read_b32 v14, a75
  v_mul_f32 v249, v249, v244
  v_mul_f32 v250, v250, v244
  v_mul_f32 v251, v251, v244
  v_mul_f32 v14, v14, v244
  v_accvgpr_write_b32 a72, v249
  v_accvgpr_write_b32 a73, v250
  v_accvgpr_write_b32 a74, v251
  v_accvgpr_write_b32 a75, v14
  v_accvgpr_read_b32 v249, a76
  v_accvgpr_read_b32 v250, a77
  v_accvgpr_read_b32 v251, a78
  v_accvgpr_read_b32 v14, a79
  v_mul_f32 v249, v249, v244
  v_mul_f32 v250, v250, v244
  v_mul_f32 v251, v251, v244
  v_mul_f32 v14, v14, v244
  v_accvgpr_write_b32 a76, v249
  v_accvgpr_write_b32 a77, v250
  v_accvgpr_write_b32 a78, v251
  v_accvgpr_write_b32 a79, v14
  v_accvgpr_read_b32 v249, a80
  v_accvgpr_read_b32 v250, a81
  v_accvgpr_read_b32 v251, a82
  v_accvgpr_read_b32 v14, a83
  v_mul_f32 v249, v249, v244
  v_mul_f32 v250, v250, v244
  v_mul_f32 v251, v251, v244
  v_mul_f32 v14, v14, v244
  v_accvgpr_write_b32 a80, v249
  v_accvgpr_write_b32 a81, v250
  v_accvgpr_write_b32 a82, v251
  v_accvgpr_write_b32 a83, v14
  v_accvgpr_read_b32 v249, a84
  v_accvgpr_read_b32 v250, a85
  v_accvgpr_read_b32 v251, a86
  v_accvgpr_read_b32 v14, a87
  v_mul_f32 v249, v249, v244
  v_mul_f32 v250, v250, v244
  v_mul_f32 v251, v251, v244
  v_mul_f32 v14, v14, v244
  v_accvgpr_write_b32 a84, v249
  v_accvgpr_write_b32 a85, v250
  v_accvgpr_write_b32 a86, v251
  v_accvgpr_write_b32 a87, v14
  v_accvgpr_read_b32 v249, a88
  v_accvgpr_read_b32 v250, a89
  v_accvgpr_read_b32 v251, a90
  v_accvgpr_read_b32 v14, a91
  v_mul_f32 v249, v249, v244
  v_mul_f32 v250, v250, v244
  v_mul_f32 v251, v251, v244
  v_mul_f32 v14, v14, v244
  v_accvgpr_write_b32 a88, v249
  v_accvgpr_write_b32 a89, v250
  v_accvgpr_write_b32 a90, v251
  v_accvgpr_write_b32 a91, v14
  v_accvgpr_read_b32 v249, a92
  v_accvgpr_read_b32 v250, a93
  v_accvgpr_read_b32 v251, a94
  v_accvgpr_read_b32 v14, a95
  v_mul_f32 v249, v249, v244
  v_mul_f32 v250, v250, v244
  v_mul_f32 v251, v251, v244
  v_mul_f32 v14, v14, v244
  v_accvgpr_write_b32 a92, v249
  v_accvgpr_write_b32 a93, v250
  v_accvgpr_write_b32 a94, v251
  v_accvgpr_write_b32 a95, v14
  v_accvgpr_read_b32 v249, a96
  v_accvgpr_read_b32 v250, a97
  v_accvgpr_read_b32 v251, a98
  v_accvgpr_read_b32 v14, a99
  v_mul_f32 v249, v249, v244
  v_mul_f32 v250, v250, v244
  v_mul_f32 v251, v251, v244
  v_mul_f32 v14, v14, v244
  v_accvgpr_write_b32 a96, v249
  v_accvgpr_write_b32 a97, v250
  v_accvgpr_write_b32 a98, v251
  v_accvgpr_write_b32 a99, v14
  v_accvgpr_read_b32 v249, a100
  v_accvgpr_read_b32 v250, a101
  v_accvgpr_read_b32 v251, a102
  v_accvgpr_read_b32 v14, a103
  v_mul_f32 v249, v249, v244
  v_mul_f32 v250, v250, v244
  v_mul_f32 v251, v251, v244
  v_mul_f32 v14, v14, v244
  v_accvgpr_write_b32 a100, v249
  v_accvgpr_write_b32 a101, v250
  v_accvgpr_write_b32 a102, v251
  v_accvgpr_write_b32 a103, v14
  v_accvgpr_read_b32 v249, a104
  v_accvgpr_read_b32 v250, a105
  v_accvgpr_read_b32 v251, a106
  v_accvgpr_read_b32 v14, a107
  v_mul_f32 v249, v249, v244
  v_mul_f32 v250, v250, v244
  v_mul_f32 v251, v251, v244
  v_mul_f32 v14, v14, v244
  v_accvgpr_write_b32 a104, v249
  v_accvgpr_write_b32 a105, v250
  v_accvgpr_write_b32 a106, v251
  v_accvgpr_write_b32 a107, v14
  v_accvgpr_read_b32 v249, a108
  v_accvgpr_read_b32 v250, a109
  v_accvgpr_read_b32 v251, a110
  v_accvgpr_read_b32 v14, a111
  v_mul_f32 v249, v249, v244
  v_mul_f32 v250, v250, v244
  v_mul_f32 v251, v251, v244
  v_mul_f32 v14, v14, v244
  v_accvgpr_write_b32 a108, v249
  v_accvgpr_write_b32 a109, v250
  v_accvgpr_write_b32 a110, v251
  v_accvgpr_write_b32 a111, v14
  v_accvgpr_read_b32 v249, a112
  v_accvgpr_read_b32 v250, a113
  v_accvgpr_read_b32 v251, a114
  v_accvgpr_read_b32 v14, a115
  v_mul_f32 v249, v249, v244
  v_mul_f32 v250, v250, v244
  v_mul_f32 v251, v251, v244
  v_mul_f32 v14, v14, v244
  v_accvgpr_write_b32 a112, v249
  v_accvgpr_write_b32 a113, v250
  v_accvgpr_write_b32 a114, v251
  v_accvgpr_write_b32 a115, v14
  v_accvgpr_read_b32 v249, a116
  v_accvgpr_read_b32 v250, a117
  v_accvgpr_read_b32 v251, a118
  v_accvgpr_read_b32 v14, a119
  v_mul_f32 v249, v249, v244
  v_mul_f32 v250, v250, v244
  v_mul_f32 v251, v251, v244
  v_mul_f32 v14, v14, v244
  v_accvgpr_write_b32 a116, v249
  v_accvgpr_write_b32 a117, v250
  v_accvgpr_write_b32 a118, v251
  v_accvgpr_write_b32 a119, v14
  v_accvgpr_read_b32 v249, a120
  v_accvgpr_read_b32 v250, a121
  v_accvgpr_read_b32 v251, a122
  v_accvgpr_read_b32 v14, a123
  v_mul_f32 v249, v249, v244
  v_mul_f32 v250, v250, v244
  v_mul_f32 v251, v251, v244
  v_mul_f32 v14, v14, v244
  v_accvgpr_write_b32 a120, v249
  v_accvgpr_write_b32 a121, v250
  v_accvgpr_write_b32 a122, v251
  v_accvgpr_write_b32 a123, v14
  v_accvgpr_read_b32 v249, a124
  v_accvgpr_read_b32 v250, a125
  v_accvgpr_read_b32 v251, a126
  v_accvgpr_read_b32 v14, a127
  v_mul_f32 v249, v249, v244
  v_mul_f32 v250, v250, v244
  v_mul_f32 v251, v251, v244
  v_mul_f32 v14, v14, v244
  v_accvgpr_write_b32 a124, v249
  v_accvgpr_write_b32 a125, v250
  v_accvgpr_write_b32 a126, v251
  v_accvgpr_write_b32 a127, v14
  v_accvgpr_read_b32 v249, a128
  v_accvgpr_read_b32 v250, a129
  v_accvgpr_read_b32 v251, a130
  v_accvgpr_read_b32 v14, a131
  v_mul_f32 v249, v249, v245
  v_mul_f32 v250, v250, v245
  v_mul_f32 v251, v251, v245
  v_mul_f32 v14, v14, v245
  v_accvgpr_write_b32 a128, v249
  v_accvgpr_write_b32 a129, v250
  v_accvgpr_write_b32 a130, v251
  v_accvgpr_write_b32 a131, v14
  v_accvgpr_read_b32 v249, a132
  v_accvgpr_read_b32 v250, a133
  v_accvgpr_read_b32 v251, a134
  v_accvgpr_read_b32 v14, a135
  v_mul_f32 v249, v249, v245
  v_mul_f32 v250, v250, v245
  v_mul_f32 v251, v251, v245
  v_mul_f32 v14, v14, v245
  v_accvgpr_write_b32 a132, v249
  v_accvgpr_write_b32 a133, v250
  v_accvgpr_write_b32 a134, v251
  v_accvgpr_write_b32 a135, v14
  v_accvgpr_read_b32 v249, a136
  v_accvgpr_read_b32 v250, a137
  v_accvgpr_read_b32 v251, a138
  v_accvgpr_read_b32 v14, a139
  v_mul_f32 v249, v249, v245
  v_mul_f32 v250, v250, v245
  v_mul_f32 v251, v251, v245
  v_mul_f32 v14, v14, v245
  v_accvgpr_write_b32 a136, v249
  v_accvgpr_write_b32 a137, v250
  v_accvgpr_write_b32 a138, v251
  v_accvgpr_write_b32 a139, v14
  v_accvgpr_read_b32 v249, a140
  v_accvgpr_read_b32 v250, a141
  v_accvgpr_read_b32 v251, a142
  v_accvgpr_read_b32 v14, a143
  v_mul_f32 v249, v249, v245
  v_mul_f32 v250, v250, v245
  v_mul_f32 v251, v251, v245
  v_mul_f32 v14, v14, v245
  v_accvgpr_write_b32 a140, v249
  v_accvgpr_write_b32 a141, v250
  v_accvgpr_write_b32 a142, v251
  v_accvgpr_write_b32 a143, v14
  v_accvgpr_read_b32 v249, a144
  v_accvgpr_read_b32 v250, a145
  v_accvgpr_read_b32 v251, a146
  v_accvgpr_read_b32 v14, a147
  v_mul_f32 v249, v249, v245
  v_mul_f32 v250, v250, v245
  v_mul_f32 v251, v251, v245
  v_mul_f32 v14, v14, v245
  v_accvgpr_write_b32 a144, v249
  v_accvgpr_write_b32 a145, v250
  v_accvgpr_write_b32 a146, v251
  v_accvgpr_write_b32 a147, v14
  v_accvgpr_read_b32 v249, a148
  v_accvgpr_read_b32 v250, a149
  v_accvgpr_read_b32 v251, a150
  v_accvgpr_read_b32 v14, a151
  v_mul_f32 v249, v249, v245
  v_mul_f32 v250, v250, v245
  v_mul_f32 v251, v251, v245
  v_mul_f32 v14, v14, v245
  v_accvgpr_write_b32 a148, v249
  v_accvgpr_write_b32 a149, v250
  v_accvgpr_write_b32 a150, v251
  v_accvgpr_write_b32 a151, v14
  v_accvgpr_read_b32 v249, a152
  v_accvgpr_read_b32 v250, a153
  v_accvgpr_read_b32 v251, a154
  v_accvgpr_read_b32 v14, a155
  v_mul_f32 v249, v249, v245
  v_mul_f32 v250, v250, v245
  v_mul_f32 v251, v251, v245
  v_mul_f32 v14, v14, v245
  v_accvgpr_write_b32 a152, v249
  v_accvgpr_write_b32 a153, v250
  v_accvgpr_write_b32 a154, v251
  v_accvgpr_write_b32 a155, v14
  v_accvgpr_read_b32 v249, a156
  v_accvgpr_read_b32 v250, a157
  v_accvgpr_read_b32 v251, a158
  v_accvgpr_read_b32 v14, a159
  v_mul_f32 v249, v249, v245
  v_mul_f32 v250, v250, v245
  v_mul_f32 v251, v251, v245
  v_mul_f32 v14, v14, v245
  v_accvgpr_write_b32 a156, v249
  v_accvgpr_write_b32 a157, v250
  v_accvgpr_write_b32 a158, v251
  v_accvgpr_write_b32 a159, v14
  v_accvgpr_read_b32 v249, a160
  v_accvgpr_read_b32 v250, a161
  v_accvgpr_read_b32 v251, a162
  v_accvgpr_read_b32 v14, a163
  v_mul_f32 v249, v249, v245
  v_mul_f32 v250, v250, v245
  v_mul_f32 v251, v251, v245
  v_mul_f32 v14, v14, v245
  v_accvgpr_write_b32 a160, v249
  v_accvgpr_write_b32 a161, v250
  v_accvgpr_write_b32 a162, v251
  v_accvgpr_write_b32 a163, v14
  v_accvgpr_read_b32 v249, a164
  v_accvgpr_read_b32 v250, a165
  v_accvgpr_read_b32 v251, a166
  v_accvgpr_read_b32 v14, a167
  v_mul_f32 v249, v249, v245
  v_mul_f32 v250, v250, v245
  v_mul_f32 v251, v251, v245
  v_mul_f32 v14, v14, v245
  v_accvgpr_write_b32 a164, v249
  v_accvgpr_write_b32 a165, v250
  v_accvgpr_write_b32 a166, v251
  v_accvgpr_write_b32 a167, v14
  v_accvgpr_read_b32 v249, a168
  v_accvgpr_read_b32 v250, a169
  v_accvgpr_read_b32 v251, a170
  v_accvgpr_read_b32 v14, a171
  v_mul_f32 v249, v249, v245
  v_mul_f32 v250, v250, v245
  v_mul_f32 v251, v251, v245
  v_mul_f32 v14, v14, v245
  v_accvgpr_write_b32 a168, v249
  v_accvgpr_write_b32 a169, v250
  v_accvgpr_write_b32 a170, v251
  v_accvgpr_write_b32 a171, v14
  v_accvgpr_read_b32 v249, a172
  v_accvgpr_read_b32 v250, a173
  v_accvgpr_read_b32 v251, a174
  v_accvgpr_read_b32 v14, a175
  v_mul_f32 v249, v249, v245
  v_mul_f32 v250, v250, v245
  v_mul_f32 v251, v251, v245
  v_mul_f32 v14, v14, v245
  v_accvgpr_write_b32 a172, v249
  v_accvgpr_write_b32 a173, v250
  v_accvgpr_write_b32 a174, v251
  v_accvgpr_write_b32 a175, v14
  v_accvgpr_read_b32 v249, a176
  v_accvgpr_read_b32 v250, a177
  v_accvgpr_read_b32 v251, a178
  v_accvgpr_read_b32 v14, a179
  v_mul_f32 v249, v249, v245
  v_mul_f32 v250, v250, v245
  v_mul_f32 v251, v251, v245
  v_mul_f32 v14, v14, v245
  v_accvgpr_write_b32 a176, v249
  v_accvgpr_write_b32 a177, v250
  v_accvgpr_write_b32 a178, v251
  v_accvgpr_write_b32 a179, v14
  v_accvgpr_read_b32 v249, a180
  v_accvgpr_read_b32 v250, a181
  v_accvgpr_read_b32 v251, a182
  v_accvgpr_read_b32 v14, a183
  v_mul_f32 v249, v249, v245
  v_mul_f32 v250, v250, v245
  v_mul_f32 v251, v251, v245
  v_mul_f32 v14, v14, v245
  v_accvgpr_write_b32 a180, v249
  v_accvgpr_write_b32 a181, v250
  v_accvgpr_write_b32 a182, v251
  v_accvgpr_write_b32 a183, v14
  v_accvgpr_read_b32 v249, a184
  v_accvgpr_read_b32 v250, a185
  v_accvgpr_read_b32 v251, a186
  v_accvgpr_read_b32 v14, a187
  v_mul_f32 v249, v249, v245
  v_mul_f32 v250, v250, v245
  v_mul_f32 v251, v251, v245
  v_mul_f32 v14, v14, v245
  v_accvgpr_write_b32 a184, v249
  v_accvgpr_write_b32 a185, v250
  v_accvgpr_write_b32 a186, v251
  v_accvgpr_write_b32 a187, v14
  v_accvgpr_read_b32 v249, a188
  v_accvgpr_read_b32 v250, a189
  v_accvgpr_read_b32 v251, a190
  v_accvgpr_read_b32 v14, a191
  v_mul_f32 v249, v249, v245
  v_mul_f32 v250, v250, v245
  v_mul_f32 v251, v251, v245
  v_mul_f32 v14, v14, v245
  v_accvgpr_write_b32 a188, v249
  v_accvgpr_write_b32 a189, v250
  v_accvgpr_write_b32 a190, v251
  v_accvgpr_write_b32 a191, v14
  s_mov_b32 s52, 0
  s_nop 3
  s_branch L_attn_rsret7
.section .rodata,"a"
.p2align 6
.amdhsa_kernel standalone__mha_block_cached__near_ridge_kernel
  .amdhsa_next_free_vgpr 512
  .amdhsa_next_free_sgpr 102
  .amdhsa_accum_offset 256
  .amdhsa_group_segment_fixed_size 0
  .amdhsa_kernarg_size 64
  .amdhsa_user_sgpr_count 2
  .amdhsa_user_sgpr_kernarg_segment_ptr 1
  .amdhsa_system_sgpr_workgroup_id_x 1
.end_amdhsa_kernel
```
